```python
import torch

def _softmax(x, axis=-1):
    return torch.softmax(x, dim=axis)
def _gelu(x):
    return torch.nn.functional.gelu(x, approximate="tanh")
def _silu(x):
    return torch.nn.functional.silu(x)
def _sigmoid(x):
    return torch.sigmoid(x)
def _layernorm(x, axis=-1, eps=1e-5):
    m = x.mean(dim=axis, keepdim=True)
    v = x.var(dim=axis, keepdim=True, unbiased=False)
    return (x - m) / torch.sqrt(v + eps)
def _scatter_add(tgt, idx, src, axis=0):
    return tgt.clone().index_add_(axis, idx, src)
def _segment_sum(src, seg, n):
    out = torch.zeros((n,) + src.shape[1:], dtype=src.dtype)
    return out.index_add_(0, seg, src)
def _pad(x, pw):
    flat = tuple(v for pair in reversed(pw) for v in pair)
    return torch.nn.functional.pad(x, flat)

kernel_name = 'concat_heads__mha_block__ssm_conv_s4d__prompt'

def setup_inputs():

    _w = (lambda a: (lambda t: t.to(torch.bfloat16) if t.is_floating_point() else t)(torch.as_tensor(a)))
    def _A_setup():
        B, S, D, H = 1, 2048, 576, 32
        return {
            "x": _w((lambda *s: torch.randn(*s, dtype=torch.bfloat16) * 0.2)(B, S, D)),
            "wqkv": _w((lambda *s: torch.randn(*s, dtype=torch.bfloat16) * 0.2)(D, 3 * D)),
            "wo": _w((lambda *s: torch.randn(*s, dtype=torch.bfloat16) * 0.05)(D, D)),
        }
    _A_in = _A_setup()

    def _B_setup():
        Bsz, L, D, N = 1, 2048, 576, 128
        return {
            "u": _w((lambda *s: torch.randn(*s, dtype=torch.bfloat16) * 0.05)(Bsz, L, D)),
            "log_A_real": _w((lambda *s: torch.randn(*s, dtype=torch.bfloat16) * 6.4)(D, N) * 0.5),
            "A_imag": _w((lambda *s: torch.randn(*s, dtype=torch.bfloat16) * 0.1)(D, N) * 3.14),
            "C_real": _w((lambda *s: torch.randn(*s, dtype=torch.bfloat16) * 0.8)(D, N) / N ** 0.5),
            "C_imag": _w((lambda *s: torch.randn(*s, dtype=torch.bfloat16) * 0.8)(D, N) / N ** 0.5),
            "log_dt": _w((lambda *s: torch.randn(*s, dtype=torch.bfloat16) * 0.1)(D) * 0.5 - 4.0),
            "D_skip": _w((lambda *s: torch.randn(*s, dtype=torch.bfloat16) * 0.1)(D)),
        }
    _B_in = _B_setup()

    return {
        "A_x": _A_in["x"],
        "A_wqkv": _A_in["wqkv"],
        "A_wo": _A_in["wo"],
        "B_u": _B_in["u"],
        "B_log_A_real": _B_in["log_A_real"],
        "B_A_imag": _B_in["A_imag"],
        "B_C_real": _B_in["C_real"],
        "B_C_imag": _B_in["C_imag"],
        "B_log_dt": _B_in["log_dt"],
        "B_D_skip": _B_in["D_skip"],
    }

def reference(A_x, A_wqkv, A_wo, B_u, B_log_A_real, B_A_imag, B_C_real, B_C_imag, B_log_dt, B_D_skip):
    def _A_ref(x, wqkv, wo):
        B, S, D = x.shape
        H = 32
        Dh = D // H
        qkv = (lambda x, *d: x.permute(*d))((x @ wqkv).reshape(B, S, 3, H, Dh), 2, 0, 3, 1, 4)
        q, k, v = qkv[0], qkv[1], qkv[2]
        scores = torch.einsum("bhqd,bhkd->bhqk", q, k) * (Dh ** -0.5)
        p = _softmax(scores, axis=-1)
        o = torch.einsum("bhqk,bhkd->bhqd", p, v)
        return (lambda x, *d: x.permute(*d))(o, 0, 2, 1, 3).reshape(B, S, D) @ wo

    def _B_ref(u, log_A_real, A_imag, C_real, C_imag, log_dt, D_skip):
        L = u.shape[1]
        dt = torch.exp(log_dt)
        A = -torch.exp(log_A_real) + 1j * A_imag
        C = (C_real + 1j * C_imag) * dt[:, None]
        pos = (lambda x, dt: x.to(dt))(torch.arange(L), log_dt.dtype)
        P = torch.exp((A * dt[:, None])[:, :, None] * pos[None, None, :])
        K = 2.0 * torch.einsum("dn,dnl->dl", C, P).real
        L2 = 2 * L
        u_t = (lambda x, *d: x.permute(*d))(u, 0, 2, 1)
        Kf = (lambda x, *a, **k: torch.fft.rfft(x.float(), *a, **k))(K, L2)
        Uf = (lambda x, *a, **k: torch.fft.rfft(x.float(), *a, **k))(u_t, L2)
        y = (lambda x, *a, **k: torch.fft.irfft(x, *a, **k).to(torch.bfloat16))(Uf * Kf[None, :, :], L2)[:, :, :L]
        y = (lambda x, *d: x.permute(*d))(y, 0, 2, 1)
        return y + u * D_skip[None, None, :]

    a = _A_ref(A_x, A_wqkv, A_wo)
    b = _B_ref(B_u, B_log_A_real, B_A_imag, B_C_real, B_C_imag, B_log_dt, B_D_skip)
    return torch.concatenate([a, b], axis=-1)
```

```asm
; @launch grid=(256,1,1) block=(512,1,1) lds=163840
.amdgcn_target "amdgcn-amd-amdhsa--gfx950"
.text
.globl concat_heads__mha_block__ssm_conv_s4d__prompt_kernel
.p2align 8
.type concat_heads__mha_block__ssm_conv_s4d__prompt_kernel,@function
concat_heads__mha_block__ssm_conv_s4d__prompt_kernel:
L_code_start:
    s_cmp_ge_u32 s2, 256
    s_cbranch_scc1 L_exit
    s_load_dwordx16 s[16:31], s[0:1], 0
    s_load_dwordx8 s[32:39], s[0:1], 64
    s_load_dwordx2 s[40:41], s[0:1], 96
    s_lshr_b32 s43, s2, 3
    s_getpc_b64 s[46:47]
L_g_pc:
    v_lshrrev_b32 v1, 5, v0
    v_lshlrev_b32 v1, 5, v1
    v_add_u32 v1, s43, v1
    v_lshlrev_b32 v1, 7, v1
    v_min_u32 v1, L_code_end-L_g_pc-4, v1
    s_mov_b32 exec_lo, 1
    s_mov_b32 exec_hi, 1
    global_load_dword v6, v1, s[46:47]
    s_mov_b64 exec, -1
    v_lshrrev_b32 v1, 6, v0
    v_and_b32 v0, 63, v0
    v_readfirstlane_b32 s3, v1
    s_and_b32 s42, s2, 7
    s_lshl_b32 s100, s42, 5
    s_add_u32 s100, s100, s43
    s_mov_b32 s101, 4
    v_lshlrev_b32 v7, 4, v0
    v_and_b32 v16, 15, v0
    v_lshlrev_b32 v16, 2, v16
    v_add_u32 v16, 153536, v16
    v_mov_b32 v17, 0
    ds_write_b32 v16, v17
    s_and_b32 s44, s43, 3
    s_lshl_b32 s44, s44, 2
    s_and_b32 s45, s42, 3
    s_add_u32 s44, s44, s45
    s_lshl_b32 s44, s44, 7
    s_lshr_b32 s45, s42, 2
    s_lshr_b32 s46, s43, 2
    s_lshl_b32 s46, s46, 1
    s_add_u32 s45, s45, s46
    s_lshl_b32 s45, s45, 7
    s_and_b32 s46, s3, 3
    v_lshrrev_b32 v8, 3, v0
    v_and_b32 v9, 7, v0
    v_lshrrev_b32 v10, 4, v0
    v_xor_b32 v11, v10, v9
    v_mul_u32_u24 v12, 9216, v8
    v_lshl_add_u32 v12, v11, 4, v12
    v_xor_b32 v13, 64, v12
    v_add_u32 v13, 73728, v13
    s_lshl_b32 s47, s46, 1
    s_add_u32 s47, s47, s44
    s_mul_i32 s47, s47, 1152
    v_and_b32 v9, 15, v0
    v_lshlrev_b32 v11, 1, v10
    v_xor_b32 v11, v11, v9
    v_mul_u32_u24 v14, 3456, v10
    v_lshl_add_u32 v14, v11, 4, v14
    v_xor_b32 v11, 8, v11
    v_mul_u32_u24 v15, 3456, v10
    v_lshl_add_u32 v15, v11, 4, v15
    s_cmp_ge_u32 s45, 1664
    s_cselect_b32 s48, 0x8000000, 0
    v_and_b32 v9, 8, v11
    v_mul_lo_u32 v8, v9, s48
    v_add_u32 v15, v15, v8
    v_xor_b32 v9, 8, v9
    v_mul_lo_u32 v8, v9, s48
    v_add_u32 v14, v14, v8
    s_lshr_b32 s48, s46, 1
    s_lshl_b32 s48, s48, 5
    s_and_b32 s49, s46, 1
    s_lshl_b32 s49, s49, 2
    s_add_u32 s48, s48, s49
    s_mul_i32 s48, s48, 3456
    s_lshl_b32 s49, s45, 1
    s_add_u32 s48, s48, s49
    s_lshl_b32 s50, s46, 12
    s_and_b32 s51, s43, 3
    s_mul_i32 s51, s51, 2
    s_lshr_b32 s52, s43, 2
    s_mul_i32 s52, s52, 5
    s_add_u32 s49, s51, s52
    s_mul_i32 s51, s49, 57
    s_lshr_b32 s51, s51, 9
    s_mul_i32 s51, s51, 9
    s_sub_u32 s49, s49, s51
    s_lshl_b32 s51, s49, 7
    s_add_u32 s47, s47, s51
    s_mul_i32 s51, s49, 221184
    s_add_u32 s48, s48, s51
    s_add_u32 s50, s50, 98304
    s_waitcnt lgkmcnt(0)
    s_mov_b32 s4, s40
    s_mov_b32 s5, s41
    s_mov_b32 s6, 0x1400000
    s_mov_b32 s7, 0x00020000
    s_add_u32 s40, s40, 0x12c7800
    s_addc_u32 s41, s41, 0
    s_load_dword s38, s[40:41], 0
    s_cmp_ge_u32 s43, 28
    s_cbranch_scc1 L_free
    s_cmp_lt_u32 s3, 4
    s_cbranch_scc1 L_g_compute
    s_mov_b32 s8, s16
    s_mov_b32 s9, s17
    s_mov_b32 s10, 0x240000
    s_mov_b32 s11, 0x00020000
    s_mov_b32 s12, s18
    s_mov_b32 s13, s19
    s_mov_b32 s14, 0x1e6000
    s_mov_b32 s15, 0x00020000
    s_lshl_b32 s44, s100, 1
    s_bfe_u32 s45, s3, 0x10001
    s_add_u32 s44, s44, s45
    s_lshl_b32 s45, s44, 8
    v_lshlrev_b32 v8, 2, v0
    v_add_u32 v8, s45, v8
    s_lshl_b32 s45, s44, 1
    v_mov_b32 v9, s45
    global_load_ushort v1, v9, s[32:33]
    global_load_dword v2, v8, s[24:25]
    global_load_dword v3, v8, s[26:27]
    global_load_dword v4, v8, s[28:29]
    global_load_dword v5, v8, s[30:31]
    global_load_ushort v6, v9, s[34:35]
    s_mov_b32 s39, 0
L_g_issue:
    s_add_u32 m0, s50, 16384
    s_add_u32 s52, s48, 0
    buffer_load_dwordx4 v14, s[12:15], s52 offen lds
    s_add_u32 m0, s50, 0
    s_add_u32 s51, s47, 0
    buffer_load_dwordx4 v12, s[8:11], s51 offen lds
    s_add_u32 m0, s50, 17408
    s_add_u32 s52, s48, 27648
    buffer_load_dwordx4 v15, s[12:15], s52 offen lds
    s_add_u32 m0, s50, 1024
    s_add_u32 s51, s47, 0
    buffer_load_dwordx4 v13, s[8:11], s51 offen lds
    s_add_u32 m0, s50, 18432
    s_add_u32 s52, s48, 55296
    buffer_load_dwordx4 v14, s[12:15], s52 offen lds
    s_add_u32 m0, s50, 2048
    s_add_u32 s51, s47, 1152
    buffer_load_dwordx4 v12, s[8:11], s51 offen lds
    s_add_u32 m0, s50, 19456
    s_add_u32 s52, s48, 82944
    buffer_load_dwordx4 v15, s[12:15], s52 offen lds
    s_add_u32 m0, s50, 3072
    s_add_u32 s51, s47, 1152
    buffer_load_dwordx4 v13, s[8:11], s51 offen lds
    s_add_u32 s50, s50, 32768
    s_and_b32 s50, s50, 0x1ffff
    s_add_u32 s47, s47, 128
    s_add_u32 s48, s48, 221184
    s_add_u32 s49, s49, 1
    s_cmp_eq_u32 s49, 9
    s_cselect_b32 s51, 1152, 0
    s_cselect_b32 s52, 1990656, 0
    s_sub_u32 s47, s47, s51
    s_sub_u32 s48, s48, s52
    s_add_u32 s39, s39, 1
    s_cmp_eq_u32 s39, 1
    s_cbranch_scc1 L_g_issue
    s_cmp_ge_u32 s39, 7
    s_cbranch_scc1 L_g_late
    s_cmp_eq_u32 s39, 2
    s_cbranch_scc1 L_g_pre
L_g_wb:
    s_waitcnt vmcnt(8)
    s_barrier
    s_branch L_g_issue
L_g_pre:
    s_bfe_u32 s54, s3, 0x10001
    s_and_b32 s55, s3, 1
    s_mul_i32 s56, s54, 16640
    s_lshl_b32 s57, s55, 8
    v_bfe_u32 v9, v0, 2, 2
    v_mul_u32_u24 v208, 4160, v9
    v_and_b32 v10, 3, v0
    v_lshl_add_u32 v208, v10, 3, v208
    v_and_b32 v10, 48, v0
    v_sub_u32 v208, v208, v10
    s_add_u32 s56, s56, s57
    s_add_u32 s56, s56, 76888
    v_add_u32 v208, s56, v208
    v_and_b32 v11, 15, v0
    v_lshl_add_u32 v209, v11, 5, v10
    s_mul_i32 s56, s54, 4608
    s_sub_u32 s56, s56, s57
    s_add_u32 s56, s56, 143648
    v_add_u32 v209, s56, v209
    s_and_b32 s56, s3, 3
    s_lshl_b32 s56, s56, 13
    s_add_u32 s56, s56, 110080
    v_add_u32 v210, s56, v7
    v_bfe_u32 v9, v0, 1, 4
    v_lshlrev_b32 v211, 4, v9
    v_and_b32 v9, 1, v0
    v_lshl_add_u32 v211, v9, 9, v211
    v_lshrrev_b32 v9, 5, v0
    v_lshl_add_u32 v211, v9, 10, v211
    s_lshl_b32 s56, s54, 14
    s_lshl_b32 s57, s55, 12
    s_add_u32 s56, s56, s57
    s_add_u32 s56, s56, 110080
    v_add_u32 v211, s56, v211
    v_mov_b32 v18, 0
    v_mov_b32 v19, 0
    v_lshlrev_b32 v9, 3, v0
    v_add_u32 v9, 143360, v9
    ds_write_b64 v9, v[18:19] offset:0
    ds_write_b64 v9, v[18:19] offset:4608
    s_waitcnt vmcnt(16)
    s_mov_b32 s53, 0x3fb8aa3b
    s_mov_b32 s54, 0x32a57060
    s_mov_b32 s55, 0x3f317218
    s_andn2_b32 s56, 1, s3
    s_lshl_b32 s56, s56, 4
    v_lshlrev_b32 v23, 16, v1
    v_mul_f32 v20, s53, v23
    v_exp_f32 v1, v20
    v_fma_f32 v21, v23, s53, -v20
    v_fma_f32 v21, v23, s54, v21
    v_mul_f32 v21, s55, v21
    v_fma_f32 v1, v1, v21, v1
    v_cvt_pk_bf16_f32 v1, 0, v1
    v_lshlrev_b32 v23, s56, v2
    v_and_b32 v23, 0xffff0000, v23
    v_mul_f32 v20, s53, v23
    v_exp_f32 v24, v20
    v_fma_f32 v21, v23, s53, -v20
    v_fma_f32 v21, v23, s54, v21
    v_mul_f32 v21, s55, v21
    v_fma_f32 v24, v24, v21, v24
    v_cvt_pk_bf16_f32 v24, 0, v24
    v_lshlrev_b32 v25, s56, v3
    v_and_b32 v25, 0xffff0000, v25
    v_mul_f32 v24, v24, v1
    v_mul_f32 v25, v25, v1
    v_mul_f32 v24, 0xbfb8aa3b, v24
    v_mul_f32 v25, 0.15915494, v25
    v_mul_f32 v20, 0x3f800000, v25
    v_mul_f32 v21, 0x3f800000, v24
    v_fract_f32 v20, v20
    v_exp_f32 v21, v21
    v_cos_f32 v26, v20
    v_sin_f32 v27, v20
    v_mul_f32 v26, v26, v21
    v_mul_f32 v27, v27, v21
    v_mul_f32 v20, 0x41000000, v25
    v_mul_f32 v21, 0x41000000, v24
    v_fract_f32 v20, v20
    v_exp_f32 v21, v21
    v_cos_f32 v28, v20
    v_sin_f32 v29, v20
    v_mul_f32 v28, v28, v21
    v_mul_f32 v29, v29, v21
    v_mul_f32 v20, 0x42800000, v25
    v_mul_f32 v21, 0x42800000, v24
    v_fract_f32 v20, v20
    v_exp_f32 v21, v21
    v_cos_f32 v30, v20
    v_sin_f32 v31, v20
    v_mul_f32 v30, v30, v21
    v_mul_f32 v31, v31, v21
    v_mul_f32 v20, 0x43800000, v25
    v_mul_f32 v21, 0x43800000, v24
    v_fract_f32 v20, v20
    v_exp_f32 v21, v21
    v_cos_f32 v32, v20
    v_sin_f32 v33, v20
    v_mul_f32 v32, v32, v21
    v_mul_f32 v33, v33, v21
    v_mov_b32 v64, 0x3c00
    v_pk_mul_f32 v[42:43], v[30:31], v[30:31] op_sel:[0,0] op_sel_hi:[0,1]
    v_pk_fma_f32 v[42:43], v[30:31], v[30:31], v[42:43] op_sel:[1,1,0] op_sel_hi:[1,0,1] neg_lo:[1,0,0]
    v_cvt_pk_f16_f32 v65, v28, v29
    v_pk_mul_f32 v[46:47], v[42:43], v[30:31] op_sel:[0,0] op_sel_hi:[0,1]
    v_pk_fma_f32 v[46:47], v[42:43], v[30:31], v[46:47] op_sel:[1,1,0] op_sel_hi:[1,0,1] neg_lo:[1,0,0]
    v_cvt_pk_f16_f32 v66, v30, v31
    v_cvt_pk_f16_f32 v67, v42, v43
    v_cvt_pk_f16_f32 v68, v46, v47
    v_pk_mul_f32 v[34:35], v[28:29], v[28:29] op_sel:[0,0] op_sel_hi:[0,1]
    v_pk_fma_f32 v[34:35], v[28:29], v[28:29], v[34:35] op_sel:[1,1,0] op_sel_hi:[1,0,1] neg_lo:[1,0,0]
    v_cvt_pk_f16_f32 v69, v34, v35
    v_pk_mul_f32 v[38:39], v[30:31], v[28:29] op_sel:[0,0] op_sel_hi:[0,1]
    v_pk_fma_f32 v[38:39], v[30:31], v[28:29], v[38:39] op_sel:[1,1,0] op_sel_hi:[1,0,1] neg_lo:[1,0,0]
    v_cvt_pk_f16_f32 v70, v38, v39
    v_pk_mul_f32 v[44:45], v[42:43], v[28:29] op_sel:[0,0] op_sel_hi:[0,1]
    v_pk_fma_f32 v[44:45], v[42:43], v[28:29], v[44:45] op_sel:[1,1,0] op_sel_hi:[1,0,1] neg_lo:[1,0,0]
    v_cvt_pk_f16_f32 v71, v44, v45
    v_pk_mul_f32 v[48:49], v[46:47], v[28:29] op_sel:[0,0] op_sel_hi:[0,1]
    v_pk_fma_f32 v[48:49], v[46:47], v[28:29], v[48:49] op_sel:[1,1,0] op_sel_hi:[1,0,1] neg_lo:[1,0,0]
    v_cvt_pk_f16_f32 v72, v48, v49
    v_pk_mul_f32 v[36:37], v[34:35], v[28:29] op_sel:[0,0] op_sel_hi:[0,1]
    v_pk_fma_f32 v[36:37], v[34:35], v[28:29], v[36:37] op_sel:[1,1,0] op_sel_hi:[1,0,1] neg_lo:[1,0,0]
    v_cvt_pk_f16_f32 v73, v36, v37
    v_pk_mul_f32 v[40:41], v[38:39], v[28:29] op_sel:[0,0] op_sel_hi:[0,1]
    v_pk_fma_f32 v[40:41], v[38:39], v[28:29], v[40:41] op_sel:[1,1,0] op_sel_hi:[1,0,1] neg_lo:[1,0,0]
    v_cvt_pk_f16_f32 v74, v40, v41
    v_pk_mul_f32 v[42:43], v[44:45], v[28:29] op_sel:[0,0] op_sel_hi:[0,1]
    v_pk_fma_f32 v[42:43], v[44:45], v[28:29], v[42:43] op_sel:[1,1,0] op_sel_hi:[1,0,1] neg_lo:[1,0,0]
    v_cvt_pk_f16_f32 v75, v42, v43
    s_branch L_g_wb
L_g_compute:
    s_mov_b32 s8, s22
    s_mov_b32 s9, s23
    s_mov_b32 s10, 0x240000
    s_mov_b32 s11, 0x00020000
    s_andn2_b32 s53, s2, 3
    s_add_u32 s53, s53, s3
    s_and_b32 s54, s2, 3
    s_mul_i32 s55, s53, 9216
    s_mul_i32 s56, s54, 288
    s_add_u32 s55, s55, s56
    s_mul_i32 s57, s3, 3072
    v_add_u32 v16, 0, v0
    v_mul_u32_u24 v17, 3641, v16
    v_lshrrev_b32 v17, 16, v17
    v_mul_u32_u24 v18, 864, v17
    v_lshl_add_u32 v18, v16, 4, v18
    s_add_u32 m0, s57, 131072
    s_nop 0
    buffer_load_dwordx4 v18, s[8:11], s55 offen lds
    v_add_u32 v16, 64, v0
    v_mul_u32_u24 v17, 3641, v16
    v_lshrrev_b32 v17, 16, v17
    v_mul_u32_u24 v18, 864, v17
    v_lshl_add_u32 v18, v16, 4, v18
    s_add_u32 m0, s57, 132096
    s_nop 0
    buffer_load_dwordx4 v18, s[8:11], s55 offen lds
    v_add_u32 v16, 128, v0
    v_mul_u32_u24 v17, 3641, v16
    v_lshrrev_b32 v17, 16, v17
    v_mul_u32_u24 v18, 864, v17
    v_lshl_add_u32 v18, v16, 4, v18
    s_add_u32 m0, s57, 133120
    s_mov_b64 exec, 0xffff
    buffer_load_dwordx4 v18, s[8:11], s55 offen lds
    s_mov_b64 exec, -1
    s_setprio 1
    v_and_b32 v16, 15, v0
    v_lshrrev_b32 v17, 4, v0
    v_bfe_u32 v18, v0, 1, 3
    v_xor_b32 v18, v18, v17
    v_lshlrev_b32 v19, 7, v16
    v_lshl_add_u32 v8, v18, 4, v19
    v_add_u32 v8, 98304, v8
    v_xor_b32 v9, 64, v8
    v_lshlrev_b32 v12, 14, v17
    v_lshl_add_u32 v12, v16, 4, v12
    v_lshrrev_b32 v18, 2, v0
    v_and_b32 v19, 7, v18
    s_lshl_b32 s46, s3, 1
    v_xor_b32 v19, s46, v19
    v_lshlrev_b32 v18, 8, v18
    v_lshl_add_u32 v18, v19, 5, v18
    v_and_b32 v19, 3, v0
    v_lshl_add_u32 v18, v19, 3, v18
    v_add_u32 v10, 114688, v18
    v_xor_b32 v11, 32, v10
    s_lshl_b32 s46, s3, 5
    s_add_u32 s46, s46, s45
    s_lshl_b32 s47, s46, 12
    s_lshl_b32 s48, s44, 1
    s_add_u32 s47, s47, s48
    v_mov_b64 v[100:101], 0
    v_mov_b64 v[102:103], 0
    v_mov_b64 v[104:105], 0
    v_mov_b64 v[106:107], 0
    v_mov_b64 v[108:109], 0
    v_mov_b64 v[110:111], 0
    v_mov_b64 v[112:113], 0
    v_mov_b64 v[114:115], 0
    v_mov_b64 v[116:117], 0
    v_mov_b64 v[118:119], 0
    v_mov_b64 v[120:121], 0
    v_mov_b64 v[122:123], 0
    v_mov_b64 v[124:125], 0
    v_mov_b64 v[126:127], 0
    v_mov_b64 v[128:129], 0
    v_mov_b64 v[130:131], 0
    v_mov_b64 v[132:133], 0
    v_mov_b64 v[134:135], 0
    v_mov_b64 v[136:137], 0
    v_mov_b64 v[138:139], 0
    v_mov_b64 v[140:141], 0
    v_mov_b64 v[142:143], 0
    v_mov_b64 v[144:145], 0
    v_mov_b64 v[146:147], 0
    v_mov_b64 v[148:149], 0
    v_mov_b64 v[150:151], 0
    v_mov_b64 v[152:153], 0
    v_mov_b64 v[154:155], 0
    v_mov_b64 v[156:157], 0
    v_mov_b64 v[158:159], 0
    v_mov_b64 v[160:161], 0
    v_mov_b64 v[162:163], 0
    v_bfe_u32 v164, v0, 2, 2
    v_mul_u32_u24 v164, 288, v164
    v_and_b32 v165, 3, v0
    v_lshl_add_u32 v164, v165, 3, v164
    v_and_b32 v165, 48, v0
    v_lshl_add_u32 v164, v165, 1, v164
    s_and_b32 s54, s3, 3
    s_mul_i32 s55, s54, 3072
    s_add_u32 s55, s55, 131072
    v_add_u32 v164, s55, v164
    s_andn2_b32 s61, s2, 3
    s_add_u32 s61, s61, s54
    s_mul_i32 s61, s61, 9216
    s_and_b32 s54, s2, 3
    s_mul_i32 s54, s54, 2304
    s_add_u32 s61, s61, s54
    s_add_u32 s61, s61, 0xd00000
    s_mov_b32 s49, 0
    s_mov_b32 s50, 3
    s_barrier
    ds_read_b64_tr_b16 v[84:85], v10 offset:0
    ds_read_b64_tr_b16 v[86:87], v10 offset:4096
    ds_read_b64_tr_b16 v[88:89], v11 offset:0
    ds_read_b64_tr_b16 v[90:91], v11 offset:4096
    ds_read_b128 v[20:23], v8 offset:0
    ds_read_b128 v[24:27], v8 offset:2048
    ds_read_b128 v[28:31], v8 offset:4096
    ds_read_b128 v[32:35], v8 offset:6144
    ds_read_b128 v[36:39], v8 offset:8192
    ds_read_b128 v[40:43], v8 offset:10240
    ds_read_b128 v[44:47], v8 offset:12288
    ds_read_b128 v[48:51], v8 offset:14336
    s_waitcnt lgkmcnt(0)
    v_mfma_f32_16x16x32_bf16 v[100:103], v[84:87], v[20:23], v[100:103]
    ds_read_b64_tr_b16 v[92:93], v10 offset:8192
    v_mfma_f32_16x16x32_bf16 v[132:135], v[88:91], v[20:23], v[132:135]
    ds_read_b64_tr_b16 v[94:95], v10 offset:12288
    v_mfma_f32_16x16x32_bf16 v[104:107], v[84:87], v[24:27], v[104:107]
    ds_read_b64_tr_b16 v[96:97], v11 offset:8192
    v_mfma_f32_16x16x32_bf16 v[136:139], v[88:91], v[24:27], v[136:139]
    ds_read_b64_tr_b16 v[98:99], v11 offset:12288
    v_mfma_f32_16x16x32_bf16 v[108:111], v[84:87], v[28:31], v[108:111]
    ds_read_b128 v[52:55], v9 offset:0
    v_mfma_f32_16x16x32_bf16 v[140:143], v[88:91], v[28:31], v[140:143]
    ds_read_b128 v[56:59], v9 offset:2048
    v_mfma_f32_16x16x32_bf16 v[112:115], v[84:87], v[32:35], v[112:115]
    ds_read_b128 v[60:63], v9 offset:4096
    v_mfma_f32_16x16x32_bf16 v[144:147], v[88:91], v[32:35], v[144:147]
    ds_read_b128 v[64:67], v9 offset:6144
    v_mfma_f32_16x16x32_bf16 v[116:119], v[84:87], v[36:39], v[116:119]
    ds_read_b128 v[68:71], v9 offset:8192
    v_mfma_f32_16x16x32_bf16 v[148:151], v[88:91], v[36:39], v[148:151]
    ds_read_b128 v[72:75], v9 offset:10240
    v_mfma_f32_16x16x32_bf16 v[120:123], v[84:87], v[40:43], v[120:123]
    ds_read_b128 v[76:79], v9 offset:12288
    v_mfma_f32_16x16x32_bf16 v[152:155], v[88:91], v[40:43], v[152:155]
    ds_read_b128 v[80:83], v9 offset:14336
    v_mfma_f32_16x16x32_bf16 v[124:127], v[84:87], v[44:47], v[124:127]
    v_add_u32 v8, 0xfffe8000, v8
    v_mfma_f32_16x16x32_bf16 v[156:159], v[88:91], v[44:47], v[156:159]
    v_add_u32 v10, 0xfffe8000, v10
    v_mfma_f32_16x16x32_bf16 v[128:131], v[84:87], v[48:51], v[128:131]
    v_add_u32 v11, 0xfffe8000, v11
    v_mfma_f32_16x16x32_bf16 v[160:163], v[88:91], v[48:51], v[160:163]
    v_add_u32 v9, 0xfffe8000, v9
    s_waitcnt vmcnt(0) lgkmcnt(0)
    s_barrier
    s_mul_i32 s38, s38, 0x2c9277b5
    s_add_u32 s38, s38, 0xac564b05
    v_mfma_f32_16x16x32_bf16 v[100:103], v[92:95], v[52:55], v[100:103]
    ds_read_b64_tr_b16 v[84:85], v10 offset:0
    v_mfma_f32_16x16x32_bf16 v[132:135], v[96:99], v[52:55], v[132:135]
    ds_read_b64_tr_b16 v[86:87], v10 offset:4096
    v_mfma_f32_16x16x32_bf16 v[104:107], v[92:95], v[56:59], v[104:107]
    ds_read_b64_tr_b16 v[88:89], v11 offset:0
    v_mfma_f32_16x16x32_bf16 v[136:139], v[96:99], v[56:59], v[136:139]
    ds_read_b64_tr_b16 v[90:91], v11 offset:4096
    v_mfma_f32_16x16x32_bf16 v[108:111], v[92:95], v[60:63], v[108:111]
    ds_read_b128 v[20:23], v8 offset:0
    v_mfma_f32_16x16x32_bf16 v[140:143], v[96:99], v[60:63], v[140:143]
    ds_read_b128 v[24:27], v8 offset:2048
    v_mfma_f32_16x16x32_bf16 v[112:115], v[92:95], v[64:67], v[112:115]
    ds_read_b128 v[28:31], v8 offset:4096
    v_mfma_f32_16x16x32_bf16 v[144:147], v[96:99], v[64:67], v[144:147]
    ds_read_b128 v[32:35], v8 offset:6144
    v_mfma_f32_16x16x32_bf16 v[116:119], v[92:95], v[68:71], v[116:119]
    ds_read_b128 v[36:39], v8 offset:8192
    v_mfma_f32_16x16x32_bf16 v[148:151], v[96:99], v[68:71], v[148:151]
    ds_read_b128 v[40:43], v8 offset:10240
    v_mfma_f32_16x16x32_bf16 v[120:123], v[92:95], v[72:75], v[120:123]
    ds_read_b128 v[44:47], v8 offset:12288
    v_mfma_f32_16x16x32_bf16 v[152:155], v[96:99], v[72:75], v[152:155]
    ds_read_b128 v[48:51], v8 offset:14336
    v_mfma_f32_16x16x32_bf16 v[124:127], v[92:95], v[76:79], v[124:127]
    ds_read_b64_tr_b16 v[168:169], v164 offset:0
    ds_read_b64_tr_b16 v[170:171], v164 offset:1152
    v_mfma_f32_16x16x32_bf16 v[156:159], v[96:99], v[76:79], v[156:159]
    ds_read_b64_tr_b16 v[172:173], v164 offset:128
    ds_read_b64_tr_b16 v[174:175], v164 offset:1280
    v_mfma_f32_16x16x32_bf16 v[128:131], v[92:95], v[80:83], v[128:131]
    ds_read_b64_tr_b16 v[176:177], v164 offset:256
    ds_read_b64_tr_b16 v[178:179], v164 offset:1408
    v_mfma_f32_16x16x32_bf16 v[160:163], v[96:99], v[80:83], v[160:163]
    s_waitcnt lgkmcnt(0)
    v_mfma_f32_16x16x32_bf16 v[100:103], v[84:87], v[20:23], v[100:103]
    ds_read_b64_tr_b16 v[92:93], v10 offset:8192
    v_mfma_f32_16x16x32_bf16 v[132:135], v[88:91], v[20:23], v[132:135]
    ds_read_b64_tr_b16 v[94:95], v10 offset:12288
    v_mfma_f32_16x16x32_bf16 v[104:107], v[84:87], v[24:27], v[104:107]
    ds_read_b64_tr_b16 v[96:97], v11 offset:8192
    v_mfma_f32_16x16x32_bf16 v[136:139], v[88:91], v[24:27], v[136:139]
    ds_read_b64_tr_b16 v[98:99], v11 offset:12288
    v_mfma_f32_16x16x32_bf16 v[108:111], v[84:87], v[28:31], v[108:111]
    ds_read_b128 v[52:55], v9 offset:0
    v_mfma_f32_16x16x32_bf16 v[140:143], v[88:91], v[28:31], v[140:143]
    ds_read_b128 v[56:59], v9 offset:2048
    v_mfma_f32_16x16x32_bf16 v[112:115], v[84:87], v[32:35], v[112:115]
    ds_read_b128 v[60:63], v9 offset:4096
    v_mfma_f32_16x16x32_bf16 v[144:147], v[88:91], v[32:35], v[144:147]
    ds_read_b128 v[64:67], v9 offset:6144
    v_mfma_f32_16x16x32_bf16 v[116:119], v[84:87], v[36:39], v[116:119]
    ds_read_b128 v[68:71], v9 offset:8192
    v_mfma_f32_16x16x32_bf16 v[148:151], v[88:91], v[36:39], v[148:151]
    ds_read_b128 v[72:75], v9 offset:10240
    v_mfma_f32_16x16x32_bf16 v[120:123], v[84:87], v[40:43], v[120:123]
    ds_read_b128 v[76:79], v9 offset:12288
    v_mfma_f32_16x16x32_bf16 v[152:155], v[88:91], v[40:43], v[152:155]
    ds_read_b128 v[80:83], v9 offset:14336
    v_mfma_f32_16x16x32_bf16 v[124:127], v[84:87], v[44:47], v[124:127]
    v_add_u32 v8, 0x8000, v8
    v_mfma_f32_16x16x32_bf16 v[156:159], v[88:91], v[44:47], v[156:159]
    v_add_u32 v10, 0x8000, v10
    v_mfma_f32_16x16x32_bf16 v[128:131], v[84:87], v[48:51], v[128:131]
    v_add_u32 v11, 0x8000, v11
    v_mfma_f32_16x16x32_bf16 v[160:163], v[88:91], v[48:51], v[160:163]
    v_add_u32 v9, 0x8000, v9
    buffer_store_dwordx4 v[168:171], v7, s[4:7], s61 offen sc1
    buffer_store_dwordx4 v[172:175], v7, s[4:7], s61 offen offset:1024 sc1
    s_mov_b64 exec, 0xffff
    buffer_store_dwordx4 v[176:179], v7, s[4:7], s61 offen offset:2048 sc1
    s_mov_b64 exec, -1
    s_waitcnt lgkmcnt(0)
    s_barrier
    v_mfma_f32_16x16x32_bf16 v[100:103], v[92:95], v[52:55], v[100:103]
    ds_read_b64_tr_b16 v[84:85], v10 offset:0
    v_mfma_f32_16x16x32_bf16 v[132:135], v[96:99], v[52:55], v[132:135]
    ds_read_b64_tr_b16 v[86:87], v10 offset:4096
    v_mfma_f32_16x16x32_bf16 v[104:107], v[92:95], v[56:59], v[104:107]
    ds_read_b64_tr_b16 v[88:89], v11 offset:0
    v_mfma_f32_16x16x32_bf16 v[136:139], v[96:99], v[56:59], v[136:139]
    ds_read_b64_tr_b16 v[90:91], v11 offset:4096
    v_mfma_f32_16x16x32_bf16 v[108:111], v[92:95], v[60:63], v[108:111]
    ds_read_b128 v[20:23], v8 offset:0
    v_mfma_f32_16x16x32_bf16 v[140:143], v[96:99], v[60:63], v[140:143]
    ds_read_b128 v[24:27], v8 offset:2048
    v_mfma_f32_16x16x32_bf16 v[112:115], v[92:95], v[64:67], v[112:115]
    ds_read_b128 v[28:31], v8 offset:4096
    v_mfma_f32_16x16x32_bf16 v[144:147], v[96:99], v[64:67], v[144:147]
    ds_read_b128 v[32:35], v8 offset:6144
    v_mfma_f32_16x16x32_bf16 v[116:119], v[92:95], v[68:71], v[116:119]
    ds_read_b128 v[36:39], v8 offset:8192
    v_mfma_f32_16x16x32_bf16 v[148:151], v[96:99], v[68:71], v[148:151]
    ds_read_b128 v[40:43], v8 offset:10240
    v_mfma_f32_16x16x32_bf16 v[120:123], v[92:95], v[72:75], v[120:123]
    ds_read_b128 v[44:47], v8 offset:12288
    v_mfma_f32_16x16x32_bf16 v[152:155], v[96:99], v[72:75], v[152:155]
    ds_read_b128 v[48:51], v8 offset:14336
    v_mfma_f32_16x16x32_bf16 v[124:127], v[92:95], v[76:79], v[124:127]
    v_mfma_f32_16x16x32_bf16 v[156:159], v[96:99], v[76:79], v[156:159]
    v_mfma_f32_16x16x32_bf16 v[128:131], v[92:95], v[80:83], v[128:131]
    v_mfma_f32_16x16x32_bf16 v[160:163], v[96:99], v[80:83], v[160:163]
    s_waitcnt lgkmcnt(0)
    v_mfma_f32_16x16x32_bf16 v[100:103], v[84:87], v[20:23], v[100:103]
    ds_read_b64_tr_b16 v[92:93], v10 offset:8192
    v_mfma_f32_16x16x32_bf16 v[132:135], v[88:91], v[20:23], v[132:135]
    ds_read_b64_tr_b16 v[94:95], v10 offset:12288
    v_mfma_f32_16x16x32_bf16 v[104:107], v[84:87], v[24:27], v[104:107]
    ds_read_b64_tr_b16 v[96:97], v11 offset:8192
    v_mfma_f32_16x16x32_bf16 v[136:139], v[88:91], v[24:27], v[136:139]
    ds_read_b64_tr_b16 v[98:99], v11 offset:12288
    v_mfma_f32_16x16x32_bf16 v[108:111], v[84:87], v[28:31], v[108:111]
    ds_read_b128 v[52:55], v9 offset:0
    v_mfma_f32_16x16x32_bf16 v[140:143], v[88:91], v[28:31], v[140:143]
    ds_read_b128 v[56:59], v9 offset:2048
    v_mfma_f32_16x16x32_bf16 v[112:115], v[84:87], v[32:35], v[112:115]
    ds_read_b128 v[60:63], v9 offset:4096
    v_mfma_f32_16x16x32_bf16 v[144:147], v[88:91], v[32:35], v[144:147]
    ds_read_b128 v[64:67], v9 offset:6144
    v_mfma_f32_16x16x32_bf16 v[116:119], v[84:87], v[36:39], v[116:119]
    ds_read_b128 v[68:71], v9 offset:8192
    v_mfma_f32_16x16x32_bf16 v[148:151], v[88:91], v[36:39], v[148:151]
    ds_read_b128 v[72:75], v9 offset:10240
    v_mfma_f32_16x16x32_bf16 v[120:123], v[84:87], v[40:43], v[120:123]
    ds_read_b128 v[76:79], v9 offset:12288
    v_mfma_f32_16x16x32_bf16 v[152:155], v[88:91], v[40:43], v[152:155]
    ds_read_b128 v[80:83], v9 offset:14336
    v_mfma_f32_16x16x32_bf16 v[124:127], v[84:87], v[44:47], v[124:127]
    v_add_u32 v8, 0x8000, v8
    v_mfma_f32_16x16x32_bf16 v[156:159], v[88:91], v[44:47], v[156:159]
    v_add_u32 v10, 0x8000, v10
    v_mfma_f32_16x16x32_bf16 v[128:131], v[84:87], v[48:51], v[128:131]
    v_add_u32 v11, 0x8000, v11
    v_mfma_f32_16x16x32_bf16 v[160:163], v[88:91], v[48:51], v[160:163]
    v_add_u32 v9, 0x8000, v9
    s_waitcnt vmcnt(0) lgkmcnt(0)
    s_barrier
    v_mfma_f32_16x16x32_bf16 v[100:103], v[92:95], v[52:55], v[100:103]
    ds_read_b64_tr_b16 v[84:85], v10 offset:0
    v_mfma_f32_16x16x32_bf16 v[132:135], v[96:99], v[52:55], v[132:135]
    ds_read_b64_tr_b16 v[86:87], v10 offset:4096
    v_mfma_f32_16x16x32_bf16 v[104:107], v[92:95], v[56:59], v[104:107]
    ds_read_b64_tr_b16 v[88:89], v11 offset:0
    v_mfma_f32_16x16x32_bf16 v[136:139], v[96:99], v[56:59], v[136:139]
    ds_read_b64_tr_b16 v[90:91], v11 offset:4096
    v_mfma_f32_16x16x32_bf16 v[108:111], v[92:95], v[60:63], v[108:111]
    ds_read_b128 v[20:23], v8 offset:0
    v_mfma_f32_16x16x32_bf16 v[140:143], v[96:99], v[60:63], v[140:143]
    ds_read_b128 v[24:27], v8 offset:2048
    v_mfma_f32_16x16x32_bf16 v[112:115], v[92:95], v[64:67], v[112:115]
    ds_read_b128 v[28:31], v8 offset:4096
    v_mfma_f32_16x16x32_bf16 v[144:147], v[96:99], v[64:67], v[144:147]
    ds_read_b128 v[32:35], v8 offset:6144
    v_mfma_f32_16x16x32_bf16 v[116:119], v[92:95], v[68:71], v[116:119]
    ds_read_b128 v[36:39], v8 offset:8192
    v_mfma_f32_16x16x32_bf16 v[148:151], v[96:99], v[68:71], v[148:151]
    ds_read_b128 v[40:43], v8 offset:10240
    v_mfma_f32_16x16x32_bf16 v[120:123], v[92:95], v[72:75], v[120:123]
    ds_read_b128 v[44:47], v8 offset:12288
    v_mfma_f32_16x16x32_bf16 v[152:155], v[96:99], v[72:75], v[152:155]
    ds_read_b128 v[48:51], v8 offset:14336
    v_mfma_f32_16x16x32_bf16 v[124:127], v[92:95], v[76:79], v[124:127]
    s_lshl_b32 s60, s2, 7
    s_add_u32 s60, s60, 0x12c8000
    s_cmp_eq_u32 s3, 0
    s_cselect_b32 s60, s60, 0x40000000
    v_mov_b32 v165, s38
    s_mov_b64 exec, 1
    buffer_store_dword v165, off, s[4:7], s60 sc1
    s_mov_b64 exec, -1
    v_mfma_f32_16x16x32_bf16 v[156:159], v[96:99], v[76:79], v[156:159]
    v_mfma_f32_16x16x32_bf16 v[128:131], v[92:95], v[80:83], v[128:131]
    v_mfma_f32_16x16x32_bf16 v[160:163], v[96:99], v[80:83], v[160:163]
    s_waitcnt lgkmcnt(0)
    v_mfma_f32_16x16x32_bf16 v[100:103], v[84:87], v[20:23], v[100:103]
    ds_read_b64_tr_b16 v[92:93], v10 offset:8192
    v_mfma_f32_16x16x32_bf16 v[132:135], v[88:91], v[20:23], v[132:135]
    ds_read_b64_tr_b16 v[94:95], v10 offset:12288
    v_mfma_f32_16x16x32_bf16 v[104:107], v[84:87], v[24:27], v[104:107]
    ds_read_b64_tr_b16 v[96:97], v11 offset:8192
    v_mfma_f32_16x16x32_bf16 v[136:139], v[88:91], v[24:27], v[136:139]
    ds_read_b64_tr_b16 v[98:99], v11 offset:12288
    v_mfma_f32_16x16x32_bf16 v[108:111], v[84:87], v[28:31], v[108:111]
    ds_read_b128 v[52:55], v9 offset:0
    v_mfma_f32_16x16x32_bf16 v[140:143], v[88:91], v[28:31], v[140:143]
    ds_read_b128 v[56:59], v9 offset:2048
    v_mfma_f32_16x16x32_bf16 v[112:115], v[84:87], v[32:35], v[112:115]
    ds_read_b128 v[60:63], v9 offset:4096
    v_mfma_f32_16x16x32_bf16 v[144:147], v[88:91], v[32:35], v[144:147]
    ds_read_b128 v[64:67], v9 offset:6144
    v_mfma_f32_16x16x32_bf16 v[116:119], v[84:87], v[36:39], v[116:119]
    ds_read_b128 v[68:71], v9 offset:8192
    v_mfma_f32_16x16x32_bf16 v[148:151], v[88:91], v[36:39], v[148:151]
    ds_read_b128 v[72:75], v9 offset:10240
    v_mfma_f32_16x16x32_bf16 v[120:123], v[84:87], v[40:43], v[120:123]
    ds_read_b128 v[76:79], v9 offset:12288
    v_mfma_f32_16x16x32_bf16 v[152:155], v[88:91], v[40:43], v[152:155]
    ds_read_b128 v[80:83], v9 offset:14336
    v_mfma_f32_16x16x32_bf16 v[124:127], v[84:87], v[44:47], v[124:127]
    v_add_u32 v8, 0x8000, v8
    v_mfma_f32_16x16x32_bf16 v[156:159], v[88:91], v[44:47], v[156:159]
    v_add_u32 v10, 0x8000, v10
    v_mfma_f32_16x16x32_bf16 v[128:131], v[84:87], v[48:51], v[128:131]
    v_add_u32 v11, 0x8000, v11
    v_mfma_f32_16x16x32_bf16 v[160:163], v[88:91], v[48:51], v[160:163]
    v_add_u32 v9, 0x8000, v9
    s_waitcnt lgkmcnt(0)
    s_barrier
    v_mfma_f32_16x16x32_bf16 v[100:103], v[92:95], v[52:55], v[100:103]
    ds_read_b64_tr_b16 v[84:85], v10 offset:0
    v_mfma_f32_16x16x32_bf16 v[132:135], v[96:99], v[52:55], v[132:135]
    ds_read_b64_tr_b16 v[86:87], v10 offset:4096
    v_mfma_f32_16x16x32_bf16 v[104:107], v[92:95], v[56:59], v[104:107]
    ds_read_b64_tr_b16 v[88:89], v11 offset:0
    v_mfma_f32_16x16x32_bf16 v[136:139], v[96:99], v[56:59], v[136:139]
    ds_read_b64_tr_b16 v[90:91], v11 offset:4096
    v_mfma_f32_16x16x32_bf16 v[108:111], v[92:95], v[60:63], v[108:111]
    ds_read_b128 v[20:23], v8 offset:0
    v_mfma_f32_16x16x32_bf16 v[140:143], v[96:99], v[60:63], v[140:143]
    ds_read_b128 v[24:27], v8 offset:2048
    v_mfma_f32_16x16x32_bf16 v[112:115], v[92:95], v[64:67], v[112:115]
    ds_read_b128 v[28:31], v8 offset:4096
    v_mfma_f32_16x16x32_bf16 v[144:147], v[96:99], v[64:67], v[144:147]
    ds_read_b128 v[32:35], v8 offset:6144
    v_mfma_f32_16x16x32_bf16 v[116:119], v[92:95], v[68:71], v[116:119]
    ds_read_b128 v[36:39], v8 offset:8192
    v_mfma_f32_16x16x32_bf16 v[148:151], v[96:99], v[68:71], v[148:151]
    ds_read_b128 v[40:43], v8 offset:10240
    v_mfma_f32_16x16x32_bf16 v[120:123], v[92:95], v[72:75], v[120:123]
    ds_read_b128 v[44:47], v8 offset:12288
    v_mfma_f32_16x16x32_bf16 v[152:155], v[96:99], v[72:75], v[152:155]
    ds_read_b128 v[48:51], v8 offset:14336
    v_mfma_f32_16x16x32_bf16 v[124:127], v[92:95], v[76:79], v[124:127]
    v_mfma_f32_16x16x32_bf16 v[156:159], v[96:99], v[76:79], v[156:159]
    v_mfma_f32_16x16x32_bf16 v[128:131], v[92:95], v[80:83], v[128:131]
    v_mfma_f32_16x16x32_bf16 v[160:163], v[96:99], v[80:83], v[160:163]
    s_waitcnt lgkmcnt(0)
    v_mfma_f32_16x16x32_bf16 v[100:103], v[84:87], v[20:23], v[100:103]
    ds_read_b64_tr_b16 v[92:93], v10 offset:8192
    v_mfma_f32_16x16x32_bf16 v[132:135], v[88:91], v[20:23], v[132:135]
    ds_read_b64_tr_b16 v[94:95], v10 offset:12288
    v_mfma_f32_16x16x32_bf16 v[104:107], v[84:87], v[24:27], v[104:107]
    ds_read_b64_tr_b16 v[96:97], v11 offset:8192
    v_mfma_f32_16x16x32_bf16 v[136:139], v[88:91], v[24:27], v[136:139]
    ds_read_b64_tr_b16 v[98:99], v11 offset:12288
    v_mfma_f32_16x16x32_bf16 v[108:111], v[84:87], v[28:31], v[108:111]
    ds_read_b128 v[52:55], v9 offset:0
    v_mfma_f32_16x16x32_bf16 v[140:143], v[88:91], v[28:31], v[140:143]
    ds_read_b128 v[56:59], v9 offset:2048
    v_mfma_f32_16x16x32_bf16 v[112:115], v[84:87], v[32:35], v[112:115]
    ds_read_b128 v[60:63], v9 offset:4096
    v_mfma_f32_16x16x32_bf16 v[144:147], v[88:91], v[32:35], v[144:147]
    ds_read_b128 v[64:67], v9 offset:6144
    v_mfma_f32_16x16x32_bf16 v[116:119], v[84:87], v[36:39], v[116:119]
    ds_read_b128 v[68:71], v9 offset:8192
    v_mfma_f32_16x16x32_bf16 v[148:151], v[88:91], v[36:39], v[148:151]
    ds_read_b128 v[72:75], v9 offset:10240
    v_mfma_f32_16x16x32_bf16 v[120:123], v[84:87], v[40:43], v[120:123]
    ds_read_b128 v[76:79], v9 offset:12288
    v_mfma_f32_16x16x32_bf16 v[152:155], v[88:91], v[40:43], v[152:155]
    ds_read_b128 v[80:83], v9 offset:14336
    v_mfma_f32_16x16x32_bf16 v[124:127], v[84:87], v[44:47], v[124:127]
    v_add_u32 v8, 0xfffe8000, v8
    v_mfma_f32_16x16x32_bf16 v[156:159], v[88:91], v[44:47], v[156:159]
    v_add_u32 v10, 0xfffe8000, v10
    v_mfma_f32_16x16x32_bf16 v[128:131], v[84:87], v[48:51], v[128:131]
    v_add_u32 v11, 0xfffe8000, v11
    v_mfma_f32_16x16x32_bf16 v[160:163], v[88:91], v[48:51], v[160:163]
    v_add_u32 v9, 0xfffe8000, v9
    s_waitcnt lgkmcnt(0)
    s_barrier
    v_mfma_f32_16x16x32_bf16 v[100:103], v[92:95], v[52:55], v[100:103]
    ds_read_b64_tr_b16 v[84:85], v10 offset:0
    v_mfma_f32_16x16x32_bf16 v[132:135], v[96:99], v[52:55], v[132:135]
    ds_read_b64_tr_b16 v[86:87], v10 offset:4096
    v_mfma_f32_16x16x32_bf16 v[104:107], v[92:95], v[56:59], v[104:107]
    ds_read_b64_tr_b16 v[88:89], v11 offset:0
    v_mfma_f32_16x16x32_bf16 v[136:139], v[96:99], v[56:59], v[136:139]
    ds_read_b64_tr_b16 v[90:91], v11 offset:4096
    v_mfma_f32_16x16x32_bf16 v[108:111], v[92:95], v[60:63], v[108:111]
    ds_read_b128 v[20:23], v8 offset:0
    v_mfma_f32_16x16x32_bf16 v[140:143], v[96:99], v[60:63], v[140:143]
    ds_read_b128 v[24:27], v8 offset:2048
    v_mfma_f32_16x16x32_bf16 v[112:115], v[92:95], v[64:67], v[112:115]
    ds_read_b128 v[28:31], v8 offset:4096
    v_mfma_f32_16x16x32_bf16 v[144:147], v[96:99], v[64:67], v[144:147]
    ds_read_b128 v[32:35], v8 offset:6144
    v_mfma_f32_16x16x32_bf16 v[116:119], v[92:95], v[68:71], v[116:119]
    ds_read_b128 v[36:39], v8 offset:8192
    v_mfma_f32_16x16x32_bf16 v[148:151], v[96:99], v[68:71], v[148:151]
    ds_read_b128 v[40:43], v8 offset:10240
    v_mfma_f32_16x16x32_bf16 v[120:123], v[92:95], v[72:75], v[120:123]
    ds_read_b128 v[44:47], v8 offset:12288
    v_mfma_f32_16x16x32_bf16 v[152:155], v[96:99], v[72:75], v[152:155]
    ds_read_b128 v[48:51], v8 offset:14336
    v_mfma_f32_16x16x32_bf16 v[124:127], v[92:95], v[76:79], v[124:127]
    v_mfma_f32_16x16x32_bf16 v[156:159], v[96:99], v[76:79], v[156:159]
    v_mfma_f32_16x16x32_bf16 v[128:131], v[92:95], v[80:83], v[128:131]
    v_mfma_f32_16x16x32_bf16 v[160:163], v[96:99], v[80:83], v[160:163]
    s_waitcnt lgkmcnt(0)
    v_mfma_f32_16x16x32_bf16 v[100:103], v[84:87], v[20:23], v[100:103]
    ds_read_b64_tr_b16 v[92:93], v10 offset:8192
    v_mfma_f32_16x16x32_bf16 v[132:135], v[88:91], v[20:23], v[132:135]
    ds_read_b64_tr_b16 v[94:95], v10 offset:12288
    v_mfma_f32_16x16x32_bf16 v[104:107], v[84:87], v[24:27], v[104:107]
    ds_read_b64_tr_b16 v[96:97], v11 offset:8192
    v_mfma_f32_16x16x32_bf16 v[136:139], v[88:91], v[24:27], v[136:139]
    ds_read_b64_tr_b16 v[98:99], v11 offset:12288
    v_mfma_f32_16x16x32_bf16 v[108:111], v[84:87], v[28:31], v[108:111]
    ds_read_b128 v[52:55], v9 offset:0
    v_mfma_f32_16x16x32_bf16 v[140:143], v[88:91], v[28:31], v[140:143]
    ds_read_b128 v[56:59], v9 offset:2048
    v_mfma_f32_16x16x32_bf16 v[112:115], v[84:87], v[32:35], v[112:115]
    ds_read_b128 v[60:63], v9 offset:4096
    v_mfma_f32_16x16x32_bf16 v[144:147], v[88:91], v[32:35], v[144:147]
    ds_read_b128 v[64:67], v9 offset:6144
    v_mfma_f32_16x16x32_bf16 v[116:119], v[84:87], v[36:39], v[116:119]
    ds_read_b128 v[68:71], v9 offset:8192
    v_mfma_f32_16x16x32_bf16 v[148:151], v[88:91], v[36:39], v[148:151]
    ds_read_b128 v[72:75], v9 offset:10240
    v_mfma_f32_16x16x32_bf16 v[120:123], v[84:87], v[40:43], v[120:123]
    ds_read_b128 v[76:79], v9 offset:12288
    v_mfma_f32_16x16x32_bf16 v[152:155], v[88:91], v[40:43], v[152:155]
    ds_read_b128 v[80:83], v9 offset:14336
    v_mfma_f32_16x16x32_bf16 v[124:127], v[84:87], v[44:47], v[124:127]
    v_add_u32 v8, 0x8000, v8
    v_mfma_f32_16x16x32_bf16 v[156:159], v[88:91], v[44:47], v[156:159]
    v_add_u32 v10, 0x8000, v10
    v_mfma_f32_16x16x32_bf16 v[128:131], v[84:87], v[48:51], v[128:131]
    v_add_u32 v11, 0x8000, v11
    v_mfma_f32_16x16x32_bf16 v[160:163], v[88:91], v[48:51], v[160:163]
    v_add_u32 v9, 0x8000, v9
    s_waitcnt lgkmcnt(0)
    s_barrier
    v_mfma_f32_16x16x32_bf16 v[100:103], v[92:95], v[52:55], v[100:103]
    ds_read_b64_tr_b16 v[84:85], v10 offset:0
    v_mfma_f32_16x16x32_bf16 v[132:135], v[96:99], v[52:55], v[132:135]
    ds_read_b64_tr_b16 v[86:87], v10 offset:4096
    v_mfma_f32_16x16x32_bf16 v[104:107], v[92:95], v[56:59], v[104:107]
    ds_read_b64_tr_b16 v[88:89], v11 offset:0
    v_mfma_f32_16x16x32_bf16 v[136:139], v[96:99], v[56:59], v[136:139]
    ds_read_b64_tr_b16 v[90:91], v11 offset:4096
    v_mfma_f32_16x16x32_bf16 v[108:111], v[92:95], v[60:63], v[108:111]
    ds_read_b128 v[20:23], v8 offset:0
    v_mfma_f32_16x16x32_bf16 v[140:143], v[96:99], v[60:63], v[140:143]
    ds_read_b128 v[24:27], v8 offset:2048
    v_mfma_f32_16x16x32_bf16 v[112:115], v[92:95], v[64:67], v[112:115]
    ds_read_b128 v[28:31], v8 offset:4096
    v_mfma_f32_16x16x32_bf16 v[144:147], v[96:99], v[64:67], v[144:147]
    ds_read_b128 v[32:35], v8 offset:6144
    v_mfma_f32_16x16x32_bf16 v[116:119], v[92:95], v[68:71], v[116:119]
    ds_read_b128 v[36:39], v8 offset:8192
    v_mfma_f32_16x16x32_bf16 v[148:151], v[96:99], v[68:71], v[148:151]
    ds_read_b128 v[40:43], v8 offset:10240
    v_mfma_f32_16x16x32_bf16 v[120:123], v[92:95], v[72:75], v[120:123]
    ds_read_b128 v[44:47], v8 offset:12288
    v_mfma_f32_16x16x32_bf16 v[152:155], v[96:99], v[72:75], v[152:155]
    ds_read_b128 v[48:51], v8 offset:14336
    v_mfma_f32_16x16x32_bf16 v[124:127], v[92:95], v[76:79], v[124:127]
    v_mfma_f32_16x16x32_bf16 v[156:159], v[96:99], v[76:79], v[156:159]
    v_mfma_f32_16x16x32_bf16 v[128:131], v[92:95], v[80:83], v[128:131]
    v_mfma_f32_16x16x32_bf16 v[160:163], v[96:99], v[80:83], v[160:163]
    s_waitcnt lgkmcnt(0)
    v_mfma_f32_16x16x32_bf16 v[100:103], v[84:87], v[20:23], v[100:103]
    ds_read_b64_tr_b16 v[92:93], v10 offset:8192
    v_mfma_f32_16x16x32_bf16 v[132:135], v[88:91], v[20:23], v[132:135]
    ds_read_b64_tr_b16 v[94:95], v10 offset:12288
    v_mfma_f32_16x16x32_bf16 v[104:107], v[84:87], v[24:27], v[104:107]
    ds_read_b64_tr_b16 v[96:97], v11 offset:8192
    v_mfma_f32_16x16x32_bf16 v[136:139], v[88:91], v[24:27], v[136:139]
    ds_read_b64_tr_b16 v[98:99], v11 offset:12288
    v_mfma_f32_16x16x32_bf16 v[108:111], v[84:87], v[28:31], v[108:111]
    ds_read_b128 v[52:55], v9 offset:0
    v_mfma_f32_16x16x32_bf16 v[140:143], v[88:91], v[28:31], v[140:143]
    ds_read_b128 v[56:59], v9 offset:2048
    v_mfma_f32_16x16x32_bf16 v[112:115], v[84:87], v[32:35], v[112:115]
    ds_read_b128 v[60:63], v9 offset:4096
    v_mfma_f32_16x16x32_bf16 v[144:147], v[88:91], v[32:35], v[144:147]
    ds_read_b128 v[64:67], v9 offset:6144
    v_mfma_f32_16x16x32_bf16 v[116:119], v[84:87], v[36:39], v[116:119]
    ds_read_b128 v[68:71], v9 offset:8192
    v_mfma_f32_16x16x32_bf16 v[148:151], v[88:91], v[36:39], v[148:151]
    ds_read_b128 v[72:75], v9 offset:10240
    v_mfma_f32_16x16x32_bf16 v[120:123], v[84:87], v[40:43], v[120:123]
    ds_read_b128 v[76:79], v9 offset:12288
    v_mfma_f32_16x16x32_bf16 v[152:155], v[88:91], v[40:43], v[152:155]
    ds_read_b128 v[80:83], v9 offset:14336
    v_mfma_f32_16x16x32_bf16 v[124:127], v[84:87], v[44:47], v[124:127]
    v_add_u32 v8, 0x8000, v8
    v_mfma_f32_16x16x32_bf16 v[156:159], v[88:91], v[44:47], v[156:159]
    v_add_u32 v10, 0x8000, v10
    v_mfma_f32_16x16x32_bf16 v[128:131], v[84:87], v[48:51], v[128:131]
    v_add_u32 v11, 0x8000, v11
    v_mfma_f32_16x16x32_bf16 v[160:163], v[88:91], v[48:51], v[160:163]
    v_add_u32 v9, 0x8000, v9
    s_waitcnt lgkmcnt(0)
    s_barrier
    v_mfma_f32_16x16x32_bf16 v[100:103], v[92:95], v[52:55], v[100:103]
    ds_read_b64_tr_b16 v[84:85], v10 offset:0
    v_mfma_f32_16x16x32_bf16 v[132:135], v[96:99], v[52:55], v[132:135]
    ds_read_b64_tr_b16 v[86:87], v10 offset:4096
    v_mfma_f32_16x16x32_bf16 v[104:107], v[92:95], v[56:59], v[104:107]
    ds_read_b64_tr_b16 v[88:89], v11 offset:0
    v_mfma_f32_16x16x32_bf16 v[136:139], v[96:99], v[56:59], v[136:139]
    ds_read_b64_tr_b16 v[90:91], v11 offset:4096
    v_mfma_f32_16x16x32_bf16 v[108:111], v[92:95], v[60:63], v[108:111]
    ds_read_b128 v[20:23], v8 offset:0
    v_mfma_f32_16x16x32_bf16 v[140:143], v[96:99], v[60:63], v[140:143]
    ds_read_b128 v[24:27], v8 offset:2048
    v_mfma_f32_16x16x32_bf16 v[112:115], v[92:95], v[64:67], v[112:115]
    ds_read_b128 v[28:31], v8 offset:4096
    v_mfma_f32_16x16x32_bf16 v[144:147], v[96:99], v[64:67], v[144:147]
    ds_read_b128 v[32:35], v8 offset:6144
    v_mfma_f32_16x16x32_bf16 v[116:119], v[92:95], v[68:71], v[116:119]
    ds_read_b128 v[36:39], v8 offset:8192
    v_mfma_f32_16x16x32_bf16 v[148:151], v[96:99], v[68:71], v[148:151]
    ds_read_b128 v[40:43], v8 offset:10240
    v_mfma_f32_16x16x32_bf16 v[120:123], v[92:95], v[72:75], v[120:123]
    ds_read_b128 v[44:47], v8 offset:12288
    v_mfma_f32_16x16x32_bf16 v[152:155], v[96:99], v[72:75], v[152:155]
    ds_read_b128 v[48:51], v8 offset:14336
    v_mfma_f32_16x16x32_bf16 v[124:127], v[92:95], v[76:79], v[124:127]
    v_mfma_f32_16x16x32_bf16 v[156:159], v[96:99], v[76:79], v[156:159]
    v_mfma_f32_16x16x32_bf16 v[128:131], v[92:95], v[80:83], v[128:131]
    v_mfma_f32_16x16x32_bf16 v[160:163], v[96:99], v[80:83], v[160:163]
    s_waitcnt lgkmcnt(0)
    v_mfma_f32_16x16x32_bf16 v[100:103], v[84:87], v[20:23], v[100:103]
    ds_read_b64_tr_b16 v[92:93], v10 offset:8192
    v_mfma_f32_16x16x32_bf16 v[132:135], v[88:91], v[20:23], v[132:135]
    ds_read_b64_tr_b16 v[94:95], v10 offset:12288
    v_mfma_f32_16x16x32_bf16 v[104:107], v[84:87], v[24:27], v[104:107]
    ds_read_b64_tr_b16 v[96:97], v11 offset:8192
    v_mfma_f32_16x16x32_bf16 v[136:139], v[88:91], v[24:27], v[136:139]
    ds_read_b64_tr_b16 v[98:99], v11 offset:12288
    v_mfma_f32_16x16x32_bf16 v[108:111], v[84:87], v[28:31], v[108:111]
    ds_read_b128 v[52:55], v9 offset:0
    v_mfma_f32_16x16x32_bf16 v[140:143], v[88:91], v[28:31], v[140:143]
    ds_read_b128 v[56:59], v9 offset:2048
    v_mfma_f32_16x16x32_bf16 v[112:115], v[84:87], v[32:35], v[112:115]
    ds_read_b128 v[60:63], v9 offset:4096
    v_mfma_f32_16x16x32_bf16 v[144:147], v[88:91], v[32:35], v[144:147]
    ds_read_b128 v[64:67], v9 offset:6144
    v_mfma_f32_16x16x32_bf16 v[116:119], v[84:87], v[36:39], v[116:119]
    ds_read_b128 v[68:71], v9 offset:8192
    v_mfma_f32_16x16x32_bf16 v[148:151], v[88:91], v[36:39], v[148:151]
    ds_read_b128 v[72:75], v9 offset:10240
    v_mfma_f32_16x16x32_bf16 v[120:123], v[84:87], v[40:43], v[120:123]
    ds_read_b128 v[76:79], v9 offset:12288
    v_mfma_f32_16x16x32_bf16 v[152:155], v[88:91], v[40:43], v[152:155]
    ds_read_b128 v[80:83], v9 offset:14336
    v_mfma_f32_16x16x32_bf16 v[124:127], v[84:87], v[44:47], v[124:127]
    v_add_u32 v8, 0x8000, v8
    v_mfma_f32_16x16x32_bf16 v[156:159], v[88:91], v[44:47], v[156:159]
    v_add_u32 v10, 0x8000, v10
    v_mfma_f32_16x16x32_bf16 v[128:131], v[84:87], v[48:51], v[128:131]
    v_add_u32 v11, 0x8000, v11
    v_mfma_f32_16x16x32_bf16 v[160:163], v[88:91], v[48:51], v[160:163]
    v_add_u32 v9, 0x8000, v9
    s_waitcnt lgkmcnt(0)
    s_barrier
    v_mfma_f32_16x16x32_bf16 v[100:103], v[92:95], v[52:55], v[100:103]
    ds_read_b64_tr_b16 v[84:85], v10 offset:0
    v_mfma_f32_16x16x32_bf16 v[132:135], v[96:99], v[52:55], v[132:135]
    ds_read_b64_tr_b16 v[86:87], v10 offset:4096
    v_mfma_f32_16x16x32_bf16 v[104:107], v[92:95], v[56:59], v[104:107]
    ds_read_b64_tr_b16 v[88:89], v11 offset:0
    v_mfma_f32_16x16x32_bf16 v[136:139], v[96:99], v[56:59], v[136:139]
    ds_read_b64_tr_b16 v[90:91], v11 offset:4096
    v_mfma_f32_16x16x32_bf16 v[108:111], v[92:95], v[60:63], v[108:111]
    ds_read_b128 v[20:23], v8 offset:0
    v_mfma_f32_16x16x32_bf16 v[140:143], v[96:99], v[60:63], v[140:143]
    ds_read_b128 v[24:27], v8 offset:2048
    v_mfma_f32_16x16x32_bf16 v[112:115], v[92:95], v[64:67], v[112:115]
    ds_read_b128 v[28:31], v8 offset:4096
    v_mfma_f32_16x16x32_bf16 v[144:147], v[96:99], v[64:67], v[144:147]
    ds_read_b128 v[32:35], v8 offset:6144
    v_mfma_f32_16x16x32_bf16 v[116:119], v[92:95], v[68:71], v[116:119]
    ds_read_b128 v[36:39], v8 offset:8192
    v_mfma_f32_16x16x32_bf16 v[148:151], v[96:99], v[68:71], v[148:151]
    ds_read_b128 v[40:43], v8 offset:10240
    v_mfma_f32_16x16x32_bf16 v[120:123], v[92:95], v[72:75], v[120:123]
    ds_read_b128 v[44:47], v8 offset:12288
    v_mfma_f32_16x16x32_bf16 v[152:155], v[96:99], v[72:75], v[152:155]
    ds_read_b128 v[48:51], v8 offset:14336
    v_mfma_f32_16x16x32_bf16 v[124:127], v[92:95], v[76:79], v[124:127]
    v_mfma_f32_16x16x32_bf16 v[156:159], v[96:99], v[76:79], v[156:159]
    v_mfma_f32_16x16x32_bf16 v[128:131], v[92:95], v[80:83], v[128:131]
    v_mfma_f32_16x16x32_bf16 v[160:163], v[96:99], v[80:83], v[160:163]
    s_waitcnt lgkmcnt(0)
    v_mfma_f32_16x16x32_bf16 v[100:103], v[84:87], v[20:23], v[100:103]
    ds_read_b64_tr_b16 v[92:93], v10 offset:8192
    v_mfma_f32_16x16x32_bf16 v[132:135], v[88:91], v[20:23], v[132:135]
    ds_read_b64_tr_b16 v[94:95], v10 offset:12288
    v_mfma_f32_16x16x32_bf16 v[104:107], v[84:87], v[24:27], v[104:107]
    ds_read_b64_tr_b16 v[96:97], v11 offset:8192
    v_mfma_f32_16x16x32_bf16 v[136:139], v[88:91], v[24:27], v[136:139]
    ds_read_b64_tr_b16 v[98:99], v11 offset:12288
    v_mfma_f32_16x16x32_bf16 v[108:111], v[84:87], v[28:31], v[108:111]
    ds_read_b128 v[52:55], v9 offset:0
    v_mfma_f32_16x16x32_bf16 v[140:143], v[88:91], v[28:31], v[140:143]
    ds_read_b128 v[56:59], v9 offset:2048
    v_mfma_f32_16x16x32_bf16 v[112:115], v[84:87], v[32:35], v[112:115]
    ds_read_b128 v[60:63], v9 offset:4096
    v_mfma_f32_16x16x32_bf16 v[144:147], v[88:91], v[32:35], v[144:147]
    ds_read_b128 v[64:67], v9 offset:6144
    v_mfma_f32_16x16x32_bf16 v[116:119], v[84:87], v[36:39], v[116:119]
    ds_read_b128 v[68:71], v9 offset:8192
    v_mfma_f32_16x16x32_bf16 v[148:151], v[88:91], v[36:39], v[148:151]
    ds_read_b128 v[72:75], v9 offset:10240
    v_mfma_f32_16x16x32_bf16 v[120:123], v[84:87], v[40:43], v[120:123]
    ds_read_b128 v[76:79], v9 offset:12288
    v_mfma_f32_16x16x32_bf16 v[152:155], v[88:91], v[40:43], v[152:155]
    ds_read_b128 v[80:83], v9 offset:14336
    v_mfma_f32_16x16x32_bf16 v[124:127], v[84:87], v[44:47], v[124:127]
    v_mfma_f32_16x16x32_bf16 v[156:159], v[88:91], v[44:47], v[156:159]
    v_mfma_f32_16x16x32_bf16 v[128:131], v[84:87], v[48:51], v[128:131]
    v_mfma_f32_16x16x32_bf16 v[160:163], v[88:91], v[48:51], v[160:163]
    s_mov_b64 exec, 1
    v_mov_b32 v164, 153536
    v_mov_b32 v165, 1
    ds_add_u32 v164, v165 offset:8
    s_mov_b64 exec, -1
    s_waitcnt lgkmcnt(0)
    v_mfma_f32_16x16x32_bf16 v[100:103], v[92:95], v[52:55], v[100:103]
    v_mfma_f32_16x16x32_bf16 v[132:135], v[96:99], v[52:55], v[132:135]
    v_mfma_f32_16x16x32_bf16 v[104:107], v[92:95], v[56:59], v[104:107]
    v_mfma_f32_16x16x32_bf16 v[136:139], v[96:99], v[56:59], v[136:139]
    v_mfma_f32_16x16x32_bf16 v[108:111], v[92:95], v[60:63], v[108:111]
    v_mfma_f32_16x16x32_bf16 v[140:143], v[96:99], v[60:63], v[140:143]
    v_mfma_f32_16x16x32_bf16 v[112:115], v[92:95], v[64:67], v[112:115]
    v_mfma_f32_16x16x32_bf16 v[144:147], v[96:99], v[64:67], v[144:147]
    v_mfma_f32_16x16x32_bf16 v[116:119], v[92:95], v[68:71], v[116:119]
    v_mfma_f32_16x16x32_bf16 v[148:151], v[96:99], v[68:71], v[148:151]
    v_mfma_f32_16x16x32_bf16 v[120:123], v[92:95], v[72:75], v[120:123]
    v_mfma_f32_16x16x32_bf16 v[152:155], v[96:99], v[72:75], v[152:155]
    v_mfma_f32_16x16x32_bf16 v[124:127], v[92:95], v[76:79], v[124:127]
    v_mfma_f32_16x16x32_bf16 v[156:159], v[96:99], v[76:79], v[156:159]
    v_mfma_f32_16x16x32_bf16 v[128:131], v[92:95], v[80:83], v[128:131]
    v_mfma_f32_16x16x32_bf16 v[160:163], v[96:99], v[80:83], v[160:163]
    s_waitcnt lgkmcnt(0)
    s_cmp_ge_u32 s46, 1728
    s_cbranch_scc1 L_a_setup
    s_cmp_ge_u32 s46, 576
    s_nop 5
    s_cbranch_scc1 L_g_noscale
    s_mov_b32 s48, 0x3eae1a93
    s_mov_b32 s49, s48
    v_pk_mul_f32 v[100:101], v[100:101], s[48:49]
    v_pk_mul_f32 v[102:103], v[102:103], s[48:49]
    v_pk_mul_f32 v[132:133], v[132:133], s[48:49]
    v_pk_mul_f32 v[134:135], v[134:135], s[48:49]
    v_pk_mul_f32 v[104:105], v[104:105], s[48:49]
    v_pk_mul_f32 v[106:107], v[106:107], s[48:49]
    v_pk_mul_f32 v[136:137], v[136:137], s[48:49]
    v_pk_mul_f32 v[138:139], v[138:139], s[48:49]
    v_pk_mul_f32 v[108:109], v[108:109], s[48:49]
    v_pk_mul_f32 v[110:111], v[110:111], s[48:49]
    v_pk_mul_f32 v[140:141], v[140:141], s[48:49]
    v_pk_mul_f32 v[142:143], v[142:143], s[48:49]
    v_pk_mul_f32 v[112:113], v[112:113], s[48:49]
    v_pk_mul_f32 v[114:115], v[114:115], s[48:49]
    v_pk_mul_f32 v[144:145], v[144:145], s[48:49]
    v_pk_mul_f32 v[146:147], v[146:147], s[48:49]
    v_pk_mul_f32 v[116:117], v[116:117], s[48:49]
    v_pk_mul_f32 v[118:119], v[118:119], s[48:49]
    v_pk_mul_f32 v[148:149], v[148:149], s[48:49]
    v_pk_mul_f32 v[150:151], v[150:151], s[48:49]
    v_pk_mul_f32 v[120:121], v[120:121], s[48:49]
    v_pk_mul_f32 v[122:123], v[122:123], s[48:49]
    v_pk_mul_f32 v[152:153], v[152:153], s[48:49]
    v_pk_mul_f32 v[154:155], v[154:155], s[48:49]
    v_pk_mul_f32 v[124:125], v[124:125], s[48:49]
    v_pk_mul_f32 v[126:127], v[126:127], s[48:49]
    v_pk_mul_f32 v[156:157], v[156:157], s[48:49]
    v_pk_mul_f32 v[158:159], v[158:159], s[48:49]
    v_pk_mul_f32 v[128:129], v[128:129], s[48:49]
    v_pk_mul_f32 v[130:131], v[130:131], s[48:49]
    v_pk_mul_f32 v[160:161], v[160:161], s[48:49]
    v_pk_mul_f32 v[162:163], v[162:163], s[48:49]
L_g_noscale:
    v_cvt_pk_bf16_f32 v20, v100, v104
    v_cvt_pk_bf16_f32 v21, v108, v112
    v_cvt_pk_bf16_f32 v22, v116, v120
    v_cvt_pk_bf16_f32 v23, v124, v128
    s_add_u32 s48, s47, 0
    buffer_store_dwordx4 v[20:23], v12, s[4:7], s48 offen sc1
    v_cvt_pk_bf16_f32 v24, v101, v105
    v_cvt_pk_bf16_f32 v25, v109, v113
    v_cvt_pk_bf16_f32 v26, v117, v121
    v_cvt_pk_bf16_f32 v27, v125, v129
    s_add_u32 s48, s47, 4096
    buffer_store_dwordx4 v[24:27], v12, s[4:7], s48 offen sc1
    v_cvt_pk_bf16_f32 v28, v102, v106
    v_cvt_pk_bf16_f32 v29, v110, v114
    v_cvt_pk_bf16_f32 v30, v118, v122
    v_cvt_pk_bf16_f32 v31, v126, v130
    s_add_u32 s48, s47, 8192
    buffer_store_dwordx4 v[28:31], v12, s[4:7], s48 offen sc1
    v_cvt_pk_bf16_f32 v32, v103, v107
    v_cvt_pk_bf16_f32 v33, v111, v115
    v_cvt_pk_bf16_f32 v34, v119, v123
    v_cvt_pk_bf16_f32 v35, v127, v131
    s_add_u32 s48, s47, 12288
    buffer_store_dwordx4 v[32:35], v12, s[4:7], s48 offen sc1
    v_cvt_pk_bf16_f32 v36, v132, v136
    v_cvt_pk_bf16_f32 v37, v140, v144
    v_cvt_pk_bf16_f32 v38, v148, v152
    v_cvt_pk_bf16_f32 v39, v156, v160
    s_add_u32 s48, s47, 65536
    buffer_store_dwordx4 v[36:39], v12, s[4:7], s48 offen sc1
    v_cvt_pk_bf16_f32 v40, v133, v137
    v_cvt_pk_bf16_f32 v41, v141, v145
    v_cvt_pk_bf16_f32 v42, v149, v153
    v_cvt_pk_bf16_f32 v43, v157, v161
    s_add_u32 s48, s47, 69632
    buffer_store_dwordx4 v[40:43], v12, s[4:7], s48 offen sc1
    v_cvt_pk_bf16_f32 v44, v134, v138
    v_cvt_pk_bf16_f32 v45, v142, v146
    v_cvt_pk_bf16_f32 v46, v150, v154
    v_cvt_pk_bf16_f32 v47, v158, v162
    s_add_u32 s48, s47, 73728
    buffer_store_dwordx4 v[44:47], v12, s[4:7], s48 offen sc1
    v_cvt_pk_bf16_f32 v48, v135, v139
    v_cvt_pk_bf16_f32 v49, v143, v147
    v_cvt_pk_bf16_f32 v50, v151, v155
    v_cvt_pk_bf16_f32 v51, v159, v163
    s_add_u32 s48, s47, 77824
    buffer_store_dwordx4 v[48:51], v12, s[4:7], s48 offen sc1
    s_setprio 0
    s_lshr_b32 s47, s46, 7
    s_lshl_b32 s47, s47, 11
    s_add_u32 s47, s47, s44
    s_add_u32 s47, s47, 0x12c0000
    s_cmp_ge_u32 s45, 1664
    s_cselect_b32 s48, 1, 3
    s_call_b64 s[62:63], L_sub_asetup
    v_mov_b32 v8, 153536
    v_mov_b32 v9, 1
    v_mov_b32 v11, s38
    s_waitcnt vmcnt(0)
    s_mov_b64 exec, 1
    ds_add_rtn_u32 v10, v8, v9 offset:56
    s_waitcnt lgkmcnt(0)
    v_cmp_eq_u32 vcc, s48, v10
    s_cbranch_vccz L_g_nf
    buffer_store_dword v11, off, s[4:7], s47 sc1
L_g_nf:
    s_mov_b64 exec, -1
    s_mov_b32 s59, 4
    s_branch L_a_wait
L_sub_asetup:
    s_and_b32 s50, s2, 7
    s_lshl_b32 s50, s50, 2
    s_bfe_u32 s51, s2, 0x20003
    s_add_u32 s50, s50, s51
    s_lshr_b32 s51, s2, 5
    s_mul_i32 s52, s50, 0x12000
    s_add_u32 s53, s52, 0x240000
    s_add_u32 s54, s52, 0x480000
    v_and_b32 v168, 31, v0
    v_lshrrev_b32 v171, 5, v0
    v_mul_u32_u24 v180, 33024, v171
    v_lshl_add_u32 v180, v168, 4, v180
    v_lshlrev_b32 v181, 2, v0
    s_lshl_b32 s55, s51, 2
    s_and_b32 s56, s3, 3
    s_add_u32 s55, s55, s56
    s_mul_i32 s0, s50, 66048
    s_lshl_b32 s56, s55, 10
    s_add_u32 s0, s0, s56
    s_add_u32 s0, s0, 0x700000
    s_mul_i32 s1, s50, 8320
    s_lshl_b32 s56, s55, 8
    s_add_u32 s1, s1, s56
    s_add_u32 s1, s1, 0x980000
    v_bfe_u32 v168, v0, 2, 2
    v_and_b32 v169, 3, v0
    v_lshrrev_b32 v182, 2, v0
    v_lshlrev_b32 v182, 12, v182
    v_lshl_add_u32 v182, v169, 4, v182
    v_lshlrev_b32 v169, 3, v169
    v_and_b32 v170, 16, v0
    v_lshl_add_u32 v169, v170, 1, v169
    v_lshl_add_u32 v170, v171, 3, v168
    v_mul_u32_u24 v172, 1088, v170
    v_add_u32 v172, v172, v169
    v_add_u32 v172, 18816, v172
    s_mul_i32 s56, s3, 2304
    s_add_u32 s56, s56, 153600
    v_lshl_add_u32 v178, v170, 6, v169
    v_add_u32 v178, s56, v178
    v_and_b32 v179, 1, v168
    v_lshl_add_u32 v179, v179, 6, v169
    v_mul_u32_u24 v170, 1152, v171
    v_add3_u32 v179, v179, v170, s56
    v_mul_u32_u24 v173, 1088, v168
    v_add_u32 v173, 36224, v173
    v_cmp_lt_u32 vcc, 1, v168
    v_mov_b32 v170, 162816
    v_mov_b32 v176, 38400
    v_lshl_add_u32 v169, v171, 6, v169
    v_cndmask_b32 v173, v173, v170, vcc
    v_cndmask_b32 v176, v176, 0, vcc
    v_add_u32 v173, v173, v169
    v_and_b32 v168, 31, v0
    v_and_b32 v169, 0x13, v168
    v_and_b32 v177, 4, v168
    v_lshl_add_u32 v169, v177, 1, v169
    v_and_b32 v177, 8, v168
    v_lshrrev_b32 v177, 1, v177
    v_add_u32 v169, v169, v177
    v_cmp_eq_u32 vcc, 18, v168
    v_mul_u32_u24 v174, 1040, v169
    v_add_u32 v174, 32, v174
    v_mov_b32 v177, 38400
    v_cndmask_b32 v174, v174, v170, vcc
    v_cndmask_b32 v177, v177, 0, vcc
    v_cmp_lt_u32 vcc, 18, v168
    v_lshl_add_u32 v174, v171, 4, v174
    v_mov_b32 v170, 196608
    v_cndmask_b32 v174, v174, v170, vcc
    v_mov_b32 v175, 0xdddddddd
    v_mov_b32 v184, 0
    v_mov_b32 v185, 0
    v_mov_b32 v186, 0
    v_mov_b32 v187, 0
    v_mov_b32 v188, 0
    v_mov_b32 v189, 0
    v_mov_b32 v190, 0
    v_mov_b32 v191, 0
    v_mov_b32 v192, 0
    v_mov_b32 v193, 0
    v_mov_b32 v194, 0
    v_mov_b32 v195, 0
    v_mov_b32 v196, 0
    v_mov_b32 v197, 0
    v_mov_b32 v198, 0
    v_mov_b32 v199, 0
    v_mov_b32 v200, 0
    v_mov_b32 v201, 0
    v_mov_b32 v202, 0
    v_mov_b32 v203, 0
    v_mov_b32 v204, 0
    v_mov_b32 v205, 0
    v_mov_b32 v206, 0
    v_mov_b32 v207, 0
    v_mov_b32 v208, 0
    v_mov_b32 v209, 0
    v_mov_b32 v210, 0
    v_mov_b32 v211, 0
    v_mov_b32 v212, 0
    v_mov_b32 v213, 0
    v_mov_b32 v214, 0
    v_mov_b32 v215, 0
    v_mov_b32 v169, 0x3f803f80
    s_lshl_b32 s56, s3, 8
    s_add_u32 s56, s56, 162816
    v_add_u32 v168, s56, v181
    ds_write_b32 v168, v169
    v_cmp_gt_u32 vcc, 16, v0
    v_lshrrev_b32 v168, 3, v0
    v_add_u32 v168, 1, v168
    v_cndmask_b32 v168, 0, v168, vcc
    v_bfe_u32 v169, v0, 2, 1
    v_bfe_u32 v170, v0, 1, 1
    v_cndmask_b32 v169, v170, v169, vcc
    v_and_b32 v170, 1, v0
    s_lshl_b32 s56, s51, 1
    v_add_u32 v170, s56, v170
    v_and_b32 v171, 3, v0
    v_cndmask_b32 v170, v170, v171, vcc
    v_mul_u32_u24 v183, 576, v168
    v_mul_u32_u24 v171, 17, v169
    s_mul_i32 s55, s50, 18
    v_add3_u32 v183, v183, v171, s55
    v_lshrrev_b32 v183, 7, v183
    v_lshl_add_u32 v183, v183, 4, v170
    v_lshlrev_b32 v183, 7, v183
    s_setpc_b64 s[62:63]
L_a_wait:
    s_setprio 3
    s_cmp_lg_u32 s3, 0
    s_cbranch_scc1 L_a_spin
    s_mov_b32 s44, 0x12c0000
    s_mov_b32 s60, 0
    s_mov_b64 exec, 0xfffff
L_poll1:
    buffer_load_dword v169, v183, s[4:7], s44 offen sc1
    s_add_u32 s60, s60, 1
    s_waitcnt vmcnt(0)
    v_cmp_ne_u32 vcc, s38, v169
    s_cbranch_vccz L_poll1_ok
    s_sleep 2
    s_cmp_lt_u32 s60, 0xf4240
    s_cbranch_scc1 L_poll1
L_poll1_ok:
    s_mov_b64 exec, -1
    s_mov_b64 exec, 1
    v_mov_b32 v168, 153536
    v_mov_b32 v169, 1
    ds_add_u32 v168, v169 offset:0
    s_mov_b64 exec, -1
L_a_spin:
    v_mov_b32 v168, 153536
L_lw2:
    ds_read_b32 v169, v168 offset:0
    ds_read_b32 v170, v168 offset:16
    s_add_u32 s42, s42, 1
    s_waitcnt lgkmcnt(0)
    v_cmp_gt_u32 s[40:41], 1, v169
    v_cmp_gt_u32 vcc, s59, v170
    s_or_b64 vcc, vcc, s[40:41]
    s_cmp_lt_u32 s42, 0xf42400
    s_cselect_b64 vcc, vcc, 0
    s_cbranch_vccnz L_lw2
    s_setprio 3
    s_lshl_b32 s44, s3, 12
    s_add_u32 s45, s53, s44
    s_mul_i32 s46, s3, 1088
    s_add_u32 m0, s46, 18816
    s_add_u32 s47, s45, 0
    buffer_load_dwordx4 v7, s[4:7], s47 offen sc1 lds
    s_add_u32 m0, s46, 23168
    s_add_u32 s47, s45, 16384
    buffer_load_dwordx4 v7, s[4:7], s47 offen sc1 lds
    s_add_u32 m0, s46, 27520
    s_add_u32 s47, s45, 32768
    buffer_load_dwordx4 v7, s[4:7], s47 offen sc1 lds
    s_add_u32 m0, s46, 31872
    s_add_u32 s47, s45, 49152
    buffer_load_dwordx4 v7, s[4:7], s47 offen sc1 lds
    s_and_b32 s47, s3, 1
    s_bitcmp1_b32 s3, 1
    s_cselect_b32 s45, s54, s53
    s_mov_b32 s48, 36224
    s_mov_b32 s49, 1088
    s_cselect_b32 s48, 16672, s48
    s_cselect_b32 s49, 1040, s49
    s_mul_i32 s49, s49, s47
    s_add_u32 s48, s48, s49
    s_lshl_b32 s47, s47, 12
    s_add_u32 s45, s45, s47
    s_add_u32 m0, s48, 0
    s_add_u32 s45, s45, 65536
    buffer_load_dwordx4 v7, s[4:7], s45 offen sc1 lds
    s_lshl_b32 s45, s51, 9
    s_add_u32 s45, s45, s52
    s_lshl_b32 s46, s3, 7
    s_add_u32 s45, s45, s46
    s_mul_i32 s46, s3, 2304
    s_add_u32 m0, s46, 153600
    s_add_u32 s47, s45, 0
    buffer_load_dwordx4 v182, s[4:7], s47 offen sc1 lds
    s_add_u32 m0, s46, 154752
    s_add_u32 s47, s45, 64
    buffer_load_dwordx4 v182, s[4:7], s47 offen sc1 lds
    s_mov_b64 exec, 0xff
    s_add_u32 m0, s46, 154624
    s_add_u32 s47, s45, 65536
    buffer_load_dwordx4 v182, s[4:7], s47 offen sc1 lds
    s_add_u32 m0, s46, 155776
    s_add_u32 s47, s45, 65600
    buffer_load_dwordx4 v182, s[4:7], s47 offen sc1 lds
    s_mov_b64 exec, -1
    s_add_u32 s45, s54, s44
    s_mul_i32 s46, s3, 1040
    s_add_u32 m0, s46, 32
    s_add_u32 s47, s45, 0
    buffer_load_dwordx4 v7, s[4:7], s47 offen sc1 lds
    s_add_u32 m0, s46, 4192
    s_add_u32 s47, s45, 16384
    buffer_load_dwordx4 v7, s[4:7], s47 offen sc1 lds
    s_add_u32 m0, s46, 8352
    s_add_u32 s47, s45, 32768
    buffer_load_dwordx4 v7, s[4:7], s47 offen sc1 lds
    s_add_u32 m0, s46, 12512
    s_add_u32 s47, s45, 49152
    buffer_load_dwordx4 v7, s[4:7], s47 offen sc1 lds
    v_mov_b32 v104, 0
    v_mov_b32 v105, 0
    v_mov_b32 v106, 0
    v_mov_b32 v107, 0
    v_mov_b32 v108, 0
    v_mov_b32 v109, 0
    v_mov_b32 v110, 0
    v_mov_b32 v111, 0
    v_mov_b32 v44, 0
    v_mov_b32 v45, 0
    v_mov_b32 v46, 0
    v_mov_b32 v47, 0
    s_waitcnt vmcnt(4)
    ds_read_b64_tr_b16 v[16:17], v179 offset:1024
    ds_read_b64_tr_b16 v[8:9], v178 offset:0
    ds_read_b64_tr_b16 v[10:11], v178 offset:256
    ds_read_b64_tr_b16 v[12:13], v178 offset:1152
    ds_read_b64_tr_b16 v[14:15], v178 offset:1408
    s_mov_b64 exec, 1
    v_mov_b32 v168, 153536
    v_mov_b32 v169, 1
    ds_add_u32 v168, v169 offset:48
    s_mov_b64 exec, -1
    v_mov_b32 v168, 153536
L_lw3:
    ds_read_b32 v169, v168 offset:48
    s_add_u32 s42, s42, 1
    s_cmp_lt_u32 s42, 0xf42400
    s_cselect_b64 s[40:41], -1, 0
    s_waitcnt lgkmcnt(0)
    v_cmp_gt_u32 vcc, 4, v169
    s_and_b64 vcc, vcc, s[40:41]
    s_cbranch_vccnz L_lw3
    v_mov_b32 v17, 0
    ds_read_b64_tr_b16 v[28:29], v173 offset:0
    ds_read_b64_tr_b16 v[20:21], v172 offset:0
    ds_read_b64_tr_b16 v[22:23], v172 offset:4352
    ds_read_b64_tr_b16 v[24:25], v172 offset:64
    ds_read_b64_tr_b16 v[26:27], v172 offset:4416
    s_waitcnt lgkmcnt(2)
    v_mfma_f32_32x32x4_2b_bf16 v[48:79], v[28:29], v[16:17], 0 cbsz:1 abid:0
    s_nop 15
    s_nop 1
    v_mfma_f32_32x32x16_bf16 v[48:63], v[20:23], v[8:11], v[48:63]
    v_mfma_f32_32x32x16_bf16 v[64:79], v[20:23], v[12:15], v[64:79]
    s_waitcnt vmcnt(0)
    s_mov_b64 exec, 1
    v_mov_b32 v170, 153536
    v_mov_b32 v171, 1
    ds_add_u32 v170, v171 offset:20
    s_mov_b64 exec, -1
    s_nop 5
    v_max3_f32 v168, v48, v49, v50
    v_max3_f32 v168, v168, v51, v52
    v_max3_f32 v168, v168, v53, v54
    v_max3_f32 v168, v168, v55, v56
    v_max3_f32 v168, v168, v57, v58
    v_max3_f32 v168, v168, v59, v60
    v_max3_f32 v168, v168, v61, v62
    v_max_f32 v168, v168, v63
    v_max3_f32 v169, v64, v65, v66
    v_max3_f32 v169, v169, v67, v68
    v_max3_f32 v169, v169, v69, v70
    v_max3_f32 v169, v169, v71, v72
    v_max3_f32 v169, v169, v73, v74
    v_max3_f32 v169, v169, v75, v76
    v_max3_f32 v169, v169, v77, v78
    v_max_f32 v169, v169, v79
    s_nop 1
    v_permlane32_swap_b32 v168, v169
    s_nop 1
    v_max_f32 v168, v168, v169
    v_cvt_pk_bf16_f32 v17, -v168, 0
    s_nop 1
    v_mfma_f32_32x32x4_2b_bf16 v[48:79], v[28:29], v[16:17], 0 cbsz:1 abid:0
    s_nop 15
    s_nop 1
    v_mfma_f32_32x32x16_bf16 v[48:63], v[20:23], v[8:11], v[48:63]
    v_mfma_f32_32x32x16_bf16 v[64:79], v[20:23], v[12:15], v[64:79]
    v_mov_b32 v170, 153536
L_lw4:
    ds_read_b32 v171, v170 offset:20
    ds_read_b32 v169, v170 offset:24
    s_add_u32 s42, s42, 1
    s_waitcnt lgkmcnt(0)
    v_cmp_gt_u32 s[40:41], 4, v171
    v_cmp_gt_u32 vcc, 0, v169
    s_or_b64 vcc, vcc, s[40:41]
    s_cmp_lt_u32 s42, 0xf42400
    s_cselect_b64 vcc, vcc, 0
    s_cbranch_vccnz L_lw4
    ds_read_b128 v[40:43], v174 offset:32
    ds_read_b128 v[32:35], v174 offset:0
    v_cmp_eq_u32 vcc, 0, v0
    s_nop 1
    v_cndmask_b32 v171, 0, 1, vcc
    v_mov_b32 v168, v170
    s_setprio 1
.p2align 6
    v_exp_f32 v48, v48
    v_exp_f32 v49, v49
    s_waitcnt lgkmcnt(0)
    v_exp_f32 v50, v50
    v_exp_f32_e64 v51, v51
    v_exp_f32 v52, v52
    v_exp_f32 v53, v53
    v_mfma_f32_32x32x4_2b_bf16 v[80:111], v[28:29], v[16:17], 0 cbsz:1 abid:1
    ds_read_b128 v[44:47], v174 offset:96
    v_exp_f32 v54, v54
    v_exp_f32 v55, v55
    v_exp_f32 v64, v64
    v_exp_f32 v65, v65
    v_exp_f32 v66, v66
    v_exp_f32 v67, v67
    v_exp_f32 v68, v68
    v_exp_f32 v69, v69
    v_smfmac_f32_32x32x32_bf16 v[184:199], v[32:35], v[48:55], v175
    ds_read_b64_tr_b16 v[20:21], v172 offset:128
    v_exp_f32 v70, v70
    v_exp_f32 v71, v71
    v_exp_f32 v56, v56
    v_exp_f32 v57, v57
    v_smfmac_f32_32x32x32_bf16 v[200:215], v[32:35], v[64:71], v175
    ds_read_b64_tr_b16 v[22:23], v172 offset:4480
    v_exp_f32 v58, v58
    v_exp_f32 v59, v59
    v_exp_f32 v60, v60
    v_exp_f32 v61, v61
    v_mfma_f32_32x32x16_bf16 v[80:95], v[24:27], v[8:11], v[80:95]
    ds_read_b128 v[36:39], v174 offset:64
    v_exp_f32 v62, v62
    v_exp_f32 v63, v63
    v_exp_f32 v72, v72
    v_exp_f32 v73, v73
    v_mfma_f32_32x32x16_bf16 v[96:111], v[24:27], v[12:15], v[96:111]
    ds_read_b64_tr_b16 v[30:31], v173 offset:128
    v_exp_f32 v74, v74
    v_exp_f32 v75, v75
    v_exp_f32 v76, v76
    v_exp_f32 v77, v77
    v_smfmac_f32_32x32x32_bf16 v[184:199], v[40:43], v[56:63], v175
    v_exp_f32 v78, v78
    v_exp_f32 v79, v79
    v_exp_f32 v80, v80
    v_exp_f32 v81, v81
    v_smfmac_f32_32x32x32_bf16 v[200:215], v[40:43], v[72:79], v175
    s_waitcnt lgkmcnt(0)
    v_exp_f32 v82, v82
    v_exp_f32_e64 v83, v83
    v_exp_f32 v84, v84
    v_exp_f32 v85, v85
    v_mfma_f32_32x32x4_2b_bf16 v[48:79], v[30:31], v[16:17], 0 cbsz:1 abid:0
    ds_read_b128 v[40:43], v174 offset:160
    v_exp_f32 v86, v86
    v_exp_f32 v87, v87
    v_exp_f32 v96, v96
    v_exp_f32 v97, v97
    v_exp_f32 v98, v98
    v_exp_f32 v99, v99
    v_exp_f32 v100, v100
    v_exp_f32 v101, v101
    v_smfmac_f32_32x32x32_bf16 v[184:199], v[36:39], v[80:87], v175
    ds_read_b64_tr_b16 v[24:25], v172 offset:192
    v_exp_f32 v102, v102
    v_exp_f32 v103, v103
    v_exp_f32 v88, v88
    v_exp_f32 v89, v89
    v_smfmac_f32_32x32x32_bf16 v[200:215], v[36:39], v[96:103], v175
    ds_read_b64_tr_b16 v[26:27], v172 offset:4544
    v_exp_f32 v90, v90
    v_exp_f32 v91, v91
    v_exp_f32 v92, v92
    v_exp_f32 v93, v93
    v_mfma_f32_32x32x16_bf16 v[48:63], v[20:23], v[8:11], v[48:63]
    ds_read_b128 v[32:35], v174 offset:128
    v_exp_f32 v94, v94
    v_exp_f32 v95, v95
    v_exp_f32 v104, v104
    v_exp_f32 v105, v105
    v_mfma_f32_32x32x16_bf16 v[64:79], v[20:23], v[12:15], v[64:79]
    v_exp_f32 v106, v106
    v_exp_f32 v107, v107
    v_exp_f32 v108, v108
    v_exp_f32 v109, v109
    v_smfmac_f32_32x32x32_bf16 v[184:199], v[44:47], v[88:95], v175
    v_exp_f32 v110, v110
    v_exp_f32 v111, v111
    v_exp_f32 v48, v48
    v_exp_f32 v49, v49
    v_smfmac_f32_32x32x32_bf16 v[200:215], v[44:47], v[104:111], v175
    s_waitcnt lgkmcnt(0)
    v_exp_f32 v50, v50
    v_exp_f32_e64 v51, v51
    v_exp_f32 v52, v52
    v_exp_f32 v53, v53
    v_mfma_f32_32x32x4_2b_bf16 v[80:111], v[30:31], v[16:17], 0 cbsz:1 abid:1
    ds_read_b128 v[44:47], v174 offset:224
    v_exp_f32 v54, v54
    v_exp_f32 v55, v55
    v_exp_f32 v64, v64
    v_exp_f32 v65, v65
    v_exp_f32 v66, v66
    v_exp_f32 v67, v67
    v_exp_f32 v68, v68
    v_exp_f32 v69, v69
    v_smfmac_f32_32x32x32_bf16 v[184:199], v[32:35], v[48:55], v175
    ds_read_b64_tr_b16 v[20:21], v172 offset:256
    v_exp_f32 v70, v70
    v_exp_f32 v71, v71
    v_exp_f32 v56, v56
    v_exp_f32 v57, v57
    v_smfmac_f32_32x32x32_bf16 v[200:215], v[32:35], v[64:71], v175
    ds_read_b64_tr_b16 v[22:23], v172 offset:4608
    v_exp_f32 v58, v58
    v_exp_f32 v59, v59
    v_exp_f32 v60, v60
    v_exp_f32 v61, v61
    v_mfma_f32_32x32x16_bf16 v[80:95], v[24:27], v[8:11], v[80:95]
    ds_read_b128 v[36:39], v174 offset:192
    v_exp_f32 v62, v62
    v_exp_f32 v63, v63
    v_exp_f32 v72, v72
    v_exp_f32 v73, v73
    v_mfma_f32_32x32x16_bf16 v[96:111], v[24:27], v[12:15], v[96:111]
    ds_read_b64_tr_b16 v[28:29], v173 offset:256
    v_exp_f32 v74, v74
    v_exp_f32 v75, v75
    v_exp_f32 v76, v76
    v_exp_f32 v77, v77
    v_smfmac_f32_32x32x32_bf16 v[184:199], v[40:43], v[56:63], v175
    v_exp_f32 v78, v78
    v_exp_f32 v79, v79
    v_exp_f32 v80, v80
    v_exp_f32 v81, v81
    v_smfmac_f32_32x32x32_bf16 v[200:215], v[40:43], v[72:79], v175
    s_waitcnt lgkmcnt(0)
    v_exp_f32 v82, v82
    v_exp_f32_e64 v83, v83
    v_exp_f32 v84, v84
    v_exp_f32 v85, v85
    v_mfma_f32_32x32x4_2b_bf16 v[48:79], v[28:29], v[16:17], 0 cbsz:1 abid:0
    ds_read_b128 v[40:43], v174 offset:288
    v_exp_f32 v86, v86
    v_exp_f32 v87, v87
    v_exp_f32 v96, v96
    v_exp_f32 v97, v97
    v_exp_f32 v98, v98
    v_exp_f32 v99, v99
    v_exp_f32 v100, v100
    v_exp_f32 v101, v101
    v_smfmac_f32_32x32x32_bf16 v[184:199], v[36:39], v[80:87], v175
    ds_read_b64_tr_b16 v[24:25], v172 offset:320
    v_exp_f32 v102, v102
    v_exp_f32 v103, v103
    v_exp_f32 v88, v88
    v_exp_f32 v89, v89
    v_smfmac_f32_32x32x32_bf16 v[200:215], v[36:39], v[96:103], v175
    ds_read_b64_tr_b16 v[26:27], v172 offset:4672
    v_exp_f32 v90, v90
    v_exp_f32 v91, v91
    v_exp_f32 v92, v92
    v_exp_f32 v93, v93
    v_mfma_f32_32x32x16_bf16 v[48:63], v[20:23], v[8:11], v[48:63]
    ds_read_b128 v[32:35], v174 offset:256
    v_exp_f32 v94, v94
    v_exp_f32 v95, v95
    v_exp_f32 v104, v104
    v_exp_f32 v105, v105
    v_mfma_f32_32x32x16_bf16 v[64:79], v[20:23], v[12:15], v[64:79]
    v_exp_f32 v106, v106
    v_exp_f32 v107, v107
    v_exp_f32 v108, v108
    v_exp_f32 v109, v109
    v_smfmac_f32_32x32x32_bf16 v[184:199], v[44:47], v[88:95], v175
    v_exp_f32 v110, v110
    v_exp_f32 v111, v111
    v_exp_f32 v48, v48
    v_exp_f32 v49, v49
    v_smfmac_f32_32x32x32_bf16 v[200:215], v[44:47], v[104:111], v175
    s_waitcnt lgkmcnt(0)
    v_exp_f32 v50, v50
    v_exp_f32_e64 v51, v51
    v_exp_f32 v52, v52
    v_exp_f32 v53, v53
    v_mfma_f32_32x32x4_2b_bf16 v[80:111], v[28:29], v[16:17], 0 cbsz:1 abid:1
    ds_read_b128 v[44:47], v174 offset:352
    v_exp_f32 v54, v54
    v_exp_f32 v55, v55
    v_exp_f32 v64, v64
    v_exp_f32 v65, v65
    v_exp_f32 v66, v66
    v_exp_f32 v67, v67
    v_exp_f32 v68, v68
    v_exp_f32 v69, v69
    v_smfmac_f32_32x32x32_bf16 v[184:199], v[32:35], v[48:55], v175
    ds_read_b64_tr_b16 v[20:21], v172 offset:384
    v_exp_f32 v70, v70
    v_exp_f32 v71, v71
    v_exp_f32 v56, v56
    v_exp_f32 v57, v57
    v_smfmac_f32_32x32x32_bf16 v[200:215], v[32:35], v[64:71], v175
    ds_read_b64_tr_b16 v[22:23], v172 offset:4736
    v_exp_f32 v58, v58
    v_exp_f32 v59, v59
    v_exp_f32 v60, v60
    v_exp_f32 v61, v61
    v_mfma_f32_32x32x16_bf16 v[80:95], v[24:27], v[8:11], v[80:95]
    ds_read_b128 v[36:39], v174 offset:320
    v_exp_f32 v62, v62
    v_exp_f32 v63, v63
    v_exp_f32 v72, v72
    v_exp_f32 v73, v73
    v_mfma_f32_32x32x16_bf16 v[96:111], v[24:27], v[12:15], v[96:111]
    ds_read_b64_tr_b16 v[30:31], v173 offset:384
    v_exp_f32 v74, v74
    v_exp_f32 v75, v75
    v_exp_f32 v76, v76
    v_exp_f32 v77, v77
    v_smfmac_f32_32x32x32_bf16 v[184:199], v[40:43], v[56:63], v175
    v_exp_f32 v78, v78
    v_exp_f32 v79, v79
    v_exp_f32 v80, v80
    v_exp_f32 v81, v81
    v_smfmac_f32_32x32x32_bf16 v[200:215], v[40:43], v[72:79], v175
    s_waitcnt lgkmcnt(0)
    v_exp_f32 v82, v82
    v_exp_f32_e64 v83, v83
    v_exp_f32 v84, v84
    v_exp_f32 v85, v85
    v_mfma_f32_32x32x4_2b_bf16 v[48:79], v[30:31], v[16:17], 0 cbsz:1 abid:0
    ds_read_b128 v[40:43], v174 offset:416
    v_exp_f32 v86, v86
    v_exp_f32 v87, v87
    v_exp_f32 v96, v96
    v_exp_f32 v97, v97
    v_exp_f32 v98, v98
    v_exp_f32 v99, v99
    v_exp_f32 v100, v100
    v_exp_f32 v101, v101
    v_smfmac_f32_32x32x32_bf16 v[184:199], v[36:39], v[80:87], v175
    ds_read_b64_tr_b16 v[24:25], v172 offset:448
    v_exp_f32 v102, v102
    v_exp_f32 v103, v103
    v_exp_f32 v88, v88
    v_exp_f32 v89, v89
    v_smfmac_f32_32x32x32_bf16 v[200:215], v[36:39], v[96:103], v175
    ds_read_b64_tr_b16 v[26:27], v172 offset:4800
    v_exp_f32 v90, v90
    v_exp_f32 v91, v91
    v_exp_f32 v92, v92
    v_exp_f32 v93, v93
    v_mfma_f32_32x32x16_bf16 v[48:63], v[20:23], v[8:11], v[48:63]
    ds_read_b128 v[32:35], v174 offset:384
    v_exp_f32 v94, v94
    v_exp_f32 v95, v95
    v_exp_f32 v104, v104
    v_exp_f32 v105, v105
    v_mfma_f32_32x32x16_bf16 v[64:79], v[20:23], v[12:15], v[64:79]
    v_exp_f32 v106, v106
    v_exp_f32 v107, v107
    v_exp_f32 v108, v108
    v_exp_f32 v109, v109
    v_smfmac_f32_32x32x32_bf16 v[184:199], v[44:47], v[88:95], v175
    v_exp_f32 v110, v110
    v_exp_f32 v111, v111
    v_exp_f32 v48, v48
    v_exp_f32 v49, v49
    v_smfmac_f32_32x32x32_bf16 v[200:215], v[44:47], v[104:111], v175
    s_waitcnt lgkmcnt(0)
    v_exp_f32 v50, v50
    v_exp_f32_e64 v51, v51
    v_exp_f32 v52, v52
    v_exp_f32 v53, v53
    v_mfma_f32_32x32x4_2b_bf16 v[80:111], v[30:31], v[16:17], 0 cbsz:1 abid:1
    ds_read_b128 v[44:47], v174 offset:480
    v_exp_f32 v54, v54
    v_exp_f32 v55, v55
    v_exp_f32 v64, v64
    v_exp_f32 v65, v65
    v_exp_f32 v66, v66
    v_exp_f32 v67, v67
    v_exp_f32 v68, v68
    v_exp_f32 v69, v69
    v_smfmac_f32_32x32x32_bf16 v[184:199], v[32:35], v[48:55], v175
    ds_read_b64_tr_b16 v[20:21], v172 offset:512
    v_exp_f32 v70, v70
    v_exp_f32 v71, v71
    v_exp_f32 v56, v56
    v_exp_f32 v57, v57
    v_smfmac_f32_32x32x32_bf16 v[200:215], v[32:35], v[64:71], v175
    ds_read_b64_tr_b16 v[22:23], v172 offset:4864
    v_exp_f32 v58, v58
    v_exp_f32 v59, v59
    v_exp_f32 v60, v60
    v_exp_f32 v61, v61
    v_mfma_f32_32x32x16_bf16 v[80:95], v[24:27], v[8:11], v[80:95]
    ds_read_b128 v[36:39], v174 offset:448
    v_exp_f32 v62, v62
    v_exp_f32 v63, v63
    v_exp_f32 v72, v72
    v_exp_f32 v73, v73
    v_mfma_f32_32x32x16_bf16 v[96:111], v[24:27], v[12:15], v[96:111]
    ds_read_b64_tr_b16 v[28:29], v173 offset:512
    v_exp_f32 v74, v74
    v_exp_f32 v75, v75
    v_exp_f32 v76, v76
    v_exp_f32 v77, v77
    v_smfmac_f32_32x32x32_bf16 v[184:199], v[40:43], v[56:63], v175
    v_exp_f32 v78, v78
    v_exp_f32 v79, v79
    v_exp_f32 v80, v80
    v_exp_f32 v81, v81
    v_smfmac_f32_32x32x32_bf16 v[200:215], v[40:43], v[72:79], v175
    s_waitcnt lgkmcnt(0)
    v_exp_f32 v82, v82
    v_exp_f32_e64 v83, v83
    v_exp_f32 v84, v84
    v_exp_f32 v85, v85
    v_mfma_f32_32x32x4_2b_bf16 v[48:79], v[28:29], v[16:17], 0 cbsz:1 abid:0
    ds_read_b128 v[40:43], v174 offset:544
    v_exp_f32 v86, v86
    v_exp_f32 v87, v87
    v_exp_f32 v96, v96
    v_exp_f32 v97, v97
    v_exp_f32 v98, v98
    v_exp_f32 v99, v99
    v_exp_f32 v100, v100
    v_exp_f32 v101, v101
    v_smfmac_f32_32x32x32_bf16 v[184:199], v[36:39], v[80:87], v175
    ds_read_b64_tr_b16 v[24:25], v172 offset:576
    v_exp_f32 v102, v102
    v_exp_f32 v103, v103
    v_exp_f32 v88, v88
    v_exp_f32 v89, v89
    v_smfmac_f32_32x32x32_bf16 v[200:215], v[36:39], v[96:103], v175
    ds_read_b64_tr_b16 v[26:27], v172 offset:4928
    v_exp_f32 v90, v90
    v_exp_f32 v91, v91
    v_exp_f32 v92, v92
    v_exp_f32 v93, v93
    v_mfma_f32_32x32x16_bf16 v[48:63], v[20:23], v[8:11], v[48:63]
    ds_read_b128 v[32:35], v174 offset:512
    v_exp_f32 v94, v94
    v_exp_f32 v95, v95
    v_exp_f32 v104, v104
    v_exp_f32 v105, v105
    v_mfma_f32_32x32x16_bf16 v[64:79], v[20:23], v[12:15], v[64:79]
    s_mov_b64 exec, 1
    ds_add_u32 v170, v171 offset:52
    s_mov_b64 exec, -1
    v_exp_f32 v106, v106
    v_exp_f32 v107, v107
    v_exp_f32 v108, v108
    v_exp_f32 v109, v109
    v_smfmac_f32_32x32x32_bf16 v[184:199], v[44:47], v[88:95], v175
    v_exp_f32 v110, v110
    v_exp_f32 v111, v111
    v_exp_f32 v48, v48
    v_exp_f32 v49, v49
    v_smfmac_f32_32x32x32_bf16 v[200:215], v[44:47], v[104:111], v175
    s_waitcnt lgkmcnt(0)
    v_exp_f32 v50, v50
    v_exp_f32_e64 v51, v51
    v_exp_f32 v52, v52
    v_exp_f32 v53, v53
    v_mfma_f32_32x32x4_2b_bf16 v[80:111], v[28:29], v[16:17], 0 cbsz:1 abid:1
    ds_read_b128 v[44:47], v174 offset:608
    v_exp_f32 v54, v54
    v_exp_f32 v55, v55
    v_exp_f32 v64, v64
    v_exp_f32 v65, v65
    v_exp_f32 v66, v66
    v_exp_f32 v67, v67
    v_exp_f32 v68, v68
    v_exp_f32 v69, v69
    v_smfmac_f32_32x32x32_bf16 v[184:199], v[32:35], v[48:55], v175
    ds_read_b64_tr_b16 v[20:21], v172 offset:640
    v_exp_f32 v70, v70
    v_exp_f32 v71, v71
    v_exp_f32 v56, v56
    v_exp_f32 v57, v57
    v_smfmac_f32_32x32x32_bf16 v[200:215], v[32:35], v[64:71], v175
    ds_read_b64_tr_b16 v[22:23], v172 offset:4992
    v_exp_f32 v58, v58
    v_exp_f32 v59, v59
    v_exp_f32 v60, v60
    v_exp_f32 v61, v61
    v_mfma_f32_32x32x16_bf16 v[80:95], v[24:27], v[8:11], v[80:95]
    ds_read_b128 v[36:39], v174 offset:576
    v_exp_f32 v62, v62
    v_exp_f32 v63, v63
    v_exp_f32 v72, v72
    v_exp_f32 v73, v73
    v_mfma_f32_32x32x16_bf16 v[96:111], v[24:27], v[12:15], v[96:111]
    ds_read_b64_tr_b16 v[30:31], v173 offset:640
    v_exp_f32 v74, v74
    v_exp_f32 v75, v75
    v_exp_f32 v76, v76
    v_exp_f32 v77, v77
    v_smfmac_f32_32x32x32_bf16 v[184:199], v[40:43], v[56:63], v175
    v_exp_f32 v78, v78
    v_exp_f32 v79, v79
    v_exp_f32 v80, v80
    v_exp_f32 v81, v81
    v_smfmac_f32_32x32x32_bf16 v[200:215], v[40:43], v[72:79], v175
    s_waitcnt lgkmcnt(0)
    v_exp_f32 v82, v82
    v_exp_f32_e64 v83, v83
    v_exp_f32 v84, v84
    v_exp_f32 v85, v85
    v_mfma_f32_32x32x4_2b_bf16 v[48:79], v[30:31], v[16:17], 0 cbsz:1 abid:0
    ds_read_b128 v[40:43], v174 offset:672
    v_exp_f32 v86, v86
    v_exp_f32 v87, v87
    v_exp_f32 v96, v96
    v_exp_f32 v97, v97
    v_exp_f32 v98, v98
    v_exp_f32 v99, v99
    v_exp_f32 v100, v100
    v_exp_f32 v101, v101
    v_smfmac_f32_32x32x32_bf16 v[184:199], v[36:39], v[80:87], v175
    ds_read_b64_tr_b16 v[24:25], v172 offset:704
    v_exp_f32 v102, v102
    v_exp_f32 v103, v103
    v_exp_f32 v88, v88
    v_exp_f32 v89, v89
    v_smfmac_f32_32x32x32_bf16 v[200:215], v[36:39], v[96:103], v175
    ds_read_b64_tr_b16 v[26:27], v172 offset:5056
    v_exp_f32 v90, v90
    v_exp_f32 v91, v91
    v_exp_f32 v92, v92
    v_exp_f32 v93, v93
    v_mfma_f32_32x32x16_bf16 v[48:63], v[20:23], v[8:11], v[48:63]
    ds_read_b128 v[32:35], v174 offset:640
    v_exp_f32 v94, v94
    v_exp_f32 v95, v95
    v_exp_f32 v104, v104
    v_exp_f32 v105, v105
    v_mfma_f32_32x32x16_bf16 v[64:79], v[20:23], v[12:15], v[64:79]
    v_exp_f32 v106, v106
    v_exp_f32 v107, v107
    v_exp_f32 v108, v108
    v_exp_f32 v109, v109
    v_smfmac_f32_32x32x32_bf16 v[184:199], v[44:47], v[88:95], v175
    v_exp_f32 v110, v110
    v_exp_f32 v111, v111
    v_exp_f32 v48, v48
    v_exp_f32 v49, v49
    v_smfmac_f32_32x32x32_bf16 v[200:215], v[44:47], v[104:111], v175
    s_waitcnt lgkmcnt(0)
    v_exp_f32 v50, v50
    v_exp_f32_e64 v51, v51
    v_exp_f32 v52, v52
    v_exp_f32 v53, v53
    v_mfma_f32_32x32x4_2b_bf16 v[80:111], v[30:31], v[16:17], 0 cbsz:1 abid:1
    ds_read_b128 v[44:47], v174 offset:736
    v_exp_f32 v54, v54
    v_exp_f32 v55, v55
    v_exp_f32 v64, v64
    v_exp_f32 v65, v65
    v_exp_f32 v66, v66
    v_exp_f32 v67, v67
    v_exp_f32 v68, v68
    v_exp_f32 v69, v69
    v_smfmac_f32_32x32x32_bf16 v[184:199], v[32:35], v[48:55], v175
    ds_read_b64_tr_b16 v[20:21], v172 offset:768
    v_exp_f32 v70, v70
    v_exp_f32 v71, v71
    v_exp_f32 v56, v56
    v_exp_f32 v57, v57
    v_smfmac_f32_32x32x32_bf16 v[200:215], v[32:35], v[64:71], v175
    ds_read_b64_tr_b16 v[22:23], v172 offset:5120
    v_exp_f32 v58, v58
    v_exp_f32 v59, v59
    v_exp_f32 v60, v60
    v_exp_f32 v61, v61
    v_mfma_f32_32x32x16_bf16 v[80:95], v[24:27], v[8:11], v[80:95]
    ds_read_b128 v[36:39], v174 offset:704
    v_exp_f32 v62, v62
    v_exp_f32 v63, v63
    v_exp_f32 v72, v72
    v_exp_f32 v73, v73
    v_mfma_f32_32x32x16_bf16 v[96:111], v[24:27], v[12:15], v[96:111]
    ds_read_b64_tr_b16 v[28:29], v173 offset:768
    v_exp_f32 v74, v74
    v_exp_f32 v75, v75
    v_exp_f32 v76, v76
    v_exp_f32 v77, v77
    v_smfmac_f32_32x32x32_bf16 v[184:199], v[40:43], v[56:63], v175
    v_exp_f32 v78, v78
    v_exp_f32 v79, v79
    v_exp_f32 v80, v80
    v_exp_f32 v81, v81
    v_smfmac_f32_32x32x32_bf16 v[200:215], v[40:43], v[72:79], v175
    s_waitcnt lgkmcnt(0)
    v_exp_f32 v82, v82
    v_exp_f32_e64 v83, v83
    v_exp_f32 v84, v84
    v_exp_f32 v85, v85
    v_mfma_f32_32x32x4_2b_bf16 v[48:79], v[28:29], v[16:17], 0 cbsz:1 abid:0
    ds_read_b128 v[40:43], v174 offset:800
    v_exp_f32 v86, v86
    v_exp_f32 v87, v87
    v_exp_f32 v96, v96
    v_exp_f32 v97, v97
    v_exp_f32 v98, v98
    v_exp_f32 v99, v99
    v_exp_f32 v100, v100
    v_exp_f32 v101, v101
    v_smfmac_f32_32x32x32_bf16 v[184:199], v[36:39], v[80:87], v175
    ds_read_b64_tr_b16 v[24:25], v172 offset:832
    v_exp_f32 v102, v102
    v_exp_f32 v103, v103
    v_exp_f32 v88, v88
    v_exp_f32 v89, v89
    v_smfmac_f32_32x32x32_bf16 v[200:215], v[36:39], v[96:103], v175
    ds_read_b64_tr_b16 v[26:27], v172 offset:5184
    v_exp_f32 v90, v90
    v_exp_f32 v91, v91
    v_exp_f32 v92, v92
    v_exp_f32 v93, v93
    v_mfma_f32_32x32x16_bf16 v[48:63], v[20:23], v[8:11], v[48:63]
    ds_read_b128 v[32:35], v174 offset:768
    v_exp_f32 v94, v94
    v_exp_f32 v95, v95
    v_exp_f32 v104, v104
    v_exp_f32 v105, v105
    v_mfma_f32_32x32x16_bf16 v[64:79], v[20:23], v[12:15], v[64:79]
    v_exp_f32 v106, v106
    v_exp_f32 v107, v107
    v_exp_f32 v108, v108
    v_exp_f32 v109, v109
    v_smfmac_f32_32x32x32_bf16 v[184:199], v[44:47], v[88:95], v175
    v_exp_f32 v110, v110
    v_exp_f32 v111, v111
    v_exp_f32 v48, v48
    v_exp_f32 v49, v49
    v_smfmac_f32_32x32x32_bf16 v[200:215], v[44:47], v[104:111], v175
    s_waitcnt lgkmcnt(0)
    v_exp_f32 v50, v50
    v_exp_f32_e64 v51, v51
    v_exp_f32 v52, v52
    v_exp_f32 v53, v53
    v_mfma_f32_32x32x4_2b_bf16 v[80:111], v[28:29], v[16:17], 0 cbsz:1 abid:1
    ds_read_b128 v[44:47], v174 offset:864
    v_exp_f32 v54, v54
    v_exp_f32 v55, v55
    v_exp_f32 v64, v64
    v_exp_f32 v65, v65
    v_exp_f32 v66, v66
    v_exp_f32 v67, v67
    v_exp_f32 v68, v68
    v_exp_f32 v69, v69
    v_smfmac_f32_32x32x32_bf16 v[184:199], v[32:35], v[48:55], v175
    ds_read_b64_tr_b16 v[20:21], v172 offset:896
    v_exp_f32 v70, v70
    v_exp_f32 v71, v71
    v_exp_f32 v56, v56
    v_exp_f32 v57, v57
    v_smfmac_f32_32x32x32_bf16 v[200:215], v[32:35], v[64:71], v175
    ds_read_b64_tr_b16 v[22:23], v172 offset:5248
    v_exp_f32 v58, v58
    v_exp_f32 v59, v59
    v_exp_f32 v60, v60
    v_exp_f32 v61, v61
    v_mfma_f32_32x32x16_bf16 v[80:95], v[24:27], v[8:11], v[80:95]
    ds_read_b128 v[36:39], v174 offset:832
    v_exp_f32 v62, v62
    v_exp_f32 v63, v63
    v_exp_f32 v72, v72
    v_exp_f32 v73, v73
    v_mfma_f32_32x32x16_bf16 v[96:111], v[24:27], v[12:15], v[96:111]
    ds_read_b64_tr_b16 v[30:31], v173 offset:896
    v_exp_f32 v74, v74
    v_exp_f32 v75, v75
    v_exp_f32 v76, v76
    v_exp_f32 v77, v77
    v_smfmac_f32_32x32x32_bf16 v[184:199], v[40:43], v[56:63], v175
    v_exp_f32 v78, v78
    v_exp_f32 v79, v79
    v_exp_f32 v80, v80
    v_exp_f32 v81, v81
    v_smfmac_f32_32x32x32_bf16 v[200:215], v[40:43], v[72:79], v175
    s_waitcnt lgkmcnt(0)
    v_exp_f32 v82, v82
    v_exp_f32_e64 v83, v83
    v_exp_f32 v84, v84
    v_exp_f32 v85, v85
    v_mfma_f32_32x32x4_2b_bf16 v[48:79], v[30:31], v[16:17], 0 cbsz:1 abid:0
    ds_read_b128 v[40:43], v174 offset:928
    v_exp_f32 v86, v86
    v_exp_f32 v87, v87
    v_exp_f32 v96, v96
    v_exp_f32 v97, v97
    v_exp_f32 v98, v98
    v_exp_f32 v99, v99
    v_exp_f32 v100, v100
    v_exp_f32 v101, v101
    v_smfmac_f32_32x32x32_bf16 v[184:199], v[36:39], v[80:87], v175
    ds_read_b64_tr_b16 v[24:25], v172 offset:960
    v_exp_f32 v102, v102
    v_exp_f32 v103, v103
    v_exp_f32 v88, v88
    v_exp_f32 v89, v89
    v_smfmac_f32_32x32x32_bf16 v[200:215], v[36:39], v[96:103], v175
    ds_read_b64_tr_b16 v[26:27], v172 offset:5312
    v_exp_f32 v90, v90
    v_exp_f32 v91, v91
    v_exp_f32 v92, v92
    v_exp_f32 v93, v93
    v_mfma_f32_32x32x16_bf16 v[48:63], v[20:23], v[8:11], v[48:63]
    ds_read_b128 v[32:35], v174 offset:896
    v_exp_f32 v94, v94
    v_exp_f32 v95, v95
    v_exp_f32 v104, v104
    v_exp_f32 v105, v105
    v_mfma_f32_32x32x16_bf16 v[64:79], v[20:23], v[12:15], v[64:79]
    ds_read_b32 v169, v170 offset:32
    v_exp_f32 v106, v106
    v_exp_f32 v107, v107
    v_exp_f32 v108, v108
    v_exp_f32 v109, v109
    v_smfmac_f32_32x32x32_bf16 v[184:199], v[44:47], v[88:95], v175
    v_exp_f32 v110, v110
    v_exp_f32 v111, v111
    v_exp_f32 v48, v48
    v_exp_f32 v49, v49
    v_smfmac_f32_32x32x32_bf16 v[200:215], v[44:47], v[104:111], v175
    s_waitcnt lgkmcnt(0)
    v_cmp_gt_u32 vcc, 4, v169
    s_cbranch_vccnz L_ll5
L_ll5_x:
    v_exp_f32 v50, v50
    v_exp_f32_e64 v51, v51
    v_exp_f32 v52, v52
    v_exp_f32 v53, v53
    v_mfma_f32_32x32x4_2b_bf16 v[80:111], v[30:31], v[16:17], 0 cbsz:1 abid:1
    ds_read_b128 v[44:47], v174 offset:992
    v_exp_f32 v54, v54
    v_exp_f32 v55, v55
    v_exp_f32 v64, v64
    v_exp_f32 v65, v65
    v_exp_f32 v66, v66
    v_exp_f32 v67, v67
    v_exp_f32 v68, v68
    v_exp_f32 v69, v69
    v_smfmac_f32_32x32x32_bf16 v[184:199], v[32:35], v[48:55], v175
    v_add_u32 v172, 38400, v172
    ds_read_b64_tr_b16 v[20:21], v172 offset:0
    v_exp_f32 v70, v70
    v_exp_f32 v71, v71
    v_exp_f32 v56, v56
    v_exp_f32 v57, v57
    v_smfmac_f32_32x32x32_bf16 v[200:215], v[32:35], v[64:71], v175
    ds_read_b64_tr_b16 v[22:23], v172 offset:4352
    v_exp_f32 v58, v58
    v_exp_f32 v59, v59
    v_exp_f32 v60, v60
    v_exp_f32 v61, v61
    v_mfma_f32_32x32x16_bf16 v[80:95], v[24:27], v[8:11], v[80:95]
    ds_read_b128 v[36:39], v174 offset:960
    v_exp_f32 v62, v62
    v_exp_f32 v63, v63
    v_exp_f32 v72, v72
    v_exp_f32 v73, v73
    v_mfma_f32_32x32x16_bf16 v[96:111], v[24:27], v[12:15], v[96:111]
    v_add_u32_e64 v173, v173, v176
    ds_read_b64_tr_b16 v[28:29], v173 offset:0
    v_exp_f32 v74, v74
    v_exp_f32 v75, v75
    v_exp_f32 v76, v76
    v_exp_f32 v77, v77
    v_smfmac_f32_32x32x32_bf16 v[184:199], v[40:43], v[56:63], v175
    v_exp_f32 v78, v78
    v_exp_f32 v79, v79
    v_exp_f32 v80, v80
    v_exp_f32 v81, v81
    v_smfmac_f32_32x32x32_bf16 v[200:215], v[40:43], v[72:79], v175
    s_waitcnt lgkmcnt(0)
    v_exp_f32 v82, v82
    v_exp_f32_e64 v83, v83
    v_exp_f32 v84, v84
    v_exp_f32 v85, v85
    v_mfma_f32_32x32x4_2b_bf16 v[48:79], v[28:29], v[16:17], 0 cbsz:1 abid:0
    v_add_u32_e64 v174, v174, v177
    ds_read_b128 v[40:43], v174 offset:32
    v_exp_f32 v86, v86
    v_exp_f32 v87, v87
    v_exp_f32 v96, v96
    v_exp_f32 v97, v97
    v_exp_f32 v98, v98
    v_exp_f32 v99, v99
    v_exp_f32 v100, v100
    v_exp_f32 v101, v101
    v_smfmac_f32_32x32x32_bf16 v[184:199], v[36:39], v[80:87], v175
    ds_read_b64_tr_b16 v[24:25], v172 offset:64
    v_exp_f32 v102, v102
    v_exp_f32 v103, v103
    v_exp_f32 v88, v88
    v_exp_f32 v89, v89
    v_smfmac_f32_32x32x32_bf16 v[200:215], v[36:39], v[96:103], v175
    ds_read_b64_tr_b16 v[26:27], v172 offset:4416
    v_exp_f32 v90, v90
    v_exp_f32 v91, v91
    v_exp_f32 v92, v92
    v_exp_f32 v93, v93
    v_mfma_f32_32x32x16_bf16 v[48:63], v[20:23], v[8:11], v[48:63]
    ds_read_b128 v[32:35], v174 offset:0
    v_exp_f32 v94, v94
    v_exp_f32 v95, v95
    v_exp_f32 v104, v104
    v_exp_f32 v105, v105
    v_mfma_f32_32x32x16_bf16 v[64:79], v[20:23], v[12:15], v[64:79]
    v_exp_f32 v106, v106
    v_exp_f32 v107, v107
    v_exp_f32 v108, v108
    v_exp_f32 v109, v109
    v_smfmac_f32_32x32x32_bf16 v[184:199], v[44:47], v[88:95], v175
    v_exp_f32 v110, v110
    v_exp_f32 v111, v111
    v_exp_f32 v48, v48
    v_exp_f32 v49, v49
    v_smfmac_f32_32x32x32_bf16 v[200:215], v[44:47], v[104:111], v175
    s_waitcnt lgkmcnt(0)
    v_exp_f32 v50, v50
    v_exp_f32_e64 v51, v51
    v_exp_f32 v52, v52
    v_exp_f32 v53, v53
    v_mfma_f32_32x32x4_2b_bf16 v[80:111], v[28:29], v[16:17], 0 cbsz:1 abid:1
    ds_read_b128 v[44:47], v174 offset:96
    v_exp_f32 v54, v54
    v_exp_f32 v55, v55
    v_exp_f32 v64, v64
    v_exp_f32 v65, v65
    v_exp_f32 v66, v66
    v_exp_f32 v67, v67
    v_exp_f32 v68, v68
    v_exp_f32 v69, v69
    v_smfmac_f32_32x32x32_bf16 v[184:199], v[32:35], v[48:55], v175
    ds_read_b64_tr_b16 v[20:21], v172 offset:128
    v_exp_f32 v70, v70
    v_exp_f32 v71, v71
    v_exp_f32 v56, v56
    v_exp_f32 v57, v57
    v_smfmac_f32_32x32x32_bf16 v[200:215], v[32:35], v[64:71], v175
    ds_read_b64_tr_b16 v[22:23], v172 offset:4480
    v_exp_f32 v58, v58
    v_exp_f32 v59, v59
    v_exp_f32 v60, v60
    v_exp_f32 v61, v61
    v_mfma_f32_32x32x16_bf16 v[80:95], v[24:27], v[8:11], v[80:95]
    ds_read_b128 v[36:39], v174 offset:64
    v_exp_f32 v62, v62
    v_exp_f32 v63, v63
    v_exp_f32 v72, v72
    v_exp_f32 v73, v73
    v_mfma_f32_32x32x16_bf16 v[96:111], v[24:27], v[12:15], v[96:111]
    ds_read_b64_tr_b16 v[30:31], v173 offset:128
    v_exp_f32 v74, v74
    v_exp_f32 v75, v75
    v_exp_f32 v76, v76
    v_exp_f32 v77, v77
    v_smfmac_f32_32x32x32_bf16 v[184:199], v[40:43], v[56:63], v175
    v_exp_f32 v78, v78
    v_exp_f32 v79, v79
    v_exp_f32 v80, v80
    v_exp_f32 v81, v81
    v_smfmac_f32_32x32x32_bf16 v[200:215], v[40:43], v[72:79], v175
    s_waitcnt lgkmcnt(0)
    v_exp_f32 v82, v82
    v_exp_f32_e64 v83, v83
    v_exp_f32 v84, v84
    v_exp_f32 v85, v85
    v_mfma_f32_32x32x4_2b_bf16 v[48:79], v[30:31], v[16:17], 0 cbsz:1 abid:0
    ds_read_b128 v[40:43], v174 offset:160
    v_exp_f32 v86, v86
    v_exp_f32 v87, v87
    v_exp_f32 v96, v96
    v_exp_f32 v97, v97
    v_exp_f32 v98, v98
    v_exp_f32 v99, v99
    v_exp_f32 v100, v100
    v_exp_f32 v101, v101
    v_smfmac_f32_32x32x32_bf16 v[184:199], v[36:39], v[80:87], v175
    ds_read_b64_tr_b16 v[24:25], v172 offset:192
    v_exp_f32 v102, v102
    v_exp_f32 v103, v103
    v_exp_f32 v88, v88
    v_exp_f32 v89, v89
    v_smfmac_f32_32x32x32_bf16 v[200:215], v[36:39], v[96:103], v175
    ds_read_b64_tr_b16 v[26:27], v172 offset:4544
    v_exp_f32 v90, v90
    v_exp_f32 v91, v91
    v_exp_f32 v92, v92
    v_exp_f32 v93, v93
    v_mfma_f32_32x32x16_bf16 v[48:63], v[20:23], v[8:11], v[48:63]
    ds_read_b128 v[32:35], v174 offset:128
    v_exp_f32 v94, v94
    v_exp_f32 v95, v95
    v_exp_f32 v104, v104
    v_exp_f32 v105, v105
    v_mfma_f32_32x32x16_bf16 v[64:79], v[20:23], v[12:15], v[64:79]
    v_exp_f32 v106, v106
    v_exp_f32 v107, v107
    v_exp_f32 v108, v108
    v_exp_f32 v109, v109
    v_smfmac_f32_32x32x32_bf16 v[184:199], v[44:47], v[88:95], v175
    v_exp_f32 v110, v110
    v_exp_f32 v111, v111
    v_exp_f32 v48, v48
    v_exp_f32 v49, v49
    v_smfmac_f32_32x32x32_bf16 v[200:215], v[44:47], v[104:111], v175
    s_waitcnt lgkmcnt(0)
    v_exp_f32 v50, v50
    v_exp_f32_e64 v51, v51
    v_exp_f32 v52, v52
    v_exp_f32 v53, v53
    v_mfma_f32_32x32x4_2b_bf16 v[80:111], v[30:31], v[16:17], 0 cbsz:1 abid:1
    ds_read_b128 v[44:47], v174 offset:224
    v_exp_f32 v54, v54
    v_exp_f32 v55, v55
    v_exp_f32 v64, v64
    v_exp_f32 v65, v65
    v_exp_f32 v66, v66
    v_exp_f32 v67, v67
    v_exp_f32 v68, v68
    v_exp_f32 v69, v69
    v_smfmac_f32_32x32x32_bf16 v[184:199], v[32:35], v[48:55], v175
    ds_read_b64_tr_b16 v[20:21], v172 offset:256
    v_exp_f32 v70, v70
    v_exp_f32 v71, v71
    v_exp_f32 v56, v56
    v_exp_f32 v57, v57
    v_smfmac_f32_32x32x32_bf16 v[200:215], v[32:35], v[64:71], v175
    ds_read_b64_tr_b16 v[22:23], v172 offset:4608
    v_exp_f32 v58, v58
    v_exp_f32 v59, v59
    v_exp_f32 v60, v60
    v_exp_f32 v61, v61
    v_mfma_f32_32x32x16_bf16 v[80:95], v[24:27], v[8:11], v[80:95]
    ds_read_b128 v[36:39], v174 offset:192
    v_exp_f32 v62, v62
    v_exp_f32 v63, v63
    v_exp_f32 v72, v72
    v_exp_f32 v73, v73
    v_mfma_f32_32x32x16_bf16 v[96:111], v[24:27], v[12:15], v[96:111]
    ds_read_b64_tr_b16 v[28:29], v173 offset:256
    v_exp_f32 v74, v74
    v_exp_f32 v75, v75
    v_exp_f32 v76, v76
    v_exp_f32 v77, v77
    v_smfmac_f32_32x32x32_bf16 v[184:199], v[40:43], v[56:63], v175
    v_exp_f32 v78, v78
    v_exp_f32 v79, v79
    v_exp_f32 v80, v80
    v_exp_f32 v81, v81
    v_smfmac_f32_32x32x32_bf16 v[200:215], v[40:43], v[72:79], v175
    s_waitcnt lgkmcnt(0)
    v_exp_f32 v82, v82
    v_exp_f32_e64 v83, v83
    v_exp_f32 v84, v84
    v_exp_f32 v85, v85
    v_mfma_f32_32x32x4_2b_bf16 v[48:79], v[28:29], v[16:17], 0 cbsz:1 abid:0
    ds_read_b128 v[40:43], v174 offset:288
    v_exp_f32 v86, v86
    v_exp_f32 v87, v87
    v_exp_f32 v96, v96
    v_exp_f32 v97, v97
    v_exp_f32 v98, v98
    v_exp_f32 v99, v99
    v_exp_f32 v100, v100
    v_exp_f32 v101, v101
    v_smfmac_f32_32x32x32_bf16 v[184:199], v[36:39], v[80:87], v175
    ds_read_b64_tr_b16 v[24:25], v172 offset:320
    v_exp_f32 v102, v102
    v_exp_f32 v103, v103
    v_exp_f32 v88, v88
    v_exp_f32 v89, v89
    v_smfmac_f32_32x32x32_bf16 v[200:215], v[36:39], v[96:103], v175
    ds_read_b64_tr_b16 v[26:27], v172 offset:4672
    v_exp_f32 v90, v90
    v_exp_f32 v91, v91
    v_exp_f32 v92, v92
    v_exp_f32 v93, v93
    v_mfma_f32_32x32x16_bf16 v[48:63], v[20:23], v[8:11], v[48:63]
    ds_read_b128 v[32:35], v174 offset:256
    v_exp_f32 v94, v94
    v_exp_f32 v95, v95
    v_exp_f32 v104, v104
    v_exp_f32 v105, v105
    v_mfma_f32_32x32x16_bf16 v[64:79], v[20:23], v[12:15], v[64:79]
    v_exp_f32 v106, v106
    v_exp_f32 v107, v107
    v_exp_f32 v108, v108
    v_exp_f32 v109, v109
    v_smfmac_f32_32x32x32_bf16 v[184:199], v[44:47], v[88:95], v175
    v_exp_f32 v110, v110
    v_exp_f32 v111, v111
    v_exp_f32 v48, v48
    v_exp_f32 v49, v49
    v_smfmac_f32_32x32x32_bf16 v[200:215], v[44:47], v[104:111], v175
    s_waitcnt lgkmcnt(0)
    v_exp_f32 v50, v50
    v_exp_f32_e64 v51, v51
    v_exp_f32 v52, v52
    v_exp_f32 v53, v53
    v_mfma_f32_32x32x4_2b_bf16 v[80:111], v[28:29], v[16:17], 0 cbsz:1 abid:1
    ds_read_b128 v[44:47], v174 offset:352
    v_exp_f32 v54, v54
    v_exp_f32 v55, v55
    v_exp_f32 v64, v64
    v_exp_f32 v65, v65
    v_exp_f32 v66, v66
    v_exp_f32 v67, v67
    v_exp_f32 v68, v68
    v_exp_f32 v69, v69
    v_smfmac_f32_32x32x32_bf16 v[184:199], v[32:35], v[48:55], v175
    ds_read_b64_tr_b16 v[20:21], v172 offset:384
    v_exp_f32 v70, v70
    v_exp_f32 v71, v71
    v_exp_f32 v56, v56
    v_exp_f32 v57, v57
    v_smfmac_f32_32x32x32_bf16 v[200:215], v[32:35], v[64:71], v175
    ds_read_b64_tr_b16 v[22:23], v172 offset:4736
    v_exp_f32 v58, v58
    v_exp_f32 v59, v59
    v_exp_f32 v60, v60
    v_exp_f32 v61, v61
    v_mfma_f32_32x32x16_bf16 v[80:95], v[24:27], v[8:11], v[80:95]
    ds_read_b128 v[36:39], v174 offset:320
    v_exp_f32 v62, v62
    v_exp_f32 v63, v63
    v_exp_f32 v72, v72
    v_exp_f32 v73, v73
    v_mfma_f32_32x32x16_bf16 v[96:111], v[24:27], v[12:15], v[96:111]
    ds_read_b64_tr_b16 v[30:31], v173 offset:384
    v_exp_f32 v74, v74
    v_exp_f32 v75, v75
    v_exp_f32 v76, v76
    v_exp_f32 v77, v77
    v_smfmac_f32_32x32x32_bf16 v[184:199], v[40:43], v[56:63], v175
    v_exp_f32 v78, v78
    v_exp_f32 v79, v79
    v_exp_f32 v80, v80
    v_exp_f32 v81, v81
    v_smfmac_f32_32x32x32_bf16 v[200:215], v[40:43], v[72:79], v175
    s_waitcnt lgkmcnt(0)
    v_exp_f32 v82, v82
    v_exp_f32_e64 v83, v83
    v_exp_f32 v84, v84
    v_exp_f32 v85, v85
    v_mfma_f32_32x32x4_2b_bf16 v[48:79], v[30:31], v[16:17], 0 cbsz:1 abid:0
    ds_read_b128 v[40:43], v174 offset:416
    v_exp_f32 v86, v86
    v_exp_f32 v87, v87
    v_exp_f32 v96, v96
    v_exp_f32 v97, v97
    v_exp_f32 v98, v98
    v_exp_f32 v99, v99
    v_exp_f32 v100, v100
    v_exp_f32 v101, v101
    v_smfmac_f32_32x32x32_bf16 v[184:199], v[36:39], v[80:87], v175
    ds_read_b64_tr_b16 v[24:25], v172 offset:448
    v_exp_f32 v102, v102
    v_exp_f32 v103, v103
    v_exp_f32 v88, v88
    v_exp_f32 v89, v89
    v_smfmac_f32_32x32x32_bf16 v[200:215], v[36:39], v[96:103], v175
    ds_read_b64_tr_b16 v[26:27], v172 offset:4800
    v_exp_f32 v90, v90
    v_exp_f32 v91, v91
    v_exp_f32 v92, v92
    v_exp_f32 v93, v93
    v_mfma_f32_32x32x16_bf16 v[48:63], v[20:23], v[8:11], v[48:63]
    ds_read_b128 v[32:35], v174 offset:384
    v_exp_f32 v94, v94
    v_exp_f32 v95, v95
    v_exp_f32 v104, v104
    v_exp_f32 v105, v105
    v_mfma_f32_32x32x16_bf16 v[64:79], v[20:23], v[12:15], v[64:79]
    v_exp_f32 v106, v106
    v_exp_f32 v107, v107
    v_exp_f32 v108, v108
    v_exp_f32 v109, v109
    v_smfmac_f32_32x32x32_bf16 v[184:199], v[44:47], v[88:95], v175
    v_exp_f32 v110, v110
    v_exp_f32 v111, v111
    v_exp_f32 v48, v48
    v_exp_f32 v49, v49
    v_smfmac_f32_32x32x32_bf16 v[200:215], v[44:47], v[104:111], v175
    s_waitcnt lgkmcnt(0)
    v_exp_f32 v50, v50
    v_exp_f32_e64 v51, v51
    v_exp_f32 v52, v52
    v_exp_f32 v53, v53
    v_mfma_f32_32x32x4_2b_bf16 v[80:111], v[30:31], v[16:17], 0 cbsz:1 abid:1
    ds_read_b128 v[44:47], v174 offset:480
    v_exp_f32 v54, v54
    v_exp_f32 v55, v55
    v_exp_f32 v64, v64
    v_exp_f32 v65, v65
    v_exp_f32 v66, v66
    v_exp_f32 v67, v67
    v_exp_f32 v68, v68
    v_exp_f32 v69, v69
    v_smfmac_f32_32x32x32_bf16 v[184:199], v[32:35], v[48:55], v175
    ds_read_b64_tr_b16 v[20:21], v172 offset:512
    v_exp_f32 v70, v70
    v_exp_f32 v71, v71
    v_exp_f32 v56, v56
    v_exp_f32 v57, v57
    v_smfmac_f32_32x32x32_bf16 v[200:215], v[32:35], v[64:71], v175
    ds_read_b64_tr_b16 v[22:23], v172 offset:4864
    v_exp_f32 v58, v58
    v_exp_f32 v59, v59
    v_exp_f32 v60, v60
    v_exp_f32 v61, v61
    v_mfma_f32_32x32x16_bf16 v[80:95], v[24:27], v[8:11], v[80:95]
    ds_read_b128 v[36:39], v174 offset:448
    v_exp_f32 v62, v62
    v_exp_f32 v63, v63
    v_exp_f32 v72, v72
    v_exp_f32 v73, v73
    v_mfma_f32_32x32x16_bf16 v[96:111], v[24:27], v[12:15], v[96:111]
    ds_read_b64_tr_b16 v[28:29], v173 offset:512
    v_exp_f32 v74, v74
    v_exp_f32 v75, v75
    v_exp_f32 v76, v76
    v_exp_f32 v77, v77
    v_smfmac_f32_32x32x32_bf16 v[184:199], v[40:43], v[56:63], v175
    v_exp_f32 v78, v78
    v_exp_f32 v79, v79
    v_exp_f32 v80, v80
    v_exp_f32 v81, v81
    v_smfmac_f32_32x32x32_bf16 v[200:215], v[40:43], v[72:79], v175
    s_waitcnt lgkmcnt(0)
    v_exp_f32 v82, v82
    v_exp_f32_e64 v83, v83
    v_exp_f32 v84, v84
    v_exp_f32 v85, v85
    v_mfma_f32_32x32x4_2b_bf16 v[48:79], v[28:29], v[16:17], 0 cbsz:1 abid:0
    ds_read_b128 v[40:43], v174 offset:544
    v_exp_f32 v86, v86
    v_exp_f32 v87, v87
    v_exp_f32 v96, v96
    v_exp_f32 v97, v97
    v_exp_f32 v98, v98
    v_exp_f32 v99, v99
    v_exp_f32 v100, v100
    v_exp_f32 v101, v101
    v_smfmac_f32_32x32x32_bf16 v[184:199], v[36:39], v[80:87], v175
    ds_read_b64_tr_b16 v[24:25], v172 offset:576
    v_exp_f32 v102, v102
    v_exp_f32 v103, v103
    v_exp_f32 v88, v88
    v_exp_f32 v89, v89
    v_smfmac_f32_32x32x32_bf16 v[200:215], v[36:39], v[96:103], v175
    ds_read_b64_tr_b16 v[26:27], v172 offset:4928
    v_exp_f32 v90, v90
    v_exp_f32 v91, v91
    v_exp_f32 v92, v92
    v_exp_f32 v93, v93
    v_mfma_f32_32x32x16_bf16 v[48:63], v[20:23], v[8:11], v[48:63]
    ds_read_b128 v[32:35], v174 offset:512
    v_exp_f32 v94, v94
    v_exp_f32 v95, v95
    v_exp_f32 v104, v104
    v_exp_f32 v105, v105
    v_mfma_f32_32x32x16_bf16 v[64:79], v[20:23], v[12:15], v[64:79]
    v_exp_f32 v106, v106
    v_exp_f32 v107, v107
    v_exp_f32 v108, v108
    v_exp_f32 v109, v109
    v_smfmac_f32_32x32x32_bf16 v[184:199], v[44:47], v[88:95], v175
    v_exp_f32 v110, v110
    v_exp_f32 v111, v111
    v_exp_f32 v48, v48
    v_exp_f32 v49, v49
    v_smfmac_f32_32x32x32_bf16 v[200:215], v[44:47], v[104:111], v175
    s_waitcnt lgkmcnt(0)
    v_exp_f32 v50, v50
    v_exp_f32_e64 v51, v51
    v_exp_f32 v52, v52
    v_exp_f32 v53, v53
    v_mfma_f32_32x32x4_2b_bf16 v[80:111], v[28:29], v[16:17], 0 cbsz:1 abid:1
    ds_read_b128 v[44:47], v174 offset:608
    v_exp_f32 v54, v54
    v_exp_f32 v55, v55
    v_exp_f32 v64, v64
    v_exp_f32 v65, v65
    v_exp_f32 v66, v66
    v_exp_f32 v67, v67
    v_exp_f32 v68, v68
    v_exp_f32 v69, v69
    v_smfmac_f32_32x32x32_bf16 v[184:199], v[32:35], v[48:55], v175
    ds_read_b64_tr_b16 v[20:21], v172 offset:640
    v_exp_f32 v70, v70
    v_exp_f32 v71, v71
    v_exp_f32 v56, v56
    v_exp_f32 v57, v57
    v_smfmac_f32_32x32x32_bf16 v[200:215], v[32:35], v[64:71], v175
    ds_read_b64_tr_b16 v[22:23], v172 offset:4992
    v_exp_f32 v58, v58
    v_exp_f32 v59, v59
    v_exp_f32 v60, v60
    v_exp_f32 v61, v61
    v_mfma_f32_32x32x16_bf16 v[80:95], v[24:27], v[8:11], v[80:95]
    ds_read_b128 v[36:39], v174 offset:576
    v_exp_f32 v62, v62
    v_exp_f32 v63, v63
    v_exp_f32 v72, v72
    v_exp_f32 v73, v73
    v_mfma_f32_32x32x16_bf16 v[96:111], v[24:27], v[12:15], v[96:111]
    ds_read_b64_tr_b16 v[30:31], v173 offset:640
    v_exp_f32 v74, v74
    v_exp_f32 v75, v75
    v_exp_f32 v76, v76
    v_exp_f32 v77, v77
    v_smfmac_f32_32x32x32_bf16 v[184:199], v[40:43], v[56:63], v175
    v_exp_f32 v78, v78
    v_exp_f32 v79, v79
    v_exp_f32 v80, v80
    v_exp_f32 v81, v81
    v_smfmac_f32_32x32x32_bf16 v[200:215], v[40:43], v[72:79], v175
    s_waitcnt lgkmcnt(0)
    v_exp_f32 v82, v82
    v_exp_f32_e64 v83, v83
    v_exp_f32 v84, v84
    v_exp_f32 v85, v85
    v_mfma_f32_32x32x4_2b_bf16 v[48:79], v[30:31], v[16:17], 0 cbsz:1 abid:0
    ds_read_b128 v[40:43], v174 offset:672
    v_exp_f32 v86, v86
    v_exp_f32 v87, v87
    v_exp_f32 v96, v96
    v_exp_f32 v97, v97
    v_exp_f32 v98, v98
    v_exp_f32 v99, v99
    v_exp_f32 v100, v100
    v_exp_f32 v101, v101
    v_smfmac_f32_32x32x32_bf16 v[184:199], v[36:39], v[80:87], v175
    ds_read_b64_tr_b16 v[24:25], v172 offset:704
    v_exp_f32 v102, v102
    v_exp_f32 v103, v103
    v_exp_f32 v88, v88
    v_exp_f32 v89, v89
    v_smfmac_f32_32x32x32_bf16 v[200:215], v[36:39], v[96:103], v175
    ds_read_b64_tr_b16 v[26:27], v172 offset:5056
    v_exp_f32 v90, v90
    v_exp_f32 v91, v91
    v_exp_f32 v92, v92
    v_exp_f32 v93, v93
    v_mfma_f32_32x32x16_bf16 v[48:63], v[20:23], v[8:11], v[48:63]
    ds_read_b128 v[32:35], v174 offset:640
    v_exp_f32 v94, v94
    v_exp_f32 v95, v95
    v_exp_f32 v104, v104
    v_exp_f32 v105, v105
    v_mfma_f32_32x32x16_bf16 v[64:79], v[20:23], v[12:15], v[64:79]
    v_exp_f32 v106, v106
    v_exp_f32 v107, v107
    v_exp_f32 v108, v108
    v_exp_f32 v109, v109
    v_smfmac_f32_32x32x32_bf16 v[184:199], v[44:47], v[88:95], v175
    v_exp_f32 v110, v110
    v_exp_f32 v111, v111
    v_exp_f32 v48, v48
    v_exp_f32 v49, v49
    v_smfmac_f32_32x32x32_bf16 v[200:215], v[44:47], v[104:111], v175
    s_waitcnt lgkmcnt(0)
    v_exp_f32 v50, v50
    v_exp_f32_e64 v51, v51
    v_exp_f32 v52, v52
    v_exp_f32 v53, v53
    v_mfma_f32_32x32x4_2b_bf16 v[80:111], v[30:31], v[16:17], 0 cbsz:1 abid:1
    ds_read_b128 v[44:47], v174 offset:736
    v_exp_f32 v54, v54
    v_exp_f32 v55, v55
    v_exp_f32 v64, v64
    v_exp_f32 v65, v65
    v_exp_f32 v66, v66
    v_exp_f32 v67, v67
    v_exp_f32 v68, v68
    v_exp_f32 v69, v69
    v_smfmac_f32_32x32x32_bf16 v[184:199], v[32:35], v[48:55], v175
    ds_read_b64_tr_b16 v[20:21], v172 offset:768
    v_exp_f32 v70, v70
    v_exp_f32 v71, v71
    v_exp_f32 v56, v56
    v_exp_f32 v57, v57
    v_smfmac_f32_32x32x32_bf16 v[200:215], v[32:35], v[64:71], v175
    ds_read_b64_tr_b16 v[22:23], v172 offset:5120
    v_exp_f32 v58, v58
    v_exp_f32 v59, v59
    v_exp_f32 v60, v60
    v_exp_f32 v61, v61
    v_mfma_f32_32x32x16_bf16 v[80:95], v[24:27], v[8:11], v[80:95]
    ds_read_b128 v[36:39], v174 offset:704
    v_exp_f32 v62, v62
    v_exp_f32 v63, v63
    v_exp_f32 v72, v72
    v_exp_f32 v73, v73
    v_mfma_f32_32x32x16_bf16 v[96:111], v[24:27], v[12:15], v[96:111]
    ds_read_b64_tr_b16 v[28:29], v173 offset:768
    v_exp_f32 v74, v74
    v_exp_f32 v75, v75
    v_exp_f32 v76, v76
    v_exp_f32 v77, v77
    v_smfmac_f32_32x32x32_bf16 v[184:199], v[40:43], v[56:63], v175
    v_exp_f32 v78, v78
    v_exp_f32 v79, v79
    v_exp_f32 v80, v80
    v_exp_f32 v81, v81
    v_smfmac_f32_32x32x32_bf16 v[200:215], v[40:43], v[72:79], v175
    s_waitcnt lgkmcnt(0)
    v_exp_f32 v82, v82
    v_exp_f32_e64 v83, v83
    v_exp_f32 v84, v84
    v_exp_f32 v85, v85
    v_mfma_f32_32x32x4_2b_bf16 v[48:79], v[28:29], v[16:17], 0 cbsz:1 abid:0
    ds_read_b128 v[40:43], v174 offset:800
    v_exp_f32 v86, v86
    v_exp_f32 v87, v87
    v_exp_f32 v96, v96
    v_exp_f32 v97, v97
    v_exp_f32 v98, v98
    v_exp_f32 v99, v99
    v_exp_f32 v100, v100
    v_exp_f32 v101, v101
    v_smfmac_f32_32x32x32_bf16 v[184:199], v[36:39], v[80:87], v175
    ds_read_b64_tr_b16 v[24:25], v172 offset:832
    v_exp_f32 v102, v102
    v_exp_f32 v103, v103
    v_exp_f32 v88, v88
    v_exp_f32 v89, v89
    v_smfmac_f32_32x32x32_bf16 v[200:215], v[36:39], v[96:103], v175
    ds_read_b64_tr_b16 v[26:27], v172 offset:5184
    v_exp_f32 v90, v90
    v_exp_f32 v91, v91
    v_exp_f32 v92, v92
    v_exp_f32 v93, v93
    v_mfma_f32_32x32x16_bf16 v[48:63], v[20:23], v[8:11], v[48:63]
    ds_read_b128 v[32:35], v174 offset:768
    v_exp_f32 v94, v94
    v_exp_f32 v95, v95
    v_exp_f32 v104, v104
    v_exp_f32 v105, v105
    v_mfma_f32_32x32x16_bf16 v[64:79], v[20:23], v[12:15], v[64:79]
    v_exp_f32 v106, v106
    v_exp_f32 v107, v107
    v_exp_f32 v108, v108
    v_exp_f32 v109, v109
    v_smfmac_f32_32x32x32_bf16 v[184:199], v[44:47], v[88:95], v175
    v_exp_f32 v110, v110
    v_exp_f32 v111, v111
    v_exp_f32 v48, v48
    v_exp_f32 v49, v49
    v_smfmac_f32_32x32x32_bf16 v[200:215], v[44:47], v[104:111], v175
    s_waitcnt lgkmcnt(0)
    v_exp_f32 v50, v50
    v_exp_f32_e64 v51, v51
    v_exp_f32 v52, v52
    v_exp_f32 v53, v53
    v_mfma_f32_32x32x4_2b_bf16 v[80:111], v[28:29], v[16:17], 0 cbsz:1 abid:1
    ds_read_b128 v[44:47], v174 offset:864
    v_exp_f32 v54, v54
    v_exp_f32 v55, v55
    v_exp_f32 v64, v64
    v_exp_f32 v65, v65
    v_exp_f32 v66, v66
    v_exp_f32 v67, v67
    v_exp_f32 v68, v68
    v_exp_f32 v69, v69
    v_smfmac_f32_32x32x32_bf16 v[184:199], v[32:35], v[48:55], v175
    ds_read_b64_tr_b16 v[20:21], v172 offset:896
    v_exp_f32 v70, v70
    v_exp_f32 v71, v71
    v_exp_f32 v56, v56
    v_exp_f32 v57, v57
    v_smfmac_f32_32x32x32_bf16 v[200:215], v[32:35], v[64:71], v175
    ds_read_b64_tr_b16 v[22:23], v172 offset:5248
    v_exp_f32 v58, v58
    v_exp_f32 v59, v59
    v_exp_f32 v60, v60
    v_exp_f32 v61, v61
    v_mfma_f32_32x32x16_bf16 v[80:95], v[24:27], v[8:11], v[80:95]
    ds_read_b128 v[36:39], v174 offset:832
    v_exp_f32 v62, v62
    v_exp_f32 v63, v63
    v_exp_f32 v72, v72
    v_exp_f32 v73, v73
    v_mfma_f32_32x32x16_bf16 v[96:111], v[24:27], v[12:15], v[96:111]
    ds_read_b64_tr_b16 v[30:31], v173 offset:896
    v_exp_f32 v74, v74
    v_exp_f32 v75, v75
    v_exp_f32 v76, v76
    v_exp_f32 v77, v77
    v_smfmac_f32_32x32x32_bf16 v[184:199], v[40:43], v[56:63], v175
    v_exp_f32 v78, v78
    v_exp_f32 v79, v79
    v_exp_f32 v80, v80
    v_exp_f32 v81, v81
    v_smfmac_f32_32x32x32_bf16 v[200:215], v[40:43], v[72:79], v175
    s_waitcnt lgkmcnt(0)
    v_exp_f32 v82, v82
    v_exp_f32_e64 v83, v83
    v_exp_f32 v84, v84
    v_exp_f32 v85, v85
    v_mfma_f32_32x32x4_2b_bf16 v[48:79], v[30:31], v[16:17], 0 cbsz:1 abid:0
    ds_read_b128 v[40:43], v174 offset:928
    v_exp_f32 v86, v86
    v_exp_f32 v87, v87
    v_exp_f32 v96, v96
    v_exp_f32 v97, v97
    v_exp_f32 v98, v98
    v_exp_f32 v99, v99
    v_exp_f32 v100, v100
    v_exp_f32 v101, v101
    v_smfmac_f32_32x32x32_bf16 v[184:199], v[36:39], v[80:87], v175
    ds_read_b64_tr_b16 v[24:25], v172 offset:960
    v_exp_f32 v102, v102
    v_exp_f32 v103, v103
    v_exp_f32 v88, v88
    v_exp_f32 v89, v89
    v_smfmac_f32_32x32x32_bf16 v[200:215], v[36:39], v[96:103], v175
    ds_read_b64_tr_b16 v[26:27], v172 offset:5312
    v_exp_f32 v90, v90
    v_exp_f32 v91, v91
    v_exp_f32 v92, v92
    v_exp_f32 v93, v93
    v_mfma_f32_32x32x16_bf16 v[48:63], v[20:23], v[8:11], v[48:63]
    ds_read_b128 v[32:35], v174 offset:896
    v_exp_f32 v94, v94
    v_exp_f32 v95, v95
    v_exp_f32 v104, v104
    v_exp_f32 v105, v105
    v_mfma_f32_32x32x16_bf16 v[64:79], v[20:23], v[12:15], v[64:79]
    ds_read_b32 v169, v170 offset:36
    v_exp_f32 v106, v106
    v_exp_f32 v107, v107
    v_exp_f32 v108, v108
    v_exp_f32 v109, v109
    v_smfmac_f32_32x32x32_bf16 v[184:199], v[44:47], v[88:95], v175
    v_exp_f32 v110, v110
    v_exp_f32 v111, v111
    v_exp_f32 v48, v48
    v_exp_f32 v49, v49
    v_smfmac_f32_32x32x32_bf16 v[200:215], v[44:47], v[104:111], v175
    s_waitcnt lgkmcnt(0)
    v_cmp_gt_u32 vcc, 4, v169
    s_cbranch_vccnz L_ll6
L_ll6_x:
    v_exp_f32 v50, v50
    v_exp_f32_e64 v51, v51
    v_exp_f32 v52, v52
    v_exp_f32 v53, v53
    v_mfma_f32_32x32x4_2b_bf16 v[80:111], v[30:31], v[16:17], 0 cbsz:1 abid:1
    ds_read_b128 v[44:47], v174 offset:992
    v_exp_f32 v54, v54
    v_exp_f32 v55, v55
    v_exp_f32 v64, v64
    v_exp_f32 v65, v65
    v_exp_f32 v66, v66
    v_exp_f32 v67, v67
    v_exp_f32 v68, v68
    v_exp_f32 v69, v69
    v_smfmac_f32_32x32x32_bf16 v[184:199], v[32:35], v[48:55], v175
    v_add_u32 v172, 38400, v172
    ds_read_b64_tr_b16 v[20:21], v172 offset:0
    v_exp_f32 v70, v70
    v_exp_f32 v71, v71
    v_exp_f32 v56, v56
    v_exp_f32 v57, v57
    v_smfmac_f32_32x32x32_bf16 v[200:215], v[32:35], v[64:71], v175
    ds_read_b64_tr_b16 v[22:23], v172 offset:4352
    v_exp_f32 v58, v58
    v_exp_f32 v59, v59
    v_exp_f32 v60, v60
    v_exp_f32 v61, v61
    v_mfma_f32_32x32x16_bf16 v[80:95], v[24:27], v[8:11], v[80:95]
    ds_read_b128 v[36:39], v174 offset:960
    v_exp_f32 v62, v62
    v_exp_f32 v63, v63
    v_exp_f32 v72, v72
    v_exp_f32 v73, v73
    v_mfma_f32_32x32x16_bf16 v[96:111], v[24:27], v[12:15], v[96:111]
    v_add_u32_e64 v173, v173, v176
    ds_read_b64_tr_b16 v[28:29], v173 offset:0
    v_exp_f32 v74, v74
    v_exp_f32 v75, v75
    v_exp_f32 v76, v76
    v_exp_f32 v77, v77
    v_smfmac_f32_32x32x32_bf16 v[184:199], v[40:43], v[56:63], v175
    v_exp_f32 v78, v78
    v_exp_f32 v79, v79
    v_exp_f32 v80, v80
    v_exp_f32 v81, v81
    v_smfmac_f32_32x32x32_bf16 v[200:215], v[40:43], v[72:79], v175
    s_waitcnt lgkmcnt(0)
    v_exp_f32 v82, v82
    v_exp_f32_e64 v83, v83
    v_exp_f32 v84, v84
    v_exp_f32 v85, v85
    v_mfma_f32_32x32x4_2b_bf16 v[48:79], v[28:29], v[16:17], 0 cbsz:1 abid:0
    v_add_u32_e64 v174, v174, v177
    ds_read_b128 v[40:43], v174 offset:32
    v_exp_f32 v86, v86
    v_exp_f32 v87, v87
    v_exp_f32 v96, v96
    v_exp_f32 v97, v97
    v_exp_f32 v98, v98
    v_exp_f32 v99, v99
    v_exp_f32 v100, v100
    v_exp_f32 v101, v101
    v_smfmac_f32_32x32x32_bf16 v[184:199], v[36:39], v[80:87], v175
    ds_read_b64_tr_b16 v[24:25], v172 offset:64
    v_exp_f32 v102, v102
    v_exp_f32 v103, v103
    v_exp_f32 v88, v88
    v_exp_f32 v89, v89
    v_smfmac_f32_32x32x32_bf16 v[200:215], v[36:39], v[96:103], v175
    ds_read_b64_tr_b16 v[26:27], v172 offset:4416
    v_exp_f32 v90, v90
    v_exp_f32 v91, v91
    v_exp_f32 v92, v92
    v_exp_f32 v93, v93
    v_mfma_f32_32x32x16_bf16 v[48:63], v[20:23], v[8:11], v[48:63]
    ds_read_b128 v[32:35], v174 offset:0
    v_exp_f32 v94, v94
    v_exp_f32 v95, v95
    v_exp_f32 v104, v104
    v_exp_f32 v105, v105
    v_mfma_f32_32x32x16_bf16 v[64:79], v[20:23], v[12:15], v[64:79]
    v_exp_f32 v106, v106
    v_exp_f32 v107, v107
    v_exp_f32 v108, v108
    v_exp_f32 v109, v109
    v_smfmac_f32_32x32x32_bf16 v[184:199], v[44:47], v[88:95], v175
    v_exp_f32 v110, v110
    v_exp_f32 v111, v111
    v_exp_f32 v48, v48
    v_exp_f32 v49, v49
    v_smfmac_f32_32x32x32_bf16 v[200:215], v[44:47], v[104:111], v175
    s_waitcnt lgkmcnt(0)
    v_exp_f32 v50, v50
    v_exp_f32_e64 v51, v51
    v_exp_f32 v52, v52
    v_exp_f32 v53, v53
    v_mfma_f32_32x32x4_2b_bf16 v[80:111], v[28:29], v[16:17], 0 cbsz:1 abid:1
    ds_read_b128 v[44:47], v174 offset:96
    v_exp_f32 v54, v54
    v_exp_f32 v55, v55
    v_exp_f32 v64, v64
    v_exp_f32 v65, v65
    v_exp_f32 v66, v66
    v_exp_f32 v67, v67
    v_exp_f32 v68, v68
    v_exp_f32 v69, v69
    v_smfmac_f32_32x32x32_bf16 v[184:199], v[32:35], v[48:55], v175
    ds_read_b64_tr_b16 v[20:21], v172 offset:128
    v_exp_f32 v70, v70
    v_exp_f32 v71, v71
    v_exp_f32 v56, v56
    v_exp_f32 v57, v57
    v_smfmac_f32_32x32x32_bf16 v[200:215], v[32:35], v[64:71], v175
    ds_read_b64_tr_b16 v[22:23], v172 offset:4480
    v_exp_f32 v58, v58
    v_exp_f32 v59, v59
    v_exp_f32 v60, v60
    v_exp_f32 v61, v61
    v_mfma_f32_32x32x16_bf16 v[80:95], v[24:27], v[8:11], v[80:95]
    ds_read_b128 v[36:39], v174 offset:64
    v_exp_f32 v62, v62
    v_exp_f32 v63, v63
    v_exp_f32 v72, v72
    v_exp_f32 v73, v73
    v_mfma_f32_32x32x16_bf16 v[96:111], v[24:27], v[12:15], v[96:111]
    ds_read_b64_tr_b16 v[30:31], v173 offset:128
    v_exp_f32 v74, v74
    v_exp_f32 v75, v75
    v_exp_f32 v76, v76
    v_exp_f32 v77, v77
    v_smfmac_f32_32x32x32_bf16 v[184:199], v[40:43], v[56:63], v175
    v_exp_f32 v78, v78
    v_exp_f32 v79, v79
    v_exp_f32 v80, v80
    v_exp_f32 v81, v81
    v_smfmac_f32_32x32x32_bf16 v[200:215], v[40:43], v[72:79], v175
    s_waitcnt lgkmcnt(0)
    v_exp_f32 v82, v82
    v_exp_f32_e64 v83, v83
    v_exp_f32 v84, v84
    v_exp_f32 v85, v85
    v_mfma_f32_32x32x4_2b_bf16 v[48:79], v[30:31], v[16:17], 0 cbsz:1 abid:0
    ds_read_b128 v[40:43], v174 offset:160
    v_exp_f32 v86, v86
    v_exp_f32 v87, v87
    v_exp_f32 v96, v96
    v_exp_f32 v97, v97
    v_exp_f32 v98, v98
    v_exp_f32 v99, v99
    v_exp_f32 v100, v100
    v_exp_f32 v101, v101
    v_smfmac_f32_32x32x32_bf16 v[184:199], v[36:39], v[80:87], v175
    ds_read_b64_tr_b16 v[24:25], v172 offset:192
    v_exp_f32 v102, v102
    v_exp_f32 v103, v103
    v_exp_f32 v88, v88
    v_exp_f32 v89, v89
    v_smfmac_f32_32x32x32_bf16 v[200:215], v[36:39], v[96:103], v175
    ds_read_b64_tr_b16 v[26:27], v172 offset:4544
    v_exp_f32 v90, v90
    v_exp_f32 v91, v91
    v_exp_f32 v92, v92
    v_exp_f32 v93, v93
    v_mfma_f32_32x32x16_bf16 v[48:63], v[20:23], v[8:11], v[48:63]
    ds_read_b128 v[32:35], v174 offset:128
    v_exp_f32 v94, v94
    v_exp_f32 v95, v95
    v_exp_f32 v104, v104
    v_exp_f32 v105, v105
    v_mfma_f32_32x32x16_bf16 v[64:79], v[20:23], v[12:15], v[64:79]
    v_exp_f32 v106, v106
    v_exp_f32 v107, v107
    v_exp_f32 v108, v108
    v_exp_f32 v109, v109
    v_smfmac_f32_32x32x32_bf16 v[184:199], v[44:47], v[88:95], v175
    v_exp_f32 v110, v110
    v_exp_f32 v111, v111
    v_exp_f32 v48, v48
    v_exp_f32 v49, v49
    v_smfmac_f32_32x32x32_bf16 v[200:215], v[44:47], v[104:111], v175
    s_waitcnt lgkmcnt(0)
    v_exp_f32 v50, v50
    v_exp_f32_e64 v51, v51
    v_exp_f32 v52, v52
    v_exp_f32 v53, v53
    v_mfma_f32_32x32x4_2b_bf16 v[80:111], v[30:31], v[16:17], 0 cbsz:1 abid:1
    ds_read_b128 v[44:47], v174 offset:224
    v_exp_f32 v54, v54
    v_exp_f32 v55, v55
    v_exp_f32 v64, v64
    v_exp_f32 v65, v65
    v_exp_f32 v66, v66
    v_exp_f32 v67, v67
    v_exp_f32 v68, v68
    v_exp_f32 v69, v69
    v_smfmac_f32_32x32x32_bf16 v[184:199], v[32:35], v[48:55], v175
    ds_read_b64_tr_b16 v[20:21], v172 offset:256
    v_exp_f32 v70, v70
    v_exp_f32 v71, v71
    v_exp_f32 v56, v56
    v_exp_f32 v57, v57
    v_smfmac_f32_32x32x32_bf16 v[200:215], v[32:35], v[64:71], v175
    ds_read_b64_tr_b16 v[22:23], v172 offset:4608
    v_exp_f32 v58, v58
    v_exp_f32 v59, v59
    v_exp_f32 v60, v60
    v_exp_f32 v61, v61
    v_mfma_f32_32x32x16_bf16 v[80:95], v[24:27], v[8:11], v[80:95]
    ds_read_b128 v[36:39], v174 offset:192
    v_exp_f32 v62, v62
    v_exp_f32 v63, v63
    v_exp_f32 v72, v72
    v_exp_f32 v73, v73
    v_mfma_f32_32x32x16_bf16 v[96:111], v[24:27], v[12:15], v[96:111]
    ds_read_b64_tr_b16 v[28:29], v173 offset:256
    v_exp_f32 v74, v74
    v_exp_f32 v75, v75
    v_exp_f32 v76, v76
    v_exp_f32 v77, v77
    v_smfmac_f32_32x32x32_bf16 v[184:199], v[40:43], v[56:63], v175
    v_exp_f32 v78, v78
    v_exp_f32 v79, v79
    v_exp_f32 v80, v80
    v_exp_f32 v81, v81
    v_smfmac_f32_32x32x32_bf16 v[200:215], v[40:43], v[72:79], v175
    s_waitcnt lgkmcnt(0)
    v_exp_f32 v82, v82
    v_exp_f32_e64 v83, v83
    v_exp_f32 v84, v84
    v_exp_f32 v85, v85
    v_mfma_f32_32x32x4_2b_bf16 v[48:79], v[28:29], v[16:17], 0 cbsz:1 abid:0
    ds_read_b128 v[40:43], v174 offset:288
    v_exp_f32 v86, v86
    v_exp_f32 v87, v87
    v_exp_f32 v96, v96
    v_exp_f32 v97, v97
    v_exp_f32 v98, v98
    v_exp_f32 v99, v99
    v_exp_f32 v100, v100
    v_exp_f32 v101, v101
    v_smfmac_f32_32x32x32_bf16 v[184:199], v[36:39], v[80:87], v175
    ds_read_b64_tr_b16 v[24:25], v172 offset:320
    v_exp_f32 v102, v102
    v_exp_f32 v103, v103
    v_exp_f32 v88, v88
    v_exp_f32 v89, v89
    v_smfmac_f32_32x32x32_bf16 v[200:215], v[36:39], v[96:103], v175
    ds_read_b64_tr_b16 v[26:27], v172 offset:4672
    v_exp_f32 v90, v90
    v_exp_f32 v91, v91
    v_exp_f32 v92, v92
    v_exp_f32 v93, v93
    v_mfma_f32_32x32x16_bf16 v[48:63], v[20:23], v[8:11], v[48:63]
    ds_read_b128 v[32:35], v174 offset:256
    v_exp_f32 v94, v94
    v_exp_f32 v95, v95
    v_exp_f32 v104, v104
    v_exp_f32 v105, v105
    v_mfma_f32_32x32x16_bf16 v[64:79], v[20:23], v[12:15], v[64:79]
    v_exp_f32 v106, v106
    v_exp_f32 v107, v107
    v_exp_f32 v108, v108
    v_exp_f32 v109, v109
    v_smfmac_f32_32x32x32_bf16 v[184:199], v[44:47], v[88:95], v175
    v_exp_f32 v110, v110
    v_exp_f32 v111, v111
    v_exp_f32 v48, v48
    v_exp_f32 v49, v49
    v_smfmac_f32_32x32x32_bf16 v[200:215], v[44:47], v[104:111], v175
    s_waitcnt lgkmcnt(0)
    v_exp_f32 v50, v50
    v_exp_f32_e64 v51, v51
    v_exp_f32 v52, v52
    v_exp_f32 v53, v53
    v_mfma_f32_32x32x4_2b_bf16 v[80:111], v[28:29], v[16:17], 0 cbsz:1 abid:1
    ds_read_b128 v[44:47], v174 offset:352
    v_exp_f32 v54, v54
    v_exp_f32 v55, v55
    v_exp_f32 v64, v64
    v_exp_f32 v65, v65
    v_exp_f32 v66, v66
    v_exp_f32 v67, v67
    v_exp_f32 v68, v68
    v_exp_f32 v69, v69
    v_smfmac_f32_32x32x32_bf16 v[184:199], v[32:35], v[48:55], v175
    ds_read_b64_tr_b16 v[20:21], v172 offset:384
    v_exp_f32 v70, v70
    v_exp_f32 v71, v71
    v_exp_f32 v56, v56
    v_exp_f32 v57, v57
    v_smfmac_f32_32x32x32_bf16 v[200:215], v[32:35], v[64:71], v175
    ds_read_b64_tr_b16 v[22:23], v172 offset:4736
    v_exp_f32 v58, v58
    v_exp_f32 v59, v59
    v_exp_f32 v60, v60
    v_exp_f32 v61, v61
    v_mfma_f32_32x32x16_bf16 v[80:95], v[24:27], v[8:11], v[80:95]
    ds_read_b128 v[36:39], v174 offset:320
    v_exp_f32 v62, v62
    v_exp_f32 v63, v63
    v_exp_f32 v72, v72
    v_exp_f32 v73, v73
    v_mfma_f32_32x32x16_bf16 v[96:111], v[24:27], v[12:15], v[96:111]
    ds_read_b64_tr_b16 v[30:31], v173 offset:384
    v_exp_f32 v74, v74
    v_exp_f32 v75, v75
    v_exp_f32 v76, v76
    v_exp_f32 v77, v77
    v_smfmac_f32_32x32x32_bf16 v[184:199], v[40:43], v[56:63], v175
    v_exp_f32 v78, v78
    v_exp_f32 v79, v79
    v_exp_f32 v80, v80
    v_exp_f32 v81, v81
    v_smfmac_f32_32x32x32_bf16 v[200:215], v[40:43], v[72:79], v175
    s_waitcnt lgkmcnt(0)
    v_exp_f32 v82, v82
    v_exp_f32_e64 v83, v83
    v_exp_f32 v84, v84
    v_exp_f32 v85, v85
    v_mfma_f32_32x32x4_2b_bf16 v[48:79], v[30:31], v[16:17], 0 cbsz:1 abid:0
    ds_read_b128 v[40:43], v174 offset:416
    v_exp_f32 v86, v86
    v_exp_f32 v87, v87
    v_exp_f32 v96, v96
    v_exp_f32 v97, v97
    v_exp_f32 v98, v98
    v_exp_f32 v99, v99
    v_exp_f32 v100, v100
    v_exp_f32 v101, v101
    v_smfmac_f32_32x32x32_bf16 v[184:199], v[36:39], v[80:87], v175
    ds_read_b64_tr_b16 v[24:25], v172 offset:448
    v_exp_f32 v102, v102
    v_exp_f32 v103, v103
    v_exp_f32 v88, v88
    v_exp_f32 v89, v89
    v_smfmac_f32_32x32x32_bf16 v[200:215], v[36:39], v[96:103], v175
    ds_read_b64_tr_b16 v[26:27], v172 offset:4800
    v_exp_f32 v90, v90
    v_exp_f32 v91, v91
    v_exp_f32 v92, v92
    v_exp_f32 v93, v93
    v_mfma_f32_32x32x16_bf16 v[48:63], v[20:23], v[8:11], v[48:63]
    ds_read_b128 v[32:35], v174 offset:384
    v_exp_f32 v94, v94
    v_exp_f32 v95, v95
    v_exp_f32 v104, v104
    v_exp_f32 v105, v105
    v_mfma_f32_32x32x16_bf16 v[64:79], v[20:23], v[12:15], v[64:79]
    v_exp_f32 v106, v106
    v_exp_f32 v107, v107
    v_exp_f32 v108, v108
    v_exp_f32 v109, v109
    v_smfmac_f32_32x32x32_bf16 v[184:199], v[44:47], v[88:95], v175
    v_exp_f32 v110, v110
    v_exp_f32 v111, v111
    v_exp_f32 v48, v48
    v_exp_f32 v49, v49
    v_smfmac_f32_32x32x32_bf16 v[200:215], v[44:47], v[104:111], v175
    s_waitcnt lgkmcnt(0)
    v_exp_f32 v50, v50
    v_exp_f32_e64 v51, v51
    v_exp_f32 v52, v52
    v_exp_f32 v53, v53
    v_mfma_f32_32x32x4_2b_bf16 v[80:111], v[30:31], v[16:17], 0 cbsz:1 abid:1
    ds_read_b128 v[44:47], v174 offset:480
    v_exp_f32 v54, v54
    v_exp_f32 v55, v55
    v_exp_f32 v64, v64
    v_exp_f32 v65, v65
    v_exp_f32 v66, v66
    v_exp_f32 v67, v67
    v_exp_f32 v68, v68
    v_exp_f32 v69, v69
    v_smfmac_f32_32x32x32_bf16 v[184:199], v[32:35], v[48:55], v175
    ds_read_b64_tr_b16 v[20:21], v172 offset:512
    v_exp_f32 v70, v70
    v_exp_f32 v71, v71
    v_exp_f32 v56, v56
    v_exp_f32 v57, v57
    v_smfmac_f32_32x32x32_bf16 v[200:215], v[32:35], v[64:71], v175
    ds_read_b64_tr_b16 v[22:23], v172 offset:4864
    v_exp_f32 v58, v58
    v_exp_f32 v59, v59
    v_exp_f32 v60, v60
    v_exp_f32 v61, v61
    v_mfma_f32_32x32x16_bf16 v[80:95], v[24:27], v[8:11], v[80:95]
    ds_read_b128 v[36:39], v174 offset:448
    v_exp_f32 v62, v62
    v_exp_f32 v63, v63
    v_exp_f32 v72, v72
    v_exp_f32 v73, v73
    v_mfma_f32_32x32x16_bf16 v[96:111], v[24:27], v[12:15], v[96:111]
    ds_read_b64_tr_b16 v[28:29], v173 offset:512
    v_exp_f32 v74, v74
    v_exp_f32 v75, v75
    v_exp_f32 v76, v76
    v_exp_f32 v77, v77
    v_smfmac_f32_32x32x32_bf16 v[184:199], v[40:43], v[56:63], v175
    v_exp_f32 v78, v78
    v_exp_f32 v79, v79
    v_exp_f32 v80, v80
    v_exp_f32 v81, v81
    v_smfmac_f32_32x32x32_bf16 v[200:215], v[40:43], v[72:79], v175
    s_waitcnt lgkmcnt(0)
    v_exp_f32 v82, v82
    v_exp_f32_e64 v83, v83
    v_exp_f32 v84, v84
    v_exp_f32 v85, v85
    v_mfma_f32_32x32x4_2b_bf16 v[48:79], v[28:29], v[16:17], 0 cbsz:1 abid:0
    ds_read_b128 v[40:43], v174 offset:544
    v_exp_f32 v86, v86
    v_exp_f32 v87, v87
    v_exp_f32 v96, v96
    v_exp_f32 v97, v97
    v_exp_f32 v98, v98
    v_exp_f32 v99, v99
    v_exp_f32 v100, v100
    v_exp_f32 v101, v101
    v_smfmac_f32_32x32x32_bf16 v[184:199], v[36:39], v[80:87], v175
    ds_read_b64_tr_b16 v[24:25], v172 offset:576
    v_exp_f32 v102, v102
    v_exp_f32 v103, v103
    v_exp_f32 v88, v88
    v_exp_f32 v89, v89
    v_smfmac_f32_32x32x32_bf16 v[200:215], v[36:39], v[96:103], v175
    ds_read_b64_tr_b16 v[26:27], v172 offset:4928
    v_exp_f32 v90, v90
    v_exp_f32 v91, v91
    v_exp_f32 v92, v92
    v_exp_f32 v93, v93
    v_mfma_f32_32x32x16_bf16 v[48:63], v[20:23], v[8:11], v[48:63]
    ds_read_b128 v[32:35], v174 offset:512
    v_exp_f32 v94, v94
    v_exp_f32 v95, v95
    v_exp_f32 v104, v104
    v_exp_f32 v105, v105
    v_mfma_f32_32x32x16_bf16 v[64:79], v[20:23], v[12:15], v[64:79]
    v_exp_f32 v106, v106
    v_exp_f32 v107, v107
    v_exp_f32 v108, v108
    v_exp_f32 v109, v109
    v_smfmac_f32_32x32x32_bf16 v[184:199], v[44:47], v[88:95], v175
    v_exp_f32 v110, v110
    v_exp_f32 v111, v111
    v_exp_f32 v48, v48
    v_exp_f32 v49, v49
    v_smfmac_f32_32x32x32_bf16 v[200:215], v[44:47], v[104:111], v175
    s_waitcnt lgkmcnt(0)
    v_exp_f32 v50, v50
    v_exp_f32_e64 v51, v51
    v_exp_f32 v52, v52
    v_exp_f32 v53, v53
    v_mfma_f32_32x32x4_2b_bf16 v[80:111], v[28:29], v[16:17], 0 cbsz:1 abid:1
    ds_read_b128 v[44:47], v174 offset:608
    v_exp_f32 v54, v54
    v_exp_f32 v55, v55
    v_exp_f32 v64, v64
    v_exp_f32 v65, v65
    v_exp_f32 v66, v66
    v_exp_f32 v67, v67
    v_exp_f32 v68, v68
    v_exp_f32 v69, v69
    v_smfmac_f32_32x32x32_bf16 v[184:199], v[32:35], v[48:55], v175
    ds_read_b64_tr_b16 v[20:21], v172 offset:640
    v_exp_f32 v70, v70
    v_exp_f32 v71, v71
    v_exp_f32 v56, v56
    v_exp_f32 v57, v57
    v_smfmac_f32_32x32x32_bf16 v[200:215], v[32:35], v[64:71], v175
    ds_read_b64_tr_b16 v[22:23], v172 offset:4992
    v_exp_f32 v58, v58
    v_exp_f32 v59, v59
    v_exp_f32 v60, v60
    v_exp_f32 v61, v61
    v_mfma_f32_32x32x16_bf16 v[80:95], v[24:27], v[8:11], v[80:95]
    ds_read_b128 v[36:39], v174 offset:576
    v_exp_f32 v62, v62
    v_exp_f32 v63, v63
    v_exp_f32 v72, v72
    v_exp_f32 v73, v73
    v_mfma_f32_32x32x16_bf16 v[96:111], v[24:27], v[12:15], v[96:111]
    ds_read_b64_tr_b16 v[30:31], v173 offset:640
    v_exp_f32 v74, v74
    v_exp_f32 v75, v75
    v_exp_f32 v76, v76
    v_exp_f32 v77, v77
    v_smfmac_f32_32x32x32_bf16 v[184:199], v[40:43], v[56:63], v175
    v_exp_f32 v78, v78
    v_exp_f32 v79, v79
    v_exp_f32 v80, v80
    v_exp_f32 v81, v81
    v_smfmac_f32_32x32x32_bf16 v[200:215], v[40:43], v[72:79], v175
    s_waitcnt lgkmcnt(0)
    v_exp_f32 v82, v82
    v_exp_f32_e64 v83, v83
    v_exp_f32 v84, v84
    v_exp_f32 v85, v85
    v_mfma_f32_32x32x4_2b_bf16 v[48:79], v[30:31], v[16:17], 0 cbsz:1 abid:0
    ds_read_b128 v[40:43], v174 offset:672
    v_exp_f32 v86, v86
    v_exp_f32 v87, v87
    v_exp_f32 v96, v96
    v_exp_f32 v97, v97
    v_exp_f32 v98, v98
    v_exp_f32 v99, v99
    v_exp_f32 v100, v100
    v_exp_f32 v101, v101
    v_smfmac_f32_32x32x32_bf16 v[184:199], v[36:39], v[80:87], v175
    ds_read_b64_tr_b16 v[24:25], v172 offset:704
    v_exp_f32 v102, v102
    v_exp_f32 v103, v103
    v_exp_f32 v88, v88
    v_exp_f32 v89, v89
    v_smfmac_f32_32x32x32_bf16 v[200:215], v[36:39], v[96:103], v175
    ds_read_b64_tr_b16 v[26:27], v172 offset:5056
    v_exp_f32 v90, v90
    v_exp_f32 v91, v91
    v_exp_f32 v92, v92
    v_exp_f32 v93, v93
    v_mfma_f32_32x32x16_bf16 v[48:63], v[20:23], v[8:11], v[48:63]
    ds_read_b128 v[32:35], v174 offset:640
    v_exp_f32 v94, v94
    v_exp_f32 v95, v95
    v_exp_f32 v104, v104
    v_exp_f32 v105, v105
    v_mfma_f32_32x32x16_bf16 v[64:79], v[20:23], v[12:15], v[64:79]
    v_exp_f32 v106, v106
    v_exp_f32 v107, v107
    v_exp_f32 v108, v108
    v_exp_f32 v109, v109
    v_smfmac_f32_32x32x32_bf16 v[184:199], v[44:47], v[88:95], v175
    v_exp_f32 v110, v110
    v_exp_f32 v111, v111
    v_exp_f32 v48, v48
    v_exp_f32 v49, v49
    v_smfmac_f32_32x32x32_bf16 v[200:215], v[44:47], v[104:111], v175
    s_waitcnt lgkmcnt(0)
    v_exp_f32 v50, v50
    v_exp_f32_e64 v51, v51
    v_exp_f32 v52, v52
    v_exp_f32 v53, v53
    v_mfma_f32_32x32x4_2b_bf16 v[80:111], v[30:31], v[16:17], 0 cbsz:1 abid:1
    ds_read_b128 v[44:47], v174 offset:736
    v_exp_f32 v54, v54
    v_exp_f32 v55, v55
    v_exp_f32 v64, v64
    v_exp_f32 v65, v65
    v_exp_f32 v66, v66
    v_exp_f32 v67, v67
    v_exp_f32 v68, v68
    v_exp_f32 v69, v69
    v_smfmac_f32_32x32x32_bf16 v[184:199], v[32:35], v[48:55], v175
    ds_read_b64_tr_b16 v[20:21], v172 offset:768
    v_exp_f32 v70, v70
    v_exp_f32 v71, v71
    v_exp_f32 v56, v56
    v_exp_f32 v57, v57
    v_smfmac_f32_32x32x32_bf16 v[200:215], v[32:35], v[64:71], v175
    ds_read_b64_tr_b16 v[22:23], v172 offset:5120
    v_exp_f32 v58, v58
    v_exp_f32 v59, v59
    v_exp_f32 v60, v60
    v_exp_f32 v61, v61
    v_mfma_f32_32x32x16_bf16 v[80:95], v[24:27], v[8:11], v[80:95]
    ds_read_b128 v[36:39], v174 offset:704
    v_exp_f32 v62, v62
    v_exp_f32 v63, v63
    v_exp_f32 v72, v72
    v_exp_f32 v73, v73
    v_mfma_f32_32x32x16_bf16 v[96:111], v[24:27], v[12:15], v[96:111]
    ds_read_b64_tr_b16 v[28:29], v173 offset:768
    v_exp_f32 v74, v74
    v_exp_f32 v75, v75
    v_exp_f32 v76, v76
    v_exp_f32 v77, v77
    v_smfmac_f32_32x32x32_bf16 v[184:199], v[40:43], v[56:63], v175
    v_exp_f32 v78, v78
    v_exp_f32 v79, v79
    v_exp_f32 v80, v80
    v_exp_f32 v81, v81
    v_smfmac_f32_32x32x32_bf16 v[200:215], v[40:43], v[72:79], v175
    s_waitcnt lgkmcnt(0)
    v_exp_f32 v82, v82
    v_exp_f32_e64 v83, v83
    v_exp_f32 v84, v84
    v_exp_f32 v85, v85
    v_mfma_f32_32x32x4_2b_bf16 v[48:79], v[28:29], v[16:17], 0 cbsz:1 abid:0
    ds_read_b128 v[40:43], v174 offset:800
    v_exp_f32 v86, v86
    v_exp_f32 v87, v87
    v_exp_f32 v96, v96
    v_exp_f32 v97, v97
    v_exp_f32 v98, v98
    v_exp_f32 v99, v99
    v_exp_f32 v100, v100
    v_exp_f32 v101, v101
    v_smfmac_f32_32x32x32_bf16 v[184:199], v[36:39], v[80:87], v175
    ds_read_b64_tr_b16 v[24:25], v172 offset:832
    v_exp_f32 v102, v102
    v_exp_f32 v103, v103
    v_exp_f32 v88, v88
    v_exp_f32 v89, v89
    v_smfmac_f32_32x32x32_bf16 v[200:215], v[36:39], v[96:103], v175
    ds_read_b64_tr_b16 v[26:27], v172 offset:5184
    v_exp_f32 v90, v90
    v_exp_f32 v91, v91
    v_exp_f32 v92, v92
    v_exp_f32 v93, v93
    v_mfma_f32_32x32x16_bf16 v[48:63], v[20:23], v[8:11], v[48:63]
    ds_read_b128 v[32:35], v174 offset:768
    v_exp_f32 v94, v94
    v_exp_f32 v95, v95
    v_exp_f32 v104, v104
    v_exp_f32 v105, v105
    v_mfma_f32_32x32x16_bf16 v[64:79], v[20:23], v[12:15], v[64:79]
    v_exp_f32 v106, v106
    v_exp_f32 v107, v107
    v_exp_f32 v108, v108
    v_exp_f32 v109, v109
    v_smfmac_f32_32x32x32_bf16 v[184:199], v[44:47], v[88:95], v175
    v_exp_f32 v110, v110
    v_exp_f32 v111, v111
    v_exp_f32 v48, v48
    v_exp_f32 v49, v49
    v_smfmac_f32_32x32x32_bf16 v[200:215], v[44:47], v[104:111], v175
    s_waitcnt lgkmcnt(0)
    v_exp_f32 v50, v50
    v_exp_f32_e64 v51, v51
    v_exp_f32 v52, v52
    v_exp_f32 v53, v53
    v_mfma_f32_32x32x4_2b_bf16 v[80:111], v[28:29], v[16:17], 0 cbsz:1 abid:1
    ds_read_b128 v[44:47], v174 offset:864
    v_exp_f32 v54, v54
    v_exp_f32 v55, v55
    v_exp_f32 v64, v64
    v_exp_f32 v65, v65
    v_exp_f32 v66, v66
    v_exp_f32 v67, v67
    v_exp_f32 v68, v68
    v_exp_f32 v69, v69
    v_smfmac_f32_32x32x32_bf16 v[184:199], v[32:35], v[48:55], v175
    ds_read_b64_tr_b16 v[20:21], v172 offset:896
    v_exp_f32 v70, v70
    v_exp_f32 v71, v71
    v_exp_f32 v56, v56
    v_exp_f32 v57, v57
    v_smfmac_f32_32x32x32_bf16 v[200:215], v[32:35], v[64:71], v175
    ds_read_b64_tr_b16 v[22:23], v172 offset:5248
    v_exp_f32 v58, v58
    v_exp_f32 v59, v59
    v_exp_f32 v60, v60
    v_exp_f32 v61, v61
    v_mfma_f32_32x32x16_bf16 v[80:95], v[24:27], v[8:11], v[80:95]
    ds_read_b128 v[36:39], v174 offset:832
    v_exp_f32 v62, v62
    v_exp_f32 v63, v63
    v_exp_f32 v72, v72
    v_exp_f32 v73, v73
    v_mfma_f32_32x32x16_bf16 v[96:111], v[24:27], v[12:15], v[96:111]
    ds_read_b64_tr_b16 v[30:31], v173 offset:896
    v_exp_f32 v74, v74
    v_exp_f32 v75, v75
    v_exp_f32 v76, v76
    v_exp_f32 v77, v77
    v_smfmac_f32_32x32x32_bf16 v[184:199], v[40:43], v[56:63], v175
    v_exp_f32 v78, v78
    v_exp_f32 v79, v79
    v_exp_f32 v80, v80
    v_exp_f32 v81, v81
    v_smfmac_f32_32x32x32_bf16 v[200:215], v[40:43], v[72:79], v175
    s_waitcnt lgkmcnt(0)
    v_exp_f32 v82, v82
    v_exp_f32_e64 v83, v83
    v_exp_f32 v84, v84
    v_exp_f32 v85, v85
    v_mfma_f32_32x32x4_2b_bf16 v[48:79], v[30:31], v[16:17], 0 cbsz:1 abid:0
    ds_read_b128 v[40:43], v174 offset:928
    v_exp_f32 v86, v86
    v_exp_f32 v87, v87
    v_exp_f32 v96, v96
    v_exp_f32 v97, v97
    v_exp_f32 v98, v98
    v_exp_f32 v99, v99
    v_exp_f32 v100, v100
    v_exp_f32 v101, v101
    v_smfmac_f32_32x32x32_bf16 v[184:199], v[36:39], v[80:87], v175
    ds_read_b64_tr_b16 v[24:25], v172 offset:960
    v_exp_f32 v102, v102
    v_exp_f32 v103, v103
    v_exp_f32 v88, v88
    v_exp_f32 v89, v89
    v_smfmac_f32_32x32x32_bf16 v[200:215], v[36:39], v[96:103], v175
    ds_read_b64_tr_b16 v[26:27], v172 offset:5312
    v_exp_f32 v90, v90
    v_exp_f32 v91, v91
    v_exp_f32 v92, v92
    v_exp_f32 v93, v93
    v_mfma_f32_32x32x16_bf16 v[48:63], v[20:23], v[8:11], v[48:63]
    ds_read_b128 v[32:35], v174 offset:896
    v_exp_f32 v94, v94
    v_exp_f32 v95, v95
    v_exp_f32 v104, v104
    v_exp_f32 v105, v105
    v_mfma_f32_32x32x16_bf16 v[64:79], v[20:23], v[12:15], v[64:79]
    v_exp_f32 v106, v106
    v_exp_f32 v107, v107
    v_exp_f32 v108, v108
    v_exp_f32 v109, v109
    v_smfmac_f32_32x32x32_bf16 v[184:199], v[44:47], v[88:95], v175
    v_exp_f32 v110, v110
    v_exp_f32 v111, v111
    v_exp_f32 v48, v48
    v_exp_f32 v49, v49
    v_smfmac_f32_32x32x32_bf16 v[200:215], v[44:47], v[104:111], v175
    s_waitcnt lgkmcnt(0)
    v_exp_f32 v50, v50
    v_exp_f32_e64 v51, v51
    v_exp_f32 v52, v52
    v_exp_f32 v53, v53
    v_mfma_f32_32x32x4_2b_bf16 v[80:111], v[30:31], v[16:17], 0 cbsz:1 abid:1
    ds_read_b128 v[44:47], v174 offset:992
    v_exp_f32 v54, v54
    v_exp_f32 v55, v55
    v_exp_f32 v64, v64
    v_exp_f32 v65, v65
    v_exp_f32 v66, v66
    v_exp_f32 v67, v67
    v_exp_f32 v68, v68
    v_exp_f32 v69, v69
    v_smfmac_f32_32x32x32_bf16 v[184:199], v[32:35], v[48:55], v175
    v_add_u32 v172, 38400, v172
    ds_read_b64_tr_b16 v[20:21], v172 offset:0
    v_exp_f32 v70, v70
    v_exp_f32 v71, v71
    v_exp_f32 v56, v56
    v_exp_f32 v57, v57
    v_smfmac_f32_32x32x32_bf16 v[200:215], v[32:35], v[64:71], v175
    ds_read_b64_tr_b16 v[22:23], v172 offset:4352
    v_exp_f32 v58, v58
    v_exp_f32 v59, v59
    v_exp_f32 v60, v60
    v_exp_f32 v61, v61
    v_mfma_f32_32x32x16_bf16 v[80:95], v[24:27], v[8:11], v[80:95]
    ds_read_b128 v[36:39], v174 offset:960
    v_exp_f32 v62, v62
    v_exp_f32 v63, v63
    v_exp_f32 v72, v72
    v_exp_f32 v73, v73
    v_mfma_f32_32x32x16_bf16 v[96:111], v[24:27], v[12:15], v[96:111]
    v_add_u32_e64 v173, v173, v176
    ds_read_b64_tr_b16 v[28:29], v173 offset:0
    v_exp_f32 v74, v74
    v_exp_f32 v75, v75
    v_exp_f32 v76, v76
    v_exp_f32 v77, v77
    v_smfmac_f32_32x32x32_bf16 v[184:199], v[40:43], v[56:63], v175
    v_exp_f32 v78, v78
    v_exp_f32 v79, v79
    v_exp_f32 v80, v80
    v_exp_f32 v81, v81
    v_smfmac_f32_32x32x32_bf16 v[200:215], v[40:43], v[72:79], v175
    s_waitcnt lgkmcnt(0)
    v_exp_f32 v82, v82
    v_exp_f32_e64 v83, v83
    v_exp_f32 v84, v84
    v_exp_f32 v85, v85
    v_mfma_f32_32x32x4_2b_bf16 v[48:79], v[28:29], v[16:17], 0 cbsz:1 abid:0
    v_add_u32_e64 v174, v174, v177
    ds_read_b128 v[40:43], v174 offset:32
    v_exp_f32 v86, v86
    v_exp_f32 v87, v87
    v_exp_f32 v96, v96
    v_exp_f32 v97, v97
    v_exp_f32 v98, v98
    v_exp_f32 v99, v99
    v_exp_f32 v100, v100
    v_exp_f32 v101, v101
    v_smfmac_f32_32x32x32_bf16 v[184:199], v[36:39], v[80:87], v175
    ds_read_b64_tr_b16 v[24:25], v172 offset:64
    v_exp_f32 v102, v102
    v_exp_f32 v103, v103
    v_exp_f32 v88, v88
    v_exp_f32 v89, v89
    v_smfmac_f32_32x32x32_bf16 v[200:215], v[36:39], v[96:103], v175
    ds_read_b64_tr_b16 v[26:27], v172 offset:4416
    v_exp_f32 v90, v90
    v_exp_f32 v91, v91
    v_exp_f32 v92, v92
    v_exp_f32 v93, v93
    v_mfma_f32_32x32x16_bf16 v[48:63], v[20:23], v[8:11], v[48:63]
    ds_read_b128 v[32:35], v174 offset:0
    v_exp_f32 v94, v94
    v_exp_f32 v95, v95
    v_exp_f32 v104, v104
    v_exp_f32 v105, v105
    v_mfma_f32_32x32x16_bf16 v[64:79], v[20:23], v[12:15], v[64:79]
    s_mov_b64 exec, 1
    ds_add_u32 v170, v171 offset:52
    s_mov_b64 exec, -1
    v_exp_f32 v106, v106
    v_exp_f32 v107, v107
    v_exp_f32 v108, v108
    v_exp_f32 v109, v109
    v_smfmac_f32_32x32x32_bf16 v[184:199], v[44:47], v[88:95], v175
    v_exp_f32 v110, v110
    v_exp_f32 v111, v111
    v_exp_f32 v48, v48
    v_exp_f32 v49, v49
    v_smfmac_f32_32x32x32_bf16 v[200:215], v[44:47], v[104:111], v175
    s_waitcnt lgkmcnt(0)
    v_exp_f32 v50, v50
    v_exp_f32_e64 v51, v51
    v_exp_f32 v52, v52
    v_exp_f32 v53, v53
    v_mfma_f32_32x32x4_2b_bf16 v[80:111], v[28:29], v[16:17], 0 cbsz:1 abid:1
    ds_read_b128 v[44:47], v174 offset:96
    v_exp_f32 v54, v54
    v_exp_f32 v55, v55
    v_exp_f32 v64, v64
    v_exp_f32 v65, v65
    v_exp_f32 v66, v66
    v_exp_f32 v67, v67
    v_exp_f32 v68, v68
    v_exp_f32 v69, v69
    v_smfmac_f32_32x32x32_bf16 v[184:199], v[32:35], v[48:55], v175
    ds_read_b64_tr_b16 v[20:21], v172 offset:128
    v_exp_f32 v70, v70
    v_exp_f32 v71, v71
    v_exp_f32 v56, v56
    v_exp_f32 v57, v57
    v_smfmac_f32_32x32x32_bf16 v[200:215], v[32:35], v[64:71], v175
    ds_read_b64_tr_b16 v[22:23], v172 offset:4480
    v_exp_f32 v58, v58
    v_exp_f32 v59, v59
    v_exp_f32 v60, v60
    v_exp_f32 v61, v61
    v_mfma_f32_32x32x16_bf16 v[80:95], v[24:27], v[8:11], v[80:95]
    ds_read_b128 v[36:39], v174 offset:64
    v_exp_f32 v62, v62
    v_exp_f32 v63, v63
    v_exp_f32 v72, v72
    v_exp_f32 v73, v73
    v_mfma_f32_32x32x16_bf16 v[96:111], v[24:27], v[12:15], v[96:111]
    ds_read_b64_tr_b16 v[30:31], v173 offset:128
    v_exp_f32 v74, v74
    v_exp_f32 v75, v75
    v_exp_f32 v76, v76
    v_exp_f32 v77, v77
    v_smfmac_f32_32x32x32_bf16 v[184:199], v[40:43], v[56:63], v175
    v_exp_f32 v78, v78
    v_exp_f32 v79, v79
    v_exp_f32 v80, v80
    v_exp_f32 v81, v81
    v_smfmac_f32_32x32x32_bf16 v[200:215], v[40:43], v[72:79], v175
    s_waitcnt lgkmcnt(0)
    v_exp_f32 v82, v82
    v_exp_f32_e64 v83, v83
    v_exp_f32 v84, v84
    v_exp_f32 v85, v85
    v_mfma_f32_32x32x4_2b_bf16 v[48:79], v[30:31], v[16:17], 0 cbsz:1 abid:0
    ds_read_b128 v[40:43], v174 offset:160
    v_exp_f32 v86, v86
    v_exp_f32 v87, v87
    v_exp_f32 v96, v96
    v_exp_f32 v97, v97
    v_exp_f32 v98, v98
    v_exp_f32 v99, v99
    v_exp_f32 v100, v100
    v_exp_f32 v101, v101
    v_smfmac_f32_32x32x32_bf16 v[184:199], v[36:39], v[80:87], v175
    ds_read_b64_tr_b16 v[24:25], v172 offset:192
    v_exp_f32 v102, v102
    v_exp_f32 v103, v103
    v_exp_f32 v88, v88
    v_exp_f32 v89, v89
    v_smfmac_f32_32x32x32_bf16 v[200:215], v[36:39], v[96:103], v175
    ds_read_b64_tr_b16 v[26:27], v172 offset:4544
    v_exp_f32 v90, v90
    v_exp_f32 v91, v91
    v_exp_f32 v92, v92
    v_exp_f32 v93, v93
    v_mfma_f32_32x32x16_bf16 v[48:63], v[20:23], v[8:11], v[48:63]
    ds_read_b128 v[32:35], v174 offset:128
    v_exp_f32 v94, v94
    v_exp_f32 v95, v95
    v_exp_f32 v104, v104
    v_exp_f32 v105, v105
    v_mfma_f32_32x32x16_bf16 v[64:79], v[20:23], v[12:15], v[64:79]
    v_exp_f32 v106, v106
    v_exp_f32 v107, v107
    v_exp_f32 v108, v108
    v_exp_f32 v109, v109
    v_smfmac_f32_32x32x32_bf16 v[184:199], v[44:47], v[88:95], v175
    v_exp_f32 v110, v110
    v_exp_f32 v111, v111
    v_exp_f32 v48, v48
    v_exp_f32 v49, v49
    v_smfmac_f32_32x32x32_bf16 v[200:215], v[44:47], v[104:111], v175
    s_waitcnt lgkmcnt(0)
    v_exp_f32 v50, v50
    v_exp_f32_e64 v51, v51
    v_exp_f32 v52, v52
    v_exp_f32 v53, v53
    v_mfma_f32_32x32x4_2b_bf16 v[80:111], v[30:31], v[16:17], 0 cbsz:1 abid:1
    ds_read_b128 v[44:47], v174 offset:224
    v_exp_f32 v54, v54
    v_exp_f32 v55, v55
    v_exp_f32 v64, v64
    v_exp_f32 v65, v65
    v_exp_f32 v66, v66
    v_exp_f32 v67, v67
    v_exp_f32 v68, v68
    v_exp_f32 v69, v69
    v_smfmac_f32_32x32x32_bf16 v[184:199], v[32:35], v[48:55], v175
    ds_read_b64_tr_b16 v[20:21], v172 offset:256
    v_exp_f32 v70, v70
    v_exp_f32 v71, v71
    v_exp_f32 v56, v56
    v_exp_f32 v57, v57
    v_smfmac_f32_32x32x32_bf16 v[200:215], v[32:35], v[64:71], v175
    ds_read_b64_tr_b16 v[22:23], v172 offset:4608
    v_exp_f32 v58, v58
    v_exp_f32 v59, v59
    v_exp_f32 v60, v60
    v_exp_f32 v61, v61
    v_mfma_f32_32x32x16_bf16 v[80:95], v[24:27], v[8:11], v[80:95]
    ds_read_b128 v[36:39], v174 offset:192
    v_exp_f32 v62, v62
    v_exp_f32 v63, v63
    v_exp_f32 v72, v72
    v_exp_f32 v73, v73
    v_mfma_f32_32x32x16_bf16 v[96:111], v[24:27], v[12:15], v[96:111]
    ds_read_b64_tr_b16 v[28:29], v173 offset:256
    v_exp_f32 v74, v74
    v_exp_f32 v75, v75
    v_exp_f32 v76, v76
    v_exp_f32 v77, v77
    v_smfmac_f32_32x32x32_bf16 v[184:199], v[40:43], v[56:63], v175
    v_exp_f32 v78, v78
    v_exp_f32 v79, v79
    v_exp_f32 v80, v80
    v_exp_f32 v81, v81
    v_smfmac_f32_32x32x32_bf16 v[200:215], v[40:43], v[72:79], v175
    s_waitcnt lgkmcnt(0)
    v_exp_f32 v82, v82
    v_exp_f32_e64 v83, v83
    v_exp_f32 v84, v84
    v_exp_f32 v85, v85
    v_mfma_f32_32x32x4_2b_bf16 v[48:79], v[28:29], v[16:17], 0 cbsz:1 abid:0
    ds_read_b128 v[40:43], v174 offset:288
    v_exp_f32 v86, v86
    v_exp_f32 v87, v87
    v_exp_f32 v96, v96
    v_exp_f32 v97, v97
    v_exp_f32 v98, v98
    v_exp_f32 v99, v99
    v_exp_f32 v100, v100
    v_exp_f32 v101, v101
    v_smfmac_f32_32x32x32_bf16 v[184:199], v[36:39], v[80:87], v175
    ds_read_b64_tr_b16 v[24:25], v172 offset:320
    v_exp_f32 v102, v102
    v_exp_f32 v103, v103
    v_exp_f32 v88, v88
    v_exp_f32 v89, v89
    v_smfmac_f32_32x32x32_bf16 v[200:215], v[36:39], v[96:103], v175
    ds_read_b64_tr_b16 v[26:27], v172 offset:4672
    v_exp_f32 v90, v90
    v_exp_f32 v91, v91
    v_exp_f32 v92, v92
    v_exp_f32 v93, v93
    v_mfma_f32_32x32x16_bf16 v[48:63], v[20:23], v[8:11], v[48:63]
    ds_read_b128 v[32:35], v174 offset:256
    v_exp_f32 v94, v94
    v_exp_f32 v95, v95
    v_exp_f32 v104, v104
    v_exp_f32 v105, v105
    v_mfma_f32_32x32x16_bf16 v[64:79], v[20:23], v[12:15], v[64:79]
    v_exp_f32 v106, v106
    v_exp_f32 v107, v107
    v_exp_f32 v108, v108
    v_exp_f32 v109, v109
    v_smfmac_f32_32x32x32_bf16 v[184:199], v[44:47], v[88:95], v175
    v_exp_f32 v110, v110
    v_exp_f32 v111, v111
    v_exp_f32 v48, v48
    v_exp_f32 v49, v49
    v_smfmac_f32_32x32x32_bf16 v[200:215], v[44:47], v[104:111], v175
    s_waitcnt lgkmcnt(0)
    v_exp_f32 v50, v50
    v_exp_f32_e64 v51, v51
    v_exp_f32 v52, v52
    v_exp_f32 v53, v53
    v_mfma_f32_32x32x4_2b_bf16 v[80:111], v[28:29], v[16:17], 0 cbsz:1 abid:1
    ds_read_b128 v[44:47], v174 offset:352
    v_exp_f32 v54, v54
    v_exp_f32 v55, v55
    v_exp_f32 v64, v64
    v_exp_f32 v65, v65
    v_exp_f32 v66, v66
    v_exp_f32 v67, v67
    v_exp_f32 v68, v68
    v_exp_f32 v69, v69
    v_smfmac_f32_32x32x32_bf16 v[184:199], v[32:35], v[48:55], v175
    ds_read_b64_tr_b16 v[20:21], v172 offset:384
    v_exp_f32 v70, v70
    v_exp_f32 v71, v71
    v_exp_f32 v56, v56
    v_exp_f32 v57, v57
    v_smfmac_f32_32x32x32_bf16 v[200:215], v[32:35], v[64:71], v175
    ds_read_b64_tr_b16 v[22:23], v172 offset:4736
    v_exp_f32 v58, v58
    v_exp_f32 v59, v59
    v_exp_f32 v60, v60
    v_exp_f32 v61, v61
    v_mfma_f32_32x32x16_bf16 v[80:95], v[24:27], v[8:11], v[80:95]
    ds_read_b128 v[36:39], v174 offset:320
    v_exp_f32 v62, v62
    v_exp_f32 v63, v63
    v_exp_f32 v72, v72
    v_exp_f32 v73, v73
    v_mfma_f32_32x32x16_bf16 v[96:111], v[24:27], v[12:15], v[96:111]
    ds_read_b64_tr_b16 v[30:31], v173 offset:384
    v_exp_f32 v74, v74
    v_exp_f32 v75, v75
    v_exp_f32 v76, v76
    v_exp_f32 v77, v77
    v_smfmac_f32_32x32x32_bf16 v[184:199], v[40:43], v[56:63], v175
    v_exp_f32 v78, v78
    v_exp_f32 v79, v79
    v_exp_f32 v80, v80
    v_exp_f32 v81, v81
    v_smfmac_f32_32x32x32_bf16 v[200:215], v[40:43], v[72:79], v175
    s_waitcnt lgkmcnt(0)
    v_exp_f32 v82, v82
    v_exp_f32_e64 v83, v83
    v_exp_f32 v84, v84
    v_exp_f32 v85, v85
    v_mfma_f32_32x32x4_2b_bf16 v[48:79], v[30:31], v[16:17], 0 cbsz:1 abid:0
    ds_read_b128 v[40:43], v174 offset:416
    v_exp_f32 v86, v86
    v_exp_f32 v87, v87
    v_exp_f32 v96, v96
    v_exp_f32 v97, v97
    v_exp_f32 v98, v98
    v_exp_f32 v99, v99
    v_exp_f32 v100, v100
    v_exp_f32 v101, v101
    v_smfmac_f32_32x32x32_bf16 v[184:199], v[36:39], v[80:87], v175
    ds_read_b64_tr_b16 v[24:25], v172 offset:448
    v_exp_f32 v102, v102
    v_exp_f32 v103, v103
    v_exp_f32 v88, v88
    v_exp_f32 v89, v89
    v_smfmac_f32_32x32x32_bf16 v[200:215], v[36:39], v[96:103], v175
    ds_read_b64_tr_b16 v[26:27], v172 offset:4800
    v_exp_f32 v90, v90
    v_exp_f32 v91, v91
    v_exp_f32 v92, v92
    v_exp_f32 v93, v93
    v_mfma_f32_32x32x16_bf16 v[48:63], v[20:23], v[8:11], v[48:63]
    ds_read_b128 v[32:35], v174 offset:384
    v_exp_f32 v94, v94
    v_exp_f32 v95, v95
    v_exp_f32 v104, v104
    v_exp_f32 v105, v105
    v_mfma_f32_32x32x16_bf16 v[64:79], v[20:23], v[12:15], v[64:79]
    v_exp_f32 v106, v106
    v_exp_f32 v107, v107
    v_exp_f32 v108, v108
    v_exp_f32 v109, v109
    v_smfmac_f32_32x32x32_bf16 v[184:199], v[44:47], v[88:95], v175
    v_exp_f32 v110, v110
    v_exp_f32 v111, v111
    v_exp_f32 v48, v48
    v_exp_f32 v49, v49
    v_smfmac_f32_32x32x32_bf16 v[200:215], v[44:47], v[104:111], v175
    s_waitcnt lgkmcnt(0)
    v_exp_f32 v50, v50
    v_exp_f32_e64 v51, v51
    v_exp_f32 v52, v52
    v_exp_f32 v53, v53
    v_mfma_f32_32x32x4_2b_bf16 v[80:111], v[30:31], v[16:17], 0 cbsz:1 abid:1
    ds_read_b128 v[44:47], v174 offset:480
    v_exp_f32 v54, v54
    v_exp_f32 v55, v55
    v_exp_f32 v64, v64
    v_exp_f32 v65, v65
    v_exp_f32 v66, v66
    v_exp_f32 v67, v67
    v_exp_f32 v68, v68
    v_exp_f32 v69, v69
    v_smfmac_f32_32x32x32_bf16 v[184:199], v[32:35], v[48:55], v175
    ds_read_b64_tr_b16 v[20:21], v172 offset:512
    v_exp_f32 v70, v70
    v_exp_f32 v71, v71
    v_exp_f32 v56, v56
    v_exp_f32 v57, v57
    v_smfmac_f32_32x32x32_bf16 v[200:215], v[32:35], v[64:71], v175
    ds_read_b64_tr_b16 v[22:23], v172 offset:4864
    v_exp_f32 v58, v58
    v_exp_f32 v59, v59
    v_exp_f32 v60, v60
    v_exp_f32 v61, v61
    v_mfma_f32_32x32x16_bf16 v[80:95], v[24:27], v[8:11], v[80:95]
    ds_read_b128 v[36:39], v174 offset:448
    v_exp_f32 v62, v62
    v_exp_f32 v63, v63
    v_exp_f32 v72, v72
    v_exp_f32 v73, v73
    v_mfma_f32_32x32x16_bf16 v[96:111], v[24:27], v[12:15], v[96:111]
    ds_read_b64_tr_b16 v[28:29], v173 offset:512
    v_exp_f32 v74, v74
    v_exp_f32 v75, v75
    v_exp_f32 v76, v76
    v_exp_f32 v77, v77
    v_smfmac_f32_32x32x32_bf16 v[184:199], v[40:43], v[56:63], v175
    v_exp_f32 v78, v78
    v_exp_f32 v79, v79
    v_exp_f32 v80, v80
    v_exp_f32 v81, v81
    v_smfmac_f32_32x32x32_bf16 v[200:215], v[40:43], v[72:79], v175
    s_waitcnt lgkmcnt(0)
    v_exp_f32 v82, v82
    v_exp_f32_e64 v83, v83
    v_exp_f32 v84, v84
    v_exp_f32 v85, v85
    v_mfma_f32_32x32x4_2b_bf16 v[48:79], v[28:29], v[16:17], 0 cbsz:1 abid:0
    ds_read_b128 v[40:43], v174 offset:544
    v_exp_f32 v86, v86
    v_exp_f32 v87, v87
    v_exp_f32 v96, v96
    v_exp_f32 v97, v97
    v_exp_f32 v98, v98
    v_exp_f32 v99, v99
    v_exp_f32 v100, v100
    v_exp_f32 v101, v101
    v_smfmac_f32_32x32x32_bf16 v[184:199], v[36:39], v[80:87], v175
    ds_read_b64_tr_b16 v[24:25], v172 offset:576
    v_exp_f32 v102, v102
    v_exp_f32 v103, v103
    v_exp_f32 v88, v88
    v_exp_f32 v89, v89
    v_smfmac_f32_32x32x32_bf16 v[200:215], v[36:39], v[96:103], v175
    ds_read_b64_tr_b16 v[26:27], v172 offset:4928
    v_exp_f32 v90, v90
    v_exp_f32 v91, v91
    v_exp_f32 v92, v92
    v_exp_f32 v93, v93
    v_mfma_f32_32x32x16_bf16 v[48:63], v[20:23], v[8:11], v[48:63]
    ds_read_b128 v[32:35], v174 offset:512
    v_exp_f32 v94, v94
    v_exp_f32 v95, v95
    v_exp_f32 v104, v104
    v_exp_f32 v105, v105
    v_mfma_f32_32x32x16_bf16 v[64:79], v[20:23], v[12:15], v[64:79]
    v_exp_f32 v106, v106
    v_exp_f32 v107, v107
    v_exp_f32 v108, v108
    v_exp_f32 v109, v109
    v_smfmac_f32_32x32x32_bf16 v[184:199], v[44:47], v[88:95], v175
    v_exp_f32 v110, v110
    v_exp_f32 v111, v111
    v_exp_f32 v48, v48
    v_exp_f32 v49, v49
    v_smfmac_f32_32x32x32_bf16 v[200:215], v[44:47], v[104:111], v175
    s_waitcnt lgkmcnt(0)
    v_exp_f32 v50, v50
    v_exp_f32_e64 v51, v51
    v_exp_f32 v52, v52
    v_exp_f32 v53, v53
    v_mfma_f32_32x32x4_2b_bf16 v[80:111], v[28:29], v[16:17], 0 cbsz:1 abid:1
    ds_read_b128 v[44:47], v174 offset:608
    v_exp_f32 v54, v54
    v_exp_f32 v55, v55
    v_exp_f32 v64, v64
    v_exp_f32 v65, v65
    v_exp_f32 v66, v66
    v_exp_f32 v67, v67
    v_exp_f32 v68, v68
    v_exp_f32 v69, v69
    v_smfmac_f32_32x32x32_bf16 v[184:199], v[32:35], v[48:55], v175
    ds_read_b64_tr_b16 v[20:21], v172 offset:640
    v_exp_f32 v70, v70
    v_exp_f32 v71, v71
    v_exp_f32 v56, v56
    v_exp_f32 v57, v57
    v_smfmac_f32_32x32x32_bf16 v[200:215], v[32:35], v[64:71], v175
    ds_read_b64_tr_b16 v[22:23], v172 offset:4992
    v_exp_f32 v58, v58
    v_exp_f32 v59, v59
    v_exp_f32 v60, v60
    v_exp_f32 v61, v61
    v_mfma_f32_32x32x16_bf16 v[80:95], v[24:27], v[8:11], v[80:95]
    ds_read_b128 v[36:39], v174 offset:576
    v_exp_f32 v62, v62
    v_exp_f32 v63, v63
    v_exp_f32 v72, v72
    v_exp_f32 v73, v73
    v_mfma_f32_32x32x16_bf16 v[96:111], v[24:27], v[12:15], v[96:111]
    ds_read_b64_tr_b16 v[30:31], v173 offset:640
    v_exp_f32 v74, v74
    v_exp_f32 v75, v75
    v_exp_f32 v76, v76
    v_exp_f32 v77, v77
    v_smfmac_f32_32x32x32_bf16 v[184:199], v[40:43], v[56:63], v175
    v_exp_f32 v78, v78
    v_exp_f32 v79, v79
    v_exp_f32 v80, v80
    v_exp_f32 v81, v81
    v_smfmac_f32_32x32x32_bf16 v[200:215], v[40:43], v[72:79], v175
    s_waitcnt lgkmcnt(0)
    v_exp_f32 v82, v82
    v_exp_f32_e64 v83, v83
    v_exp_f32 v84, v84
    v_exp_f32 v85, v85
    v_mfma_f32_32x32x4_2b_bf16 v[48:79], v[30:31], v[16:17], 0 cbsz:1 abid:0
    ds_read_b128 v[40:43], v174 offset:672
    v_exp_f32 v86, v86
    v_exp_f32 v87, v87
    v_exp_f32 v96, v96
    v_exp_f32 v97, v97
    v_exp_f32 v98, v98
    v_exp_f32 v99, v99
    v_exp_f32 v100, v100
    v_exp_f32 v101, v101
    v_smfmac_f32_32x32x32_bf16 v[184:199], v[36:39], v[80:87], v175
    ds_read_b64_tr_b16 v[24:25], v172 offset:704
    v_exp_f32 v102, v102
    v_exp_f32 v103, v103
    v_exp_f32 v88, v88
    v_exp_f32 v89, v89
    v_smfmac_f32_32x32x32_bf16 v[200:215], v[36:39], v[96:103], v175
    ds_read_b64_tr_b16 v[26:27], v172 offset:5056
    v_exp_f32 v90, v90
    v_exp_f32 v91, v91
    v_exp_f32 v92, v92
    v_exp_f32 v93, v93
    v_mfma_f32_32x32x16_bf16 v[48:63], v[20:23], v[8:11], v[48:63]
    ds_read_b128 v[32:35], v174 offset:640
    v_exp_f32 v94, v94
    v_exp_f32 v95, v95
    v_exp_f32 v104, v104
    v_exp_f32 v105, v105
    v_mfma_f32_32x32x16_bf16 v[64:79], v[20:23], v[12:15], v[64:79]
    v_exp_f32 v106, v106
    v_exp_f32 v107, v107
    v_exp_f32 v108, v108
    v_exp_f32 v109, v109
    v_smfmac_f32_32x32x32_bf16 v[184:199], v[44:47], v[88:95], v175
    v_exp_f32 v110, v110
    v_exp_f32 v111, v111
    v_exp_f32 v48, v48
    v_exp_f32 v49, v49
    v_smfmac_f32_32x32x32_bf16 v[200:215], v[44:47], v[104:111], v175
    s_waitcnt lgkmcnt(0)
    v_exp_f32 v50, v50
    v_exp_f32_e64 v51, v51
    v_exp_f32 v52, v52
    v_exp_f32 v53, v53
    v_mfma_f32_32x32x4_2b_bf16 v[80:111], v[30:31], v[16:17], 0 cbsz:1 abid:1
    ds_read_b128 v[44:47], v174 offset:736
    v_exp_f32 v54, v54
    v_exp_f32 v55, v55
    v_exp_f32 v64, v64
    v_exp_f32 v65, v65
    v_exp_f32 v66, v66
    v_exp_f32 v67, v67
    v_exp_f32 v68, v68
    v_exp_f32 v69, v69
    v_smfmac_f32_32x32x32_bf16 v[184:199], v[32:35], v[48:55], v175
    ds_read_b64_tr_b16 v[20:21], v172 offset:768
    v_exp_f32 v70, v70
    v_exp_f32 v71, v71
    v_exp_f32 v56, v56
    v_exp_f32 v57, v57
    v_smfmac_f32_32x32x32_bf16 v[200:215], v[32:35], v[64:71], v175
    ds_read_b64_tr_b16 v[22:23], v172 offset:5120
    v_exp_f32 v58, v58
    v_exp_f32 v59, v59
    v_exp_f32 v60, v60
    v_exp_f32 v61, v61
    v_mfma_f32_32x32x16_bf16 v[80:95], v[24:27], v[8:11], v[80:95]
    ds_read_b128 v[36:39], v174 offset:704
    v_exp_f32 v62, v62
    v_exp_f32 v63, v63
    v_exp_f32 v72, v72
    v_exp_f32 v73, v73
    v_mfma_f32_32x32x16_bf16 v[96:111], v[24:27], v[12:15], v[96:111]
    ds_read_b64_tr_b16 v[28:29], v173 offset:768
    v_exp_f32 v74, v74
    v_exp_f32 v75, v75
    v_exp_f32 v76, v76
    v_exp_f32 v77, v77
    v_smfmac_f32_32x32x32_bf16 v[184:199], v[40:43], v[56:63], v175
    v_exp_f32 v78, v78
    v_exp_f32 v79, v79
    v_exp_f32 v80, v80
    v_exp_f32 v81, v81
    v_smfmac_f32_32x32x32_bf16 v[200:215], v[40:43], v[72:79], v175
    s_waitcnt lgkmcnt(0)
    v_exp_f32 v82, v82
    v_exp_f32_e64 v83, v83
    v_exp_f32 v84, v84
    v_exp_f32 v85, v85
    v_mfma_f32_32x32x4_2b_bf16 v[48:79], v[28:29], v[16:17], 0 cbsz:1 abid:0
    ds_read_b128 v[40:43], v174 offset:800
    v_exp_f32 v86, v86
    v_exp_f32 v87, v87
    v_exp_f32 v96, v96
    v_exp_f32 v97, v97
    v_exp_f32 v98, v98
    v_exp_f32 v99, v99
    v_exp_f32 v100, v100
    v_exp_f32 v101, v101
    v_smfmac_f32_32x32x32_bf16 v[184:199], v[36:39], v[80:87], v175
    ds_read_b64_tr_b16 v[24:25], v172 offset:832
    v_exp_f32 v102, v102
    v_exp_f32 v103, v103
    v_exp_f32 v88, v88
    v_exp_f32 v89, v89
    v_smfmac_f32_32x32x32_bf16 v[200:215], v[36:39], v[96:103], v175
    ds_read_b64_tr_b16 v[26:27], v172 offset:5184
    v_exp_f32 v90, v90
    v_exp_f32 v91, v91
    v_exp_f32 v92, v92
    v_exp_f32 v93, v93
    v_mfma_f32_32x32x16_bf16 v[48:63], v[20:23], v[8:11], v[48:63]
    ds_read_b128 v[32:35], v174 offset:768
    v_exp_f32 v94, v94
    v_exp_f32 v95, v95
    v_exp_f32 v104, v104
    v_exp_f32 v105, v105
    v_mfma_f32_32x32x16_bf16 v[64:79], v[20:23], v[12:15], v[64:79]
    v_exp_f32 v106, v106
    v_exp_f32 v107, v107
    v_exp_f32 v108, v108
    v_exp_f32 v109, v109
    v_smfmac_f32_32x32x32_bf16 v[184:199], v[44:47], v[88:95], v175
    v_exp_f32 v110, v110
    v_exp_f32 v111, v111
    v_exp_f32 v48, v48
    v_exp_f32 v49, v49
    v_smfmac_f32_32x32x32_bf16 v[200:215], v[44:47], v[104:111], v175
    s_waitcnt lgkmcnt(0)
    v_exp_f32 v50, v50
    v_exp_f32_e64 v51, v51
    v_exp_f32 v52, v52
    v_exp_f32 v53, v53
    v_mfma_f32_32x32x4_2b_bf16 v[80:111], v[28:29], v[16:17], 0 cbsz:1 abid:1
    ds_read_b128 v[44:47], v174 offset:864
    v_exp_f32 v54, v54
    v_exp_f32 v55, v55
    v_exp_f32 v64, v64
    v_exp_f32 v65, v65
    v_exp_f32 v66, v66
    v_exp_f32 v67, v67
    v_exp_f32 v68, v68
    v_exp_f32 v69, v69
    v_smfmac_f32_32x32x32_bf16 v[184:199], v[32:35], v[48:55], v175
    ds_read_b64_tr_b16 v[20:21], v172 offset:896
    v_exp_f32 v70, v70
    v_exp_f32 v71, v71
    v_exp_f32 v56, v56
    v_exp_f32 v57, v57
    v_smfmac_f32_32x32x32_bf16 v[200:215], v[32:35], v[64:71], v175
    ds_read_b64_tr_b16 v[22:23], v172 offset:5248
    v_exp_f32 v58, v58
    v_exp_f32 v59, v59
    v_exp_f32 v60, v60
    v_exp_f32 v61, v61
    v_mfma_f32_32x32x16_bf16 v[80:95], v[24:27], v[8:11], v[80:95]
    ds_read_b128 v[36:39], v174 offset:832
    v_exp_f32 v62, v62
    v_exp_f32 v63, v63
    v_exp_f32 v72, v72
    v_exp_f32 v73, v73
    v_mfma_f32_32x32x16_bf16 v[96:111], v[24:27], v[12:15], v[96:111]
    ds_read_b64_tr_b16 v[30:31], v173 offset:896
    v_exp_f32 v74, v74
    v_exp_f32 v75, v75
    v_exp_f32 v76, v76
    v_exp_f32 v77, v77
    v_smfmac_f32_32x32x32_bf16 v[184:199], v[40:43], v[56:63], v175
    v_exp_f32 v78, v78
    v_exp_f32 v79, v79
    v_exp_f32 v80, v80
    v_exp_f32 v81, v81
    v_smfmac_f32_32x32x32_bf16 v[200:215], v[40:43], v[72:79], v175
    s_waitcnt lgkmcnt(0)
    v_exp_f32 v82, v82
    v_exp_f32_e64 v83, v83
    v_exp_f32 v84, v84
    v_exp_f32 v85, v85
    v_mfma_f32_32x32x4_2b_bf16 v[48:79], v[30:31], v[16:17], 0 cbsz:1 abid:0
    ds_read_b128 v[40:43], v174 offset:928
    v_exp_f32 v86, v86
    v_exp_f32 v87, v87
    v_exp_f32 v96, v96
    v_exp_f32 v97, v97
    v_exp_f32 v98, v98
    v_exp_f32 v99, v99
    v_exp_f32 v100, v100
    v_exp_f32 v101, v101
    v_smfmac_f32_32x32x32_bf16 v[184:199], v[36:39], v[80:87], v175
    ds_read_b64_tr_b16 v[24:25], v172 offset:960
    v_exp_f32 v102, v102
    v_exp_f32 v103, v103
    v_exp_f32 v88, v88
    v_exp_f32 v89, v89
    v_smfmac_f32_32x32x32_bf16 v[200:215], v[36:39], v[96:103], v175
    ds_read_b64_tr_b16 v[26:27], v172 offset:5312
    v_exp_f32 v90, v90
    v_exp_f32 v91, v91
    v_exp_f32 v92, v92
    v_exp_f32 v93, v93
    v_mfma_f32_32x32x16_bf16 v[48:63], v[20:23], v[8:11], v[48:63]
    ds_read_b128 v[32:35], v174 offset:896
    v_exp_f32 v94, v94
    v_exp_f32 v95, v95
    v_exp_f32 v104, v104
    v_exp_f32 v105, v105
    v_mfma_f32_32x32x16_bf16 v[64:79], v[20:23], v[12:15], v[64:79]
    v_exp_f32 v106, v106
    v_exp_f32 v107, v107
    v_exp_f32 v108, v108
    v_exp_f32 v109, v109
    v_smfmac_f32_32x32x32_bf16 v[184:199], v[44:47], v[88:95], v175
    v_exp_f32 v110, v110
    v_exp_f32 v111, v111
    v_exp_f32 v48, v48
    v_exp_f32 v49, v49
    v_smfmac_f32_32x32x32_bf16 v[200:215], v[44:47], v[104:111], v175
    s_waitcnt lgkmcnt(0)
    v_exp_f32 v50, v50
    v_exp_f32_e64 v51, v51
    v_exp_f32 v52, v52
    v_exp_f32 v53, v53
    v_mfma_f32_32x32x4_2b_bf16 v[80:111], v[30:31], v[16:17], 0 cbsz:1 abid:1
    ds_read_b128 v[44:47], v174 offset:992
    v_exp_f32 v54, v54
    v_exp_f32 v55, v55
    v_exp_f32 v64, v64
    v_exp_f32 v65, v65
    v_exp_f32 v66, v66
    v_exp_f32 v67, v67
    v_exp_f32 v68, v68
    v_exp_f32 v69, v69
    v_smfmac_f32_32x32x32_bf16 v[184:199], v[32:35], v[48:55], v175
    v_exp_f32 v70, v70
    v_exp_f32 v71, v71
    v_exp_f32 v56, v56
    v_exp_f32 v57, v57
    v_smfmac_f32_32x32x32_bf16 v[200:215], v[32:35], v[64:71], v175
    v_exp_f32 v58, v58
    v_exp_f32 v59, v59
    v_exp_f32 v60, v60
    v_exp_f32 v61, v61
    v_mfma_f32_32x32x16_bf16 v[80:95], v[24:27], v[8:11], v[80:95]
    ds_read_b128 v[36:39], v174 offset:960
    v_exp_f32 v62, v62
    v_exp_f32 v63, v63
    v_exp_f32 v72, v72
    v_exp_f32 v73, v73
    v_mfma_f32_32x32x16_bf16 v[96:111], v[24:27], v[12:15], v[96:111]
    v_exp_f32 v74, v74
    v_exp_f32 v75, v75
    v_exp_f32 v76, v76
    v_exp_f32 v77, v77
    v_smfmac_f32_32x32x32_bf16 v[184:199], v[40:43], v[56:63], v175
    v_exp_f32 v78, v78
    v_exp_f32 v79, v79
    v_exp_f32 v80, v80
    v_exp_f32 v81, v81
    v_smfmac_f32_32x32x32_bf16 v[200:215], v[40:43], v[72:79], v175
    s_waitcnt lgkmcnt(0)
    v_exp_f32 v82, v82
    v_exp_f32_e64 v83, v83
    v_exp_f32 v84, v84
    v_exp_f32 v85, v85
    v_exp_f32 v86, v86
    v_exp_f32 v87, v87
    v_exp_f32 v96, v96
    v_exp_f32 v97, v97
    v_exp_f32 v98, v98
    v_exp_f32 v99, v99
    v_exp_f32 v100, v100
    v_exp_f32 v101, v101
    v_smfmac_f32_32x32x32_bf16 v[184:199], v[36:39], v[80:87], v175
    v_exp_f32 v102, v102
    v_exp_f32 v103, v103
    v_exp_f32 v88, v88
    v_exp_f32 v89, v89
    v_smfmac_f32_32x32x32_bf16 v[200:215], v[36:39], v[96:103], v175
    v_exp_f32 v90, v90
    v_exp_f32 v91, v91
    v_exp_f32 v92, v92
    v_exp_f32 v93, v93
    v_exp_f32 v94, v94
    v_exp_f32 v95, v95
    v_exp_f32 v104, v104
    v_exp_f32 v105, v105
    v_exp_f32 v106, v106
    v_exp_f32 v107, v107
    v_exp_f32 v108, v108
    v_exp_f32 v109, v109
    v_smfmac_f32_32x32x32_bf16 v[184:199], v[44:47], v[88:95], v175
    v_exp_f32 v110, v110
    v_exp_f32 v111, v111
    s_nop 1
    v_smfmac_f32_32x32x32_bf16 v[200:215], v[44:47], v[104:111], v175
    s_mov_b32 s44, 0x2b800000
    s_mov_b32 s45, 0x5d800000
    s_nop 7
    v_mov_b32 v172, v194
    v_mov_b32 v171, v194
    s_nop 1
    v_permlane32_swap_b32 v172, v171
    v_fma_f32 v168, v184, 0, v194
    v_fma_f32 v168, v185, 0, v168
    v_fma_f32 v168, v186, 0, v168
    v_fma_f32 v168, v187, 0, v168
    v_fma_f32 v168, v188, 0, v168
    v_fma_f32 v168, v189, 0, v168
    v_fma_f32 v168, v190, 0, v168
    v_fma_f32 v168, v191, 0, v168
    v_fma_f32 v168, v192, 0, v168
    v_fma_f32 v168, v193, 0, v168
    v_fma_f32 v168, v168, 0, v172
    v_mov_b32 v173, v210
    v_mov_b32 v171, v210
    s_nop 1
    v_permlane32_swap_b32 v173, v171
    v_fma_f32 v169, v200, 0, v210
    v_fma_f32 v169, v201, 0, v169
    v_fma_f32 v169, v202, 0, v169
    v_fma_f32 v169, v203, 0, v169
    v_fma_f32 v169, v204, 0, v169
    v_fma_f32 v169, v205, 0, v169
    v_fma_f32 v169, v206, 0, v169
    v_fma_f32 v169, v207, 0, v169
    v_fma_f32 v169, v208, 0, v169
    v_fma_f32 v169, v209, 0, v169
    v_fma_f32 v169, v169, 0, v173
    v_cmp_nle_f32 s[46:47], s44, v168
    v_cmp_nge_f32 s[48:49], s45, v168
    s_or_b64 s[46:47], s[46:47], s[48:49]
    v_cmp_nle_f32 s[48:49], s44, v169
    v_cmp_nge_f32 vcc, s45, v169
    s_or_b64 s[46:47], s[46:47], s[48:49]
    s_or_b64 vcc, vcc, s[46:47]
    s_cbranch_vccnz L_a_fallback
    s_mov_b64 exec, 1
    v_mov_b32 v170, 153536
    v_mov_b32 v171, 1
    ds_add_u32 v170, v171 offset:40
    s_mov_b64 exec, -1
L_a_store:
    v_rcp_f32 v168, v172
    v_rcp_f32 v169, v173
    v_mul_f32 v184, v184, v168
    v_mul_f32 v185, v185, v168
    v_mul_f32 v186, v186, v168
    v_mul_f32 v187, v187, v168
    v_mul_f32 v188, v188, v168
    v_mul_f32 v189, v189, v168
    v_mul_f32 v190, v190, v168
    v_mul_f32 v191, v191, v168
    v_mul_f32 v192, v192, v168
    v_mul_f32 v193, v193, v168
    v_cvt_pk_bf16_f32 v8, v184, v185
    v_cvt_pk_bf16_f32 v9, v186, v187
    v_cvt_pk_bf16_f32 v10, v188, v189
    v_cvt_pk_bf16_f32 v11, v190, v191
    v_cvt_pk_bf16_f32 v18, v192, v193
    v_min_u32 v8, -2, v8
    v_min_u32 v9, -2, v9
    v_min_u32 v10, -2, v10
    v_min_u32 v11, -2, v11
    buffer_store_dwordx4 v[8:11], v180, s[4:7], s0 offen offset:0 sc1
    v_mul_f32 v200, v200, v169
    v_mul_f32 v201, v201, v169
    v_mul_f32 v202, v202, v169
    v_mul_f32 v203, v203, v169
    v_mul_f32 v204, v204, v169
    v_mul_f32 v205, v205, v169
    v_mul_f32 v206, v206, v169
    v_mul_f32 v207, v207, v169
    v_mul_f32 v208, v208, v169
    v_mul_f32 v209, v209, v169
    v_cvt_pk_bf16_f32 v12, v200, v201
    v_cvt_pk_bf16_f32 v13, v202, v203
    v_cvt_pk_bf16_f32 v14, v204, v205
    v_cvt_pk_bf16_f32 v15, v206, v207
    v_cvt_pk_bf16_f32 v19, v208, v209
    v_min_u32 v12, -2, v12
    v_min_u32 v13, -2, v13
    v_min_u32 v14, -2, v14
    v_min_u32 v15, -2, v15
    buffer_store_dwordx4 v[12:15], v180, s[4:7], s0 offen offset:512 sc1
    v_permlane32_swap_b32 v18, v19
    s_nop 1
    v_min_u32 v18, -2, v18
    buffer_store_dword v18, v181, s[4:7], s1 offen sc1
    s_cmp_lg_u32 s3, 0
    s_cbranch_scc1 L_end
    s_cmp_ge_u32 s2, 192
    s_cbranch_scc1 L_end
    s_and_b32 s44, s2, 7
    s_lshl_b32 s44, s44, 2
    s_bfe_u32 s46, s2, 0x20003
    s_add_u32 s44, s44, s46
    s_lshl_b32 s44, s44, 8
    s_add_u32 s44, s44, 0x980000
    v_mul_u32_u24 v8, 8320, v0
    v_mov_b32 v11, 153536
L_lw7_t:
    ds_read_b32 v12, v11 offset:44
    s_waitcnt lgkmcnt(0)
    v_cmp_gt_u32 vcc, 4, v12
    s_cbranch_vccnz L_lw7
L_lw7_x:
    s_mov_b32 s60, 0
    s_mov_b64 exec, 0xffffffff
    buffer_load_dword v9, v8, s[4:7], s44 offen sc1
L_pb:
    s_sleep 2
    buffer_load_dword v10, v8, s[4:7], s44 offen sc1
    s_waitcnt vmcnt(1)
    v_cmp_ne_u32 vcc, -1, v9
    s_add_u32 s60, s60, 1
    s_nop 0
    v_mov_b32 v12, vcc_lo
    ds_write_b32 v11, v12 offset:12
    s_cmp_eq_u32 vcc_lo, -1
    s_cbranch_scc1 L_pb_x
    s_sleep 2
    buffer_load_dword v9, v8, s[4:7], s44 offen sc1
    s_waitcnt vmcnt(1)
    v_cmp_ne_u32 vcc, -1, v10
    s_add_u32 s60, s60, 1
    s_nop 0
    v_mov_b32 v12, vcc_lo
    ds_write_b32 v11, v12 offset:12
    s_cmp_eq_u32 vcc_lo, -1
    s_cbranch_scc1 L_pb_x
    s_cmp_lt_u32 s60, 0xf4240
    s_cbranch_scc1 L_pb
L_pb_x:
    s_mov_b64 exec, -1
    s_branch L_end
L_a_fallback:
    s_mov_b64 exec, 1
    v_mov_b32 v170, 153536
    v_mov_b32 v171, 1
    ds_add_u32 v170, v171 offset:40
    s_mov_b64 exec, -1
    v_mov_b32 v170, 153536
    s_setprio 0
L_lw8_t:
    ds_read_b32 v171, v170 offset:60
    s_waitcnt lgkmcnt(0)
    v_cmp_gt_u32 vcc, 1, v171
    s_cbranch_vccnz L_lw8
L_lw8_x:
    s_mul_i32 s48, s3, 2304
    s_add_u32 s48, s48, 153600
    v_and_b32 v168, 31, v0
    v_and_b32 v169, 0x13, v168
    v_and_b32 v170, 4, v168
    v_lshl_add_u32 v169, v170, 1, v169
    v_and_b32 v170, 8, v168
    v_lshrrev_b32 v170, 1, v170
    v_add_u32 v169, v169, v170
    v_lshlrev_b32 v169, 6, v169
    v_lshrrev_b32 v170, 5, v0
    v_lshl_add_u32 v169, v170, 4, v169
    s_add_u32 s49, s48, 1152
    v_cmp_gt_u32 vcc, 18, v168
    v_add_u32 v169, s49, v169
    v_mov_b32 v17, 0
    v_cndmask_b32 v174, v174, v169, vcc
    v_mov_b32 v168, 0xff800000
    v_mov_b32 v169, 0xff800000
    s_mov_b32 s46, 0
L_a_fb0:
    s_add_u32 m0, s48, 0
    s_add_u32 s47, s53, s46
    buffer_load_dwordx4 v182, s[4:7], s47 offen sc1 lds
    s_add_u32 m0, s48, 1024
    s_add_u32 s47, s47, 0x10000
    s_mov_b64 exec, 0xff
    buffer_load_dwordx4 v182, s[4:7], s47 offen sc1 lds
    s_mov_b64 exec, -1
    s_add_u32 m0, s48, 1152
    s_add_u32 s47, s54, s46
    buffer_load_dwordx4 v182, s[4:7], s47 offen sc1 lds
    s_add_u32 m0, s48, 2176
    s_add_u32 s47, s47, 0x10000
    s_mov_b64 exec, 0xff
    buffer_load_dwordx4 v182, s[4:7], s47 offen sc1 lds
    s_mov_b64 exec, -1
    s_waitcnt vmcnt(0)
    ds_read_b64_tr_b16 v[28:29], v179 offset:1024
    ds_read_b64_tr_b16 v[20:21], v178
    ds_read_b64_tr_b16 v[22:23], v178 offset:256
    ds_read_b128 v[32:35], v174 offset:0
    ds_read_b128 v[40:43], v174 offset:32
    s_waitcnt lgkmcnt(0)
    v_mfma_f32_32x32x4_2b_bf16 v[48:79], v[28:29], v[16:17], 0 cbsz:1 abid:0
    s_nop 15
    s_nop 1
    v_mfma_f32_32x32x16_bf16 v[48:63], v[20:23], v[8:11], v[48:63]
    v_mfma_f32_32x32x16_bf16 v[64:79], v[20:23], v[12:15], v[64:79]
    s_nop 15
    s_add_u32 s46, s46, 64
    v_max3_f32 v168, v168, v48, v49
    v_max3_f32 v168, v168, v50, v51
    v_max3_f32 v168, v168, v52, v53
    v_max3_f32 v168, v168, v54, v55
    v_max3_f32 v168, v168, v56, v57
    v_max3_f32 v168, v168, v58, v59
    v_max3_f32 v168, v168, v60, v61
    v_max3_f32 v168, v168, v62, v63
    v_max3_f32 v169, v169, v64, v65
    v_max3_f32 v169, v169, v66, v67
    v_max3_f32 v169, v169, v68, v69
    v_max3_f32 v169, v169, v70, v71
    v_max3_f32 v169, v169, v72, v73
    v_max3_f32 v169, v169, v74, v75
    v_max3_f32 v169, v169, v76, v77
    v_max3_f32 v169, v169, v78, v79
    s_cmp_lt_u32 s46, 4096
    s_cbranch_scc1 L_a_fb0
    v_mov_b32 v171, v168
    s_nop 1
    v_permlane32_swap_b32 v168, v171
    s_nop 1
    v_max_f32 v168, v168, v171
    v_mov_b32 v171, v169
    s_nop 1
    v_permlane32_swap_b32 v169, v171
    s_nop 1
    v_max_f32 v169, v169, v171
    v_mov_b32 v184, 0
    v_mov_b32 v185, 0
    v_mov_b32 v186, 0
    v_mov_b32 v187, 0
    v_mov_b32 v188, 0
    v_mov_b32 v189, 0
    v_mov_b32 v190, 0
    v_mov_b32 v191, 0
    v_mov_b32 v192, 0
    v_mov_b32 v193, 0
    v_mov_b32 v194, 0
    v_mov_b32 v195, 0
    v_mov_b32 v196, 0
    v_mov_b32 v197, 0
    v_mov_b32 v198, 0
    v_mov_b32 v199, 0
    v_mov_b32 v200, 0
    v_mov_b32 v201, 0
    v_mov_b32 v202, 0
    v_mov_b32 v203, 0
    v_mov_b32 v204, 0
    v_mov_b32 v205, 0
    v_mov_b32 v206, 0
    v_mov_b32 v207, 0
    v_mov_b32 v208, 0
    v_mov_b32 v209, 0
    v_mov_b32 v210, 0
    v_mov_b32 v211, 0
    v_mov_b32 v212, 0
    v_mov_b32 v213, 0
    v_mov_b32 v214, 0
    v_mov_b32 v215, 0
    s_mov_b32 s46, 0
L_a_fb1:
    s_add_u32 m0, s48, 0
    s_add_u32 s47, s53, s46
    buffer_load_dwordx4 v182, s[4:7], s47 offen sc1 lds
    s_add_u32 m0, s48, 1024
    s_add_u32 s47, s47, 0x10000
    s_mov_b64 exec, 0xff
    buffer_load_dwordx4 v182, s[4:7], s47 offen sc1 lds
    s_mov_b64 exec, -1
    s_add_u32 m0, s48, 1152
    s_add_u32 s47, s54, s46
    buffer_load_dwordx4 v182, s[4:7], s47 offen sc1 lds
    s_add_u32 m0, s48, 2176
    s_add_u32 s47, s47, 0x10000
    s_mov_b64 exec, 0xff
    buffer_load_dwordx4 v182, s[4:7], s47 offen sc1 lds
    s_mov_b64 exec, -1
    s_waitcnt vmcnt(0)
    ds_read_b64_tr_b16 v[28:29], v179 offset:1024
    ds_read_b64_tr_b16 v[20:21], v178
    ds_read_b64_tr_b16 v[22:23], v178 offset:256
    ds_read_b128 v[32:35], v174 offset:0
    ds_read_b128 v[40:43], v174 offset:32
    s_waitcnt lgkmcnt(0)
    v_mfma_f32_32x32x4_2b_bf16 v[48:79], v[28:29], v[16:17], 0 cbsz:1 abid:0
    s_nop 15
    s_nop 1
    v_mfma_f32_32x32x16_bf16 v[48:63], v[20:23], v[8:11], v[48:63]
    v_mfma_f32_32x32x16_bf16 v[64:79], v[20:23], v[12:15], v[64:79]
    s_nop 15
    s_add_u32 s46, s46, 64
    v_sub_f32 v48, v48, v168
    v_sub_f32 v49, v49, v168
    v_sub_f32 v50, v50, v168
    v_sub_f32 v51, v51, v168
    v_sub_f32 v52, v52, v168
    v_sub_f32 v53, v53, v168
    v_sub_f32 v54, v54, v168
    v_sub_f32 v55, v55, v168
    v_sub_f32 v56, v56, v168
    v_sub_f32 v57, v57, v168
    v_sub_f32 v58, v58, v168
    v_sub_f32 v59, v59, v168
    v_sub_f32 v60, v60, v168
    v_sub_f32 v61, v61, v168
    v_sub_f32 v62, v62, v168
    v_sub_f32 v63, v63, v168
    v_sub_f32 v64, v64, v169
    v_sub_f32 v65, v65, v169
    v_sub_f32 v66, v66, v169
    v_sub_f32 v67, v67, v169
    v_sub_f32 v68, v68, v169
    v_sub_f32 v69, v69, v169
    v_sub_f32 v70, v70, v169
    v_sub_f32 v71, v71, v169
    v_sub_f32 v72, v72, v169
    v_sub_f32 v73, v73, v169
    v_sub_f32 v74, v74, v169
    v_sub_f32 v75, v75, v169
    v_sub_f32 v76, v76, v169
    v_sub_f32 v77, v77, v169
    v_sub_f32 v78, v78, v169
    v_sub_f32 v79, v79, v169
    v_exp_f32 v48, v48
    v_exp_f32 v49, v49
    v_exp_f32 v50, v50
    v_exp_f32_e64 v51, v51
    v_exp_f32 v52, v52
    v_exp_f32 v53, v53
    v_exp_f32 v54, v54
    v_exp_f32 v55, v55
    v_exp_f32 v64, v64
    v_exp_f32 v65, v65
    v_exp_f32 v66, v66
    v_exp_f32 v67, v67
    v_exp_f32 v68, v68
    v_exp_f32 v69, v69
    v_exp_f32 v70, v70
    v_exp_f32 v71, v71
    v_exp_f32 v56, v56
    v_exp_f32 v57, v57
    v_exp_f32 v58, v58
    v_exp_f32 v59, v59
    v_exp_f32 v60, v60
    v_exp_f32 v61, v61
    v_exp_f32 v62, v62
    v_exp_f32 v63, v63
    v_exp_f32 v72, v72
    v_exp_f32 v73, v73
    v_exp_f32 v74, v74
    v_exp_f32 v75, v75
    v_exp_f32 v76, v76
    v_exp_f32 v77, v77
    v_exp_f32 v78, v78
    v_exp_f32 v79, v79
    s_nop 1
    v_smfmac_f32_32x32x32_bf16 v[184:199], v[32:35], v[48:55], v175
    v_smfmac_f32_32x32x32_bf16 v[184:199], v[40:43], v[56:63], v175
    v_smfmac_f32_32x32x32_bf16 v[200:215], v[32:35], v[64:71], v175
    v_smfmac_f32_32x32x32_bf16 v[200:215], v[40:43], v[72:79], v175
    s_cmp_lt_u32 s46, 4096
    s_cbranch_scc1 L_a_fb1
    s_nop 15
    v_mov_b32 v172, v194
    v_mov_b32 v171, v194
    s_nop 1
    v_permlane32_swap_b32 v172, v171
    v_mov_b32 v173, v210
    v_mov_b32 v171, v210
    s_nop 1
    v_permlane32_swap_b32 v173, v171
    s_nop 1
    s_branch L_a_store
L_ll5:
    s_sleep 1
    s_add_u32 s42, s42, 1
    s_cmp_ge_u32 s42, 0xf42400
    s_cbranch_scc1 L_ll5_x
    ds_read_b32 v169, v170 offset:32
    s_waitcnt lgkmcnt(0)
    v_cmp_gt_u32 vcc, 4, v169
    s_cbranch_vccnz L_ll5
    s_branch L_ll5_x
L_ll6:
    s_sleep 1
    s_add_u32 s42, s42, 1
    s_cmp_ge_u32 s42, 0xf42400
    s_cbranch_scc1 L_ll6_x
    ds_read_b32 v169, v170 offset:36
    s_waitcnt lgkmcnt(0)
    v_cmp_gt_u32 vcc, 4, v169
    s_cbranch_vccnz L_ll6
    s_branch L_ll6_x
L_lw7:
    s_sleep 4
    s_add_u32 s42, s42, 1
    s_cmp_lt_u32 s42, 0xf42400
    s_cbranch_scc1 L_lw7_t
    s_branch L_lw7_x
L_lw8:
    s_sleep 8
    s_add_u32 s42, s42, 1
    s_cmp_lt_u32 s42, 0xf42400
    s_cbranch_scc1 L_lw8_t
    s_branch L_lw8_x
L_a_setup:
    s_setprio 0
    s_call_b64 s[62:63], L_sub_asetup
    s_mov_b32 s59, 4
    s_branch L_a_wait
L_free:
    s_add_u32 s44, s2, 32
    s_cmp_lt_u32 s3, 4
    s_cselect_b32 s100, s44, s100
    s_cbranch_scc0 L_f_h0
    s_mov_b32 s8, s22
    s_mov_b32 s9, s23
    s_mov_b32 s10, 0x240000
    s_mov_b32 s11, 0x00020000
    s_andn2_b32 s53, s2, 3
    s_add_u32 s53, s53, s3
    s_and_b32 s54, s2, 3
    s_mul_i32 s55, s53, 9216
    s_mul_i32 s56, s54, 288
    s_add_u32 s55, s55, s56
    s_mul_i32 s57, s3, 3072
    v_add_u32 v8, 0, v0
    v_mul_u32_u24 v9, 3641, v8
    v_lshrrev_b32 v9, 16, v9
    v_mul_u32_u24 v10, 864, v9
    v_lshl_add_u32 v10, v8, 4, v10
    s_add_u32 m0, s57, 131072
    s_nop 0
    buffer_load_dwordx4 v10, s[8:11], s55 offen lds
    v_add_u32 v8, 64, v0
    v_mul_u32_u24 v9, 3641, v8
    v_lshrrev_b32 v9, 16, v9
    v_mul_u32_u24 v10, 864, v9
    v_lshl_add_u32 v10, v8, 4, v10
    s_add_u32 m0, s57, 132096
    s_nop 0
    buffer_load_dwordx4 v10, s[8:11], s55 offen lds
    v_add_u32 v8, 128, v0
    v_mul_u32_u24 v9, 3641, v8
    v_lshrrev_b32 v9, 16, v9
    v_mul_u32_u24 v10, 864, v9
    v_lshl_add_u32 v10, v8, 4, v10
    s_add_u32 m0, s57, 133120
    s_mov_b64 exec, 0xffff
    buffer_load_dwordx4 v10, s[8:11], s55 offen lds
    s_mov_b64 exec, -1
L_f_h0:
    s_lshl_b32 s44, s100, 1
    s_bfe_u32 s45, s3, 0x10001
    s_add_u32 s44, s44, s45
    s_lshl_b32 s45, s44, 8
    v_lshlrev_b32 v8, 2, v0
    v_add_u32 v8, s45, v8
    s_lshl_b32 s45, s44, 1
    v_mov_b32 v9, s45
    global_load_ushort v1, v9, s[32:33]
    global_load_dword v2, v8, s[24:25]
    global_load_dword v3, v8, s[26:27]
    global_load_dword v4, v8, s[28:29]
    global_load_dword v5, v8, s[30:31]
    global_load_ushort v6, v9, s[34:35]
    s_bfe_u32 s54, s3, 0x10001
    s_and_b32 s55, s3, 1
    s_mul_i32 s56, s54, 16640
    s_lshl_b32 s57, s55, 8
    v_bfe_u32 v9, v0, 2, 2
    v_mul_u32_u24 v208, 4160, v9
    v_and_b32 v10, 3, v0
    v_lshl_add_u32 v208, v10, 3, v208
    v_and_b32 v10, 48, v0
    v_sub_u32 v208, v208, v10
    s_add_u32 s56, s56, s57
    s_add_u32 s56, s56, 76888
    v_add_u32 v208, s56, v208
    v_and_b32 v11, 15, v0
    v_lshl_add_u32 v209, v11, 5, v10
    s_mul_i32 s56, s54, 4608
    s_sub_u32 s56, s56, s57
    s_add_u32 s56, s56, 143648
    v_add_u32 v209, s56, v209
    s_and_b32 s56, s3, 3
    s_lshl_b32 s56, s56, 13
    s_add_u32 s56, s56, 110080
    v_add_u32 v210, s56, v7
    v_bfe_u32 v9, v0, 1, 4
    v_lshlrev_b32 v211, 4, v9
    v_and_b32 v9, 1, v0
    v_lshl_add_u32 v211, v9, 9, v211
    v_lshrrev_b32 v9, 5, v0
    v_lshl_add_u32 v211, v9, 10, v211
    s_lshl_b32 s56, s54, 14
    s_lshl_b32 s57, s55, 12
    s_add_u32 s56, s56, s57
    s_add_u32 s56, s56, 110080
    v_add_u32 v211, s56, v211
    v_mov_b32 v18, 0
    v_mov_b32 v19, 0
    v_lshlrev_b32 v9, 3, v0
    v_add_u32 v9, 143360, v9
    ds_write_b64 v9, v[18:19] offset:0
    ds_write_b64 v9, v[18:19] offset:4608
    v_bfe_u32 v16, v0, 2, 2
    v_mul_u32_u24 v16, 288, v16
    v_and_b32 v17, 3, v0
    v_lshl_add_u32 v16, v17, 3, v16
    v_and_b32 v17, 48, v0
    v_lshl_add_u32 v16, v17, 1, v16
    s_and_b32 s54, s3, 3
    s_mul_i32 s55, s54, 3072
    s_add_u32 s55, s55, 131072
    v_add_u32 v16, s55, v16
    s_andn2_b32 s61, s2, 3
    s_add_u32 s61, s61, s54
    s_mul_i32 s61, s61, 9216
    s_and_b32 s54, s2, 3
    s_mul_i32 s54, s54, 2304
    s_add_u32 s61, s61, s54
    s_add_u32 s61, s61, 0xd00000
    s_waitcnt lgkmcnt(0)
    s_mul_i32 s38, s38, 0x2c9277b5
    s_add_u32 s38, s38, 0xac564b05
    s_waitcnt vmcnt(0)
    s_barrier
    s_cmp_lt_u32 s3, 4
    s_cbranch_scc1 L_f_2
    s_setprio 3
    ds_read_b64_tr_b16 v[128:129], v16 offset:0
    ds_read_b64_tr_b16 v[130:131], v16 offset:1152
    ds_read_b64_tr_b16 v[132:133], v16 offset:128
    ds_read_b64_tr_b16 v[134:135], v16 offset:1280
    ds_read_b64_tr_b16 v[136:137], v16 offset:256
    ds_read_b64_tr_b16 v[138:139], v16 offset:1408
    s_waitcnt lgkmcnt(4)
    buffer_store_dwordx4 v[128:131], v7, s[4:7], s61 offen offset:0 sc1
    s_waitcnt lgkmcnt(2)
    buffer_store_dwordx4 v[132:135], v7, s[4:7], s61 offen offset:1024 sc1
    s_waitcnt lgkmcnt(0)
    s_mov_b64 exec, 0xffff
    buffer_store_dwordx4 v[136:139], v7, s[4:7], s61 offen offset:2048 sc1
    s_mov_b64 exec, -1
    s_branch L_f_3
L_f_2:
    s_sub_u32 s44, s2, 224
    s_lshl_b32 s44, s44, 2
    s_add_u32 s44, s44, s3
    s_cmp_ge_u32 s44, 108
    s_cbranch_scc1 L_wp_x
    s_mov_b32 s12, s20
    s_mov_b32 s13, s21
    s_mov_b32 s14, 0xa2000
    s_mov_b32 s15, 0x00020000
    s_mul_i32 s45, s44, 3641
    s_lshr_b32 s45, s45, 16
    s_mul_i32 s46, s45, 18
    s_sub_u32 s46, s44, s46
    s_cmp_ge_u32 s46, 16
    s_cselect_b64 s[48:49], -1, 0
    s_cselect_b32 s58, 36, 4
    s_cselect_b32 s47, 288, 36
    s_and_b32 s46, s46, 15
    s_mul_i32 s46, s46, s47
    s_mul_i32 s46, s46, 1152
    s_mul_i32 s45, s45, 192
    s_add_u32 s46, s46, s45
    s_mul_i32 s58, s58, 1152
    v_add_u32 v8, 0, v0
    v_mul_u32_u24 v9, 5462, v8
    v_lshrrev_b32 v9, 16, v9
    v_mul_u32_u24 v10, 12, v9
    v_sub_u32 v8, v8, v10
    v_and_b32 v10, 3, v9
    v_lshrrev_b32 v9, 2, v9
    v_lshrrev_b32 v11, 1, v9
    v_mul_u32_u24 v13, 18, v11
    v_and_b32 v11, 1, v9
    v_lshl_add_u32 v13, v11, 3, v13
    v_add_u32 v13, v13, v10
    v_lshrrev_b32 v11, 1, v10
    v_lshl_add_u32 v11, v9, 2, v11
    v_mul_u32_u24 v11, 18, v11
    v_and_b32 v10, 1, v10
    v_add3_u32 v11, v11, v10, 16
    v_cndmask_b32 v13, v13, v11, s[48:49]
    v_mul_u32_u24 v13, 1152, v13
    v_lshl_add_u32 v13, v8, 4, v13
    v_add_u32 v8, 64, v0
    v_mul_u32_u24 v9, 5462, v8
    v_lshrrev_b32 v9, 16, v9
    v_mul_u32_u24 v10, 12, v9
    v_sub_u32 v8, v8, v10
    v_and_b32 v10, 3, v9
    v_lshrrev_b32 v9, 2, v9
    v_lshrrev_b32 v11, 1, v9
    v_mul_u32_u24 v14, 18, v11
    v_and_b32 v11, 1, v9
    v_lshl_add_u32 v14, v11, 3, v14
    v_add_u32 v14, v14, v10
    v_lshrrev_b32 v11, 1, v10
    v_lshl_add_u32 v11, v9, 2, v11
    v_mul_u32_u24 v11, 18, v11
    v_and_b32 v10, 1, v10
    v_add3_u32 v11, v11, v10, 16
    v_cndmask_b32 v14, v14, v11, s[48:49]
    v_mul_u32_u24 v14, 1152, v14
    v_lshl_add_u32 v14, v8, 4, v14
    v_add_u32 v8, 128, v0
    v_mul_u32_u24 v9, 5462, v8
    v_lshrrev_b32 v9, 16, v9
    v_mul_u32_u24 v10, 12, v9
    v_sub_u32 v8, v8, v10
    v_and_b32 v10, 3, v9
    v_lshrrev_b32 v9, 2, v9
    v_lshrrev_b32 v11, 1, v9
    v_mul_u32_u24 v15, 18, v11
    v_and_b32 v11, 1, v9
    v_lshl_add_u32 v15, v11, 3, v15
    v_add_u32 v15, v15, v10
    v_lshrrev_b32 v11, 1, v10
    v_lshl_add_u32 v11, v9, 2, v11
    v_mul_u32_u24 v11, 18, v11
    v_and_b32 v10, 1, v10
    v_add3_u32 v11, v11, v10, 16
    v_cndmask_b32 v15, v15, v11, s[48:49]
    v_mul_u32_u24 v15, 1152, v15
    v_lshl_add_u32 v15, v8, 4, v15
    s_mul_i32 s47, s3, 6144
    s_add_u32 s47, s47, 110080
    s_cmp_eq_u32 s3, 3
    s_cselect_b32 s47, 153600, s47
    s_add_u32 m0, s47, 0
    s_nop 0
    buffer_load_dwordx4 v13, s[12:15], s46 offen lds
    s_add_u32 m0, s47, 1024
    s_nop 0
    buffer_load_dwordx4 v14, s[12:15], s46 offen lds
    s_add_u32 m0, s47, 2048
    s_nop 0
    buffer_load_dwordx4 v15, s[12:15], s46 offen lds
    s_add_u32 m0, s47, 3072
    s_add_u32 s46, s46, s58
    buffer_load_dwordx4 v13, s[12:15], s46 offen lds
    s_add_u32 m0, s47, 4096
    s_nop 0
    buffer_load_dwordx4 v14, s[12:15], s46 offen lds
    s_add_u32 m0, s47, 5120
    s_nop 0
    buffer_load_dwordx4 v15, s[12:15], s46 offen lds
    v_lshrrev_b32 v10, 2, v0
    v_mul_u32_u24 v12, 192, v10
    v_and_b32 v10, 3, v0
    v_lshl_add_u32 v12, v10, 3, v12
    v_add_u32 v12, s47, v12
    s_mul_i32 s44, s44, 6144
    s_add_u32 s44, s44, 0xa00000
    s_add_u32 s45, s44, 3072
    s_waitcnt vmcnt(0)
    ds_read_b64_tr_b16 v[16:17], v12 offset:0
    ds_read_b64_tr_b16 v[18:19], v12 offset:3072
    ds_read_b64_tr_b16 v[20:21], v12 offset:32
    ds_read_b64_tr_b16 v[22:23], v12 offset:3104
    ds_read_b64_tr_b16 v[24:25], v12 offset:64
    ds_read_b64_tr_b16 v[26:27], v12 offset:3136
    ds_read_b64_tr_b16 v[28:29], v12 offset:96
    ds_read_b64_tr_b16 v[30:31], v12 offset:3168
    ds_read_b64_tr_b16 v[32:33], v12 offset:128
    ds_read_b64_tr_b16 v[34:35], v12 offset:3200
    ds_read_b64_tr_b16 v[36:37], v12 offset:160
    ds_read_b64_tr_b16 v[38:39], v12 offset:3232
    s_waitcnt lgkmcnt(10)
    buffer_store_dwordx4 v[16:19], v7, s[4:7], s44 offen offset:0 sc1
    s_waitcnt lgkmcnt(8)
    buffer_store_dwordx4 v[20:23], v7, s[4:7], s44 offen offset:1024 sc1
    s_waitcnt lgkmcnt(6)
    buffer_store_dwordx4 v[24:27], v7, s[4:7], s44 offen offset:2048 sc1
    s_waitcnt lgkmcnt(4)
    buffer_store_dwordx4 v[28:31], v7, s[4:7], s45 offen offset:0 sc1
    s_waitcnt lgkmcnt(2)
    buffer_store_dwordx4 v[32:35], v7, s[4:7], s45 offen offset:1024 sc1
    s_waitcnt lgkmcnt(0)
    buffer_store_dwordx4 v[36:39], v7, s[4:7], s45 offen offset:2048 sc1
L_wp_x:
    s_mov_b64 exec, 1
    v_mov_b32 v8, 153536
    v_mov_b32 v9, 1
    ds_add_u32 v8, v9 offset:8
    s_mov_b64 exec, -1
L_f_3:
    s_mov_b32 s53, 0x3fb8aa3b
    s_mov_b32 s54, 0x32a57060
    s_mov_b32 s55, 0x3f317218
    s_andn2_b32 s56, 1, s3
    s_lshl_b32 s56, s56, 4
    v_lshlrev_b32 v23, 16, v1
    v_mul_f32 v20, s53, v23
    v_exp_f32 v1, v20
    v_fma_f32 v21, v23, s53, -v20
    v_fma_f32 v21, v23, s54, v21
    v_mul_f32 v21, s55, v21
    v_fma_f32 v1, v1, v21, v1
    v_cvt_pk_bf16_f32 v1, 0, v1
    v_lshlrev_b32 v23, s56, v2
    v_and_b32 v23, 0xffff0000, v23
    v_mul_f32 v20, s53, v23
    v_exp_f32 v24, v20
    v_fma_f32 v21, v23, s53, -v20
    v_fma_f32 v21, v23, s54, v21
    v_mul_f32 v21, s55, v21
    v_fma_f32 v24, v24, v21, v24
    v_cvt_pk_bf16_f32 v24, 0, v24
    v_lshlrev_b32 v25, s56, v3
    v_and_b32 v25, 0xffff0000, v25
    v_mul_f32 v24, v24, v1
    v_mul_f32 v25, v25, v1
    v_mul_f32 v24, 0xbfb8aa3b, v24
    v_mul_f32 v25, 0.15915494, v25
    v_mul_f32 v20, 0x3f800000, v25
    v_mul_f32 v21, 0x3f800000, v24
    v_fract_f32 v20, v20
    v_exp_f32 v21, v21
    v_cos_f32 v26, v20
    v_sin_f32 v27, v20
    v_mul_f32 v26, v26, v21
    v_mul_f32 v27, v27, v21
    v_mul_f32 v20, 0x41000000, v25
    v_mul_f32 v21, 0x41000000, v24
    v_fract_f32 v20, v20
    v_exp_f32 v21, v21
    v_cos_f32 v28, v20
    v_sin_f32 v29, v20
    v_mul_f32 v28, v28, v21
    v_mul_f32 v29, v29, v21
    v_mul_f32 v20, 0x42800000, v25
    v_mul_f32 v21, 0x42800000, v24
    v_fract_f32 v20, v20
    v_exp_f32 v21, v21
    v_cos_f32 v30, v20
    v_sin_f32 v31, v20
    v_mul_f32 v30, v30, v21
    v_mul_f32 v31, v31, v21
    v_mul_f32 v20, 0x43800000, v25
    v_mul_f32 v21, 0x43800000, v24
    v_fract_f32 v20, v20
    v_exp_f32 v21, v21
    v_cos_f32 v32, v20
    v_sin_f32 v33, v20
    v_mul_f32 v32, v32, v21
    v_mul_f32 v33, v33, v21
    v_mov_b32 v64, 0x3c00
    v_pk_mul_f32 v[42:43], v[30:31], v[30:31] op_sel:[0,0] op_sel_hi:[0,1]
    v_pk_fma_f32 v[42:43], v[30:31], v[30:31], v[42:43] op_sel:[1,1,0] op_sel_hi:[1,0,1] neg_lo:[1,0,0]
    v_cvt_pk_f16_f32 v65, v28, v29
    v_pk_mul_f32 v[46:47], v[42:43], v[30:31] op_sel:[0,0] op_sel_hi:[0,1]
    v_pk_fma_f32 v[46:47], v[42:43], v[30:31], v[46:47] op_sel:[1,1,0] op_sel_hi:[1,0,1] neg_lo:[1,0,0]
    v_cvt_pk_f16_f32 v66, v30, v31
    v_cvt_pk_f16_f32 v67, v42, v43
    v_cvt_pk_f16_f32 v68, v46, v47
    v_pk_mul_f32 v[34:35], v[28:29], v[28:29] op_sel:[0,0] op_sel_hi:[0,1]
    v_pk_fma_f32 v[34:35], v[28:29], v[28:29], v[34:35] op_sel:[1,1,0] op_sel_hi:[1,0,1] neg_lo:[1,0,0]
    v_cvt_pk_f16_f32 v69, v34, v35
    v_pk_mul_f32 v[38:39], v[30:31], v[28:29] op_sel:[0,0] op_sel_hi:[0,1]
    v_pk_fma_f32 v[38:39], v[30:31], v[28:29], v[38:39] op_sel:[1,1,0] op_sel_hi:[1,0,1] neg_lo:[1,0,0]
    v_cvt_pk_f16_f32 v70, v38, v39
    v_pk_mul_f32 v[44:45], v[42:43], v[28:29] op_sel:[0,0] op_sel_hi:[0,1]
    v_pk_fma_f32 v[44:45], v[42:43], v[28:29], v[44:45] op_sel:[1,1,0] op_sel_hi:[1,0,1] neg_lo:[1,0,0]
    v_cvt_pk_f16_f32 v71, v44, v45
    v_pk_mul_f32 v[48:49], v[46:47], v[28:29] op_sel:[0,0] op_sel_hi:[0,1]
    v_pk_fma_f32 v[48:49], v[46:47], v[28:29], v[48:49] op_sel:[1,1,0] op_sel_hi:[1,0,1] neg_lo:[1,0,0]
    v_cvt_pk_f16_f32 v72, v48, v49
    v_pk_mul_f32 v[36:37], v[34:35], v[28:29] op_sel:[0,0] op_sel_hi:[0,1]
    v_pk_fma_f32 v[36:37], v[34:35], v[28:29], v[36:37] op_sel:[1,1,0] op_sel_hi:[1,0,1] neg_lo:[1,0,0]
    v_cvt_pk_f16_f32 v73, v36, v37
    v_pk_mul_f32 v[40:41], v[38:39], v[28:29] op_sel:[0,0] op_sel_hi:[0,1]
    v_pk_fma_f32 v[40:41], v[38:39], v[28:29], v[40:41] op_sel:[1,1,0] op_sel_hi:[1,0,1] neg_lo:[1,0,0]
    v_cvt_pk_f16_f32 v74, v40, v41
    v_pk_mul_f32 v[42:43], v[44:45], v[28:29] op_sel:[0,0] op_sel_hi:[0,1]
    v_pk_fma_f32 v[42:43], v[44:45], v[28:29], v[42:43] op_sel:[1,1,0] op_sel_hi:[1,0,1] neg_lo:[1,0,0]
    v_cvt_pk_f16_f32 v75, v42, v43
    v_pk_mul_f32 v[46:47], v[48:49], v[28:29] op_sel:[0,0] op_sel_hi:[0,1]
    v_pk_fma_f32 v[46:47], v[48:49], v[28:29], v[46:47] op_sel:[1,1,0] op_sel_hi:[1,0,1] neg_lo:[1,0,0]
    v_cvt_pk_f16_f32 v76, v46, v47
    v_pk_mul_f32 v[34:35], v[36:37], v[28:29] op_sel:[0,0] op_sel_hi:[0,1]
    v_pk_fma_f32 v[34:35], v[36:37], v[28:29], v[34:35] op_sel:[1,1,0] op_sel_hi:[1,0,1] neg_lo:[1,0,0]
    v_cvt_pk_f16_f32 v77, v34, v35
    v_pk_mul_f32 v[38:39], v[40:41], v[28:29] op_sel:[0,0] op_sel_hi:[0,1]
    v_pk_fma_f32 v[38:39], v[40:41], v[28:29], v[38:39] op_sel:[1,1,0] op_sel_hi:[1,0,1] neg_lo:[1,0,0]
    v_cvt_pk_f16_f32 v78, v38, v39
    v_pk_mul_f32 v[44:45], v[42:43], v[28:29] op_sel:[0,0] op_sel_hi:[0,1]
    v_pk_fma_f32 v[44:45], v[42:43], v[28:29], v[44:45] op_sel:[1,1,0] op_sel_hi:[1,0,1] neg_lo:[1,0,0]
    v_cvt_pk_f16_f32 v79, v44, v45
    v_pk_mul_f32 v[48:49], v[46:47], v[28:29] op_sel:[0,0] op_sel_hi:[0,1]
    v_pk_fma_f32 v[48:49], v[46:47], v[28:29], v[48:49] op_sel:[1,1,0] op_sel_hi:[1,0,1] neg_lo:[1,0,0]
    v_cvt_pk_f16_f32 v80, v48, v49
    v_pk_mul_f32 v[36:37], v[34:35], v[28:29] op_sel:[0,0] op_sel_hi:[0,1]
    v_pk_fma_f32 v[36:37], v[34:35], v[28:29], v[36:37] op_sel:[1,1,0] op_sel_hi:[1,0,1] neg_lo:[1,0,0]
    v_cvt_pk_f16_f32 v81, v36, v37
    v_pk_mul_f32 v[40:41], v[38:39], v[28:29] op_sel:[0,0] op_sel_hi:[0,1]
    v_pk_fma_f32 v[40:41], v[38:39], v[28:29], v[40:41] op_sel:[1,1,0] op_sel_hi:[1,0,1] neg_lo:[1,0,0]
    v_cvt_pk_f16_f32 v82, v40, v41
    v_pk_mul_f32 v[42:43], v[44:45], v[28:29] op_sel:[0,0] op_sel_hi:[0,1]
    v_pk_fma_f32 v[42:43], v[44:45], v[28:29], v[42:43] op_sel:[1,1,0] op_sel_hi:[1,0,1] neg_lo:[1,0,0]
    v_cvt_pk_f16_f32 v83, v42, v43
    v_pk_mul_f32 v[46:47], v[48:49], v[28:29] op_sel:[0,0] op_sel_hi:[0,1]
    v_pk_fma_f32 v[46:47], v[48:49], v[28:29], v[46:47] op_sel:[1,1,0] op_sel_hi:[1,0,1] neg_lo:[1,0,0]
    v_cvt_pk_f16_f32 v84, v46, v47
    v_pk_mul_f32 v[34:35], v[36:37], v[28:29] op_sel:[0,0] op_sel_hi:[0,1]
    v_pk_fma_f32 v[34:35], v[36:37], v[28:29], v[34:35] op_sel:[1,1,0] op_sel_hi:[1,0,1] neg_lo:[1,0,0]
    v_cvt_pk_f16_f32 v85, v34, v35
    v_pk_mul_f32 v[38:39], v[40:41], v[28:29] op_sel:[0,0] op_sel_hi:[0,1]
    v_pk_fma_f32 v[38:39], v[40:41], v[28:29], v[38:39] op_sel:[1,1,0] op_sel_hi:[1,0,1] neg_lo:[1,0,0]
    v_cvt_pk_f16_f32 v86, v38, v39
    v_pk_mul_f32 v[44:45], v[42:43], v[28:29] op_sel:[0,0] op_sel_hi:[0,1]
    v_pk_fma_f32 v[44:45], v[42:43], v[28:29], v[44:45] op_sel:[1,1,0] op_sel_hi:[1,0,1] neg_lo:[1,0,0]
    v_cvt_pk_f16_f32 v87, v44, v45
    v_pk_mul_f32 v[48:49], v[46:47], v[28:29] op_sel:[0,0] op_sel_hi:[0,1]
    v_pk_fma_f32 v[48:49], v[46:47], v[28:29], v[48:49] op_sel:[1,1,0] op_sel_hi:[1,0,1] neg_lo:[1,0,0]
    v_cvt_pk_f16_f32 v88, v48, v49
    v_pk_mul_f32 v[36:37], v[34:35], v[28:29] op_sel:[0,0] op_sel_hi:[0,1]
    v_pk_fma_f32 v[36:37], v[34:35], v[28:29], v[36:37] op_sel:[1,1,0] op_sel_hi:[1,0,1] neg_lo:[1,0,0]
    v_cvt_pk_f16_f32 v89, v36, v37
    v_pk_mul_f32 v[40:41], v[38:39], v[28:29] op_sel:[0,0] op_sel_hi:[0,1]
    v_pk_fma_f32 v[40:41], v[38:39], v[28:29], v[40:41] op_sel:[1,1,0] op_sel_hi:[1,0,1] neg_lo:[1,0,0]
    v_cvt_pk_f16_f32 v90, v40, v41
    v_pk_mul_f32 v[42:43], v[44:45], v[28:29] op_sel:[0,0] op_sel_hi:[0,1]
    v_pk_fma_f32 v[42:43], v[44:45], v[28:29], v[42:43] op_sel:[1,1,0] op_sel_hi:[1,0,1] neg_lo:[1,0,0]
    v_cvt_pk_f16_f32 v91, v42, v43
    v_pk_mul_f32 v[46:47], v[48:49], v[28:29] op_sel:[0,0] op_sel_hi:[0,1]
    v_pk_fma_f32 v[46:47], v[48:49], v[28:29], v[46:47] op_sel:[1,1,0] op_sel_hi:[1,0,1] neg_lo:[1,0,0]
    v_cvt_pk_f16_f32 v92, v46, v47
    v_pk_mul_f32 v[38:39], v[40:41], v[28:29] op_sel:[0,0] op_sel_hi:[0,1]
    v_pk_fma_f32 v[38:39], v[40:41], v[28:29], v[38:39] op_sel:[1,1,0] op_sel_hi:[1,0,1] neg_lo:[1,0,0]
    v_cvt_pk_f16_f32 v93, v38, v39
    v_pk_mul_f32 v[44:45], v[42:43], v[28:29] op_sel:[0,0] op_sel_hi:[0,1]
    v_pk_fma_f32 v[44:45], v[42:43], v[28:29], v[44:45] op_sel:[1,1,0] op_sel_hi:[1,0,1] neg_lo:[1,0,0]
    v_cvt_pk_f16_f32 v94, v44, v45
    v_pk_mul_f32 v[48:49], v[46:47], v[28:29] op_sel:[0,0] op_sel_hi:[0,1]
    v_pk_fma_f32 v[48:49], v[46:47], v[28:29], v[48:49] op_sel:[1,1,0] op_sel_hi:[1,0,1] neg_lo:[1,0,0]
    v_cvt_pk_f16_f32 v95, v48, v49
    v_and_b32 v20, 0x7fff7fff, v4
    v_and_b32 v21, 0x7fff7fff, v5
    v_pk_max_u16 v20, v20, v21
    v_lshlrev_b32 v21, 16, v20
    v_max_u32 v20, v20, v21
    s_nop 1
    v_max_u32_dpp v20, v20, v20 row_shr:1 row_mask:0xf bank_mask:0xf
    s_nop 1
    v_max_u32_dpp v20, v20, v20 row_shr:2 row_mask:0xf bank_mask:0xf
    s_nop 1
    v_max_u32_dpp v20, v20, v20 row_shr:4 row_mask:0xf bank_mask:0xf
    s_nop 1
    v_max_u32_dpp v20, v20, v20 row_shr:8 row_mask:0xf bank_mask:0xf
    s_nop 1
    v_max_u32_dpp v20, v20, v20 row_bcast:15 row_mask:0xa bank_mask:0xf
    s_nop 1
    v_max_u32_dpp v20, v20, v20 row_bcast:31 row_mask:0xc bank_mask:0xf
    v_lshlrev_b32 v34, s56, v4
    v_and_b32 v34, 0xffff0000, v34
    v_readlane_b32 s57, v20, 63
    v_lshlrev_b32 v35, s56, v5
    v_and_b32 v35, 0xffff0000, v35
    s_lshr_b32 s57, s57, 23
    s_max_u32 s57, s57, 1
    s_min_u32 s57, s57, 252
    s_sub_u32 s58, 254, s57
    s_lshl_b32 s58, s58, 23
    s_add_u32 s57, s57, 1
    s_lshl_b32 s57, s57, 23
    v_mul_f32 v34, s58, v34
    v_mul_f32 v35, s58, v35
    v_mul_f32 v1, s57, v1
    v_pk_mul_f32 v[36:37], v[34:35], v[26:27] op_sel:[0,0] op_sel_hi:[0,1]
    v_pk_fma_f32 v[36:37], v[34:35], v[26:27], v[36:37] op_sel:[1,1,0] op_sel_hi:[1,0,1] neg_lo:[1,0,0]
    v_cvt_pk_f16_f32 v96, v34, -v35
    v_pk_mul_f32 v[38:39], v[36:37], v[26:27] op_sel:[0,0] op_sel_hi:[0,1]
    v_pk_fma_f32 v[38:39], v[36:37], v[26:27], v[38:39] op_sel:[1,1,0] op_sel_hi:[1,0,1] neg_lo:[1,0,0]
    v_cvt_pk_f16_f32 v97, v36, -v37
    v_pk_mul_f32 v[40:41], v[38:39], v[26:27] op_sel:[0,0] op_sel_hi:[0,1]
    v_pk_fma_f32 v[40:41], v[38:39], v[26:27], v[40:41] op_sel:[1,1,0] op_sel_hi:[1,0,1] neg_lo:[1,0,0]
    v_cvt_pk_f16_f32 v98, v38, -v39
    v_pk_mul_f32 v[42:43], v[40:41], v[26:27] op_sel:[0,0] op_sel_hi:[0,1]
    v_pk_fma_f32 v[42:43], v[40:41], v[26:27], v[42:43] op_sel:[1,1,0] op_sel_hi:[1,0,1] neg_lo:[1,0,0]
    v_cvt_pk_f16_f32 v99, v40, -v41
    v_pk_mul_f32 v[44:45], v[42:43], v[26:27] op_sel:[0,0] op_sel_hi:[0,1]
    v_pk_fma_f32 v[44:45], v[42:43], v[26:27], v[44:45] op_sel:[1,1,0] op_sel_hi:[1,0,1] neg_lo:[1,0,0]
    v_cvt_pk_f16_f32 v100, v42, -v43
    v_pk_mul_f32 v[46:47], v[44:45], v[26:27] op_sel:[0,0] op_sel_hi:[0,1]
    v_pk_fma_f32 v[46:47], v[44:45], v[26:27], v[46:47] op_sel:[1,1,0] op_sel_hi:[1,0,1] neg_lo:[1,0,0]
    v_cvt_pk_f16_f32 v101, v44, -v45
    v_pk_mul_f32 v[48:49], v[46:47], v[26:27] op_sel:[0,0] op_sel_hi:[0,1]
    v_pk_fma_f32 v[48:49], v[46:47], v[26:27], v[48:49] op_sel:[1,1,0] op_sel_hi:[1,0,1] neg_lo:[1,0,0]
    v_cvt_pk_f16_f32 v102, v46, -v47
    v_pk_mul_f32 v[50:51], v[48:49], v[26:27] op_sel:[0,0] op_sel_hi:[0,1]
    v_pk_fma_f32 v[50:51], v[48:49], v[26:27], v[50:51] op_sel:[1,1,0] op_sel_hi:[1,0,1] neg_lo:[1,0,0]
    v_cvt_pk_f16_f32 v103, v48, -v49
    v_pk_mul_f32 v[52:53], v[34:35], v[32:33] op_sel:[0,0] op_sel_hi:[0,1]
    v_pk_fma_f32 v[52:53], v[34:35], v[32:33], v[52:53] op_sel:[1,1,0] op_sel_hi:[1,0,1] neg_lo:[1,0,0]
    v_pk_mul_f32 v[54:55], v[38:39], v[32:33] op_sel:[0,0] op_sel_hi:[0,1]
    v_pk_fma_f32 v[54:55], v[38:39], v[32:33], v[54:55] op_sel:[1,1,0] op_sel_hi:[1,0,1] neg_lo:[1,0,0]
    v_pk_mul_f32 v[56:57], v[42:43], v[32:33] op_sel:[0,0] op_sel_hi:[0,1]
    v_pk_fma_f32 v[56:57], v[42:43], v[32:33], v[56:57] op_sel:[1,1,0] op_sel_hi:[1,0,1] neg_lo:[1,0,0]
    v_pk_mul_f32 v[58:59], v[46:47], v[32:33] op_sel:[0,0] op_sel_hi:[0,1]
    v_pk_fma_f32 v[58:59], v[46:47], v[32:33], v[58:59] op_sel:[1,1,0] op_sel_hi:[1,0,1] neg_lo:[1,0,0]
    v_pk_mul_f32 v[60:61], v[50:51], v[32:33] op_sel:[0,0] op_sel_hi:[0,1]
    v_pk_fma_f32 v[60:61], v[50:51], v[32:33], v[60:61] op_sel:[1,1,0] op_sel_hi:[1,0,1] neg_lo:[1,0,0]
    v_pk_mul_f32 v[34:35], v[52:53], v[32:33] op_sel:[0,0] op_sel_hi:[0,1]
    v_pk_fma_f32 v[34:35], v[52:53], v[32:33], v[34:35] op_sel:[1,1,0] op_sel_hi:[1,0,1] neg_lo:[1,0,0]
    v_cvt_pk_f16_f32 v104, v52, -v53
    v_pk_mul_f32 v[36:37], v[56:57], v[32:33] op_sel:[0,0] op_sel_hi:[0,1]
    v_pk_fma_f32 v[36:37], v[56:57], v[32:33], v[36:37] op_sel:[1,1,0] op_sel_hi:[1,0,1] neg_lo:[1,0,0]
    v_cvt_pk_f16_f32 v105, v56, -v57
    v_pk_mul_f32 v[38:39], v[60:61], v[32:33] op_sel:[0,0] op_sel_hi:[0,1]
    v_pk_fma_f32 v[38:39], v[60:61], v[32:33], v[38:39] op_sel:[1,1,0] op_sel_hi:[1,0,1] neg_lo:[1,0,0]
    v_cvt_pk_f16_f32 v106, v60, -v61
    v_cvt_pk_f16_f32 v107, v54, -v55
    v_cvt_pk_f16_f32 v108, v58, -v59
    v_pk_mul_f32 v[52:53], v[34:35], v[32:33] op_sel:[0,0] op_sel_hi:[0,1]
    v_pk_fma_f32 v[52:53], v[34:35], v[32:33], v[52:53] op_sel:[1,1,0] op_sel_hi:[1,0,1] neg_lo:[1,0,0]
    v_cvt_pk_f16_f32 v109, v34, -v35
    v_pk_mul_f32 v[54:55], v[36:37], v[32:33] op_sel:[0,0] op_sel_hi:[0,1]
    v_pk_fma_f32 v[54:55], v[36:37], v[32:33], v[54:55] op_sel:[1,1,0] op_sel_hi:[1,0,1] neg_lo:[1,0,0]
    v_cvt_pk_f16_f32 v110, v36, -v37
    v_pk_mul_f32 v[56:57], v[38:39], v[32:33] op_sel:[0,0] op_sel_hi:[0,1]
    v_pk_fma_f32 v[56:57], v[38:39], v[32:33], v[56:57] op_sel:[1,1,0] op_sel_hi:[1,0,1] neg_lo:[1,0,0]
    v_cvt_pk_f16_f32 v111, v38, -v39
    v_pk_mul_f32 v[40:41], v[52:53], v[32:33] op_sel:[0,0] op_sel_hi:[0,1]
    v_pk_fma_f32 v[40:41], v[52:53], v[32:33], v[40:41] op_sel:[1,1,0] op_sel_hi:[1,0,1] neg_lo:[1,0,0]
    v_pk_mul_f32 v[42:43], v[56:57], v[32:33] op_sel:[0,0] op_sel_hi:[0,1]
    v_pk_fma_f32 v[42:43], v[56:57], v[32:33], v[42:43] op_sel:[1,1,0] op_sel_hi:[1,0,1] neg_lo:[1,0,0]
    v_cvt_pk_f16_f32 v112, v52, -v53
    v_cvt_pk_f16_f32 v113, v54, -v55
    v_cvt_pk_f16_f32 v114, v56, -v57
    v_pk_mul_f32 v[44:45], v[40:41], v[32:33] op_sel:[0,0] op_sel_hi:[0,1]
    v_pk_fma_f32 v[44:45], v[40:41], v[32:33], v[44:45] op_sel:[1,1,0] op_sel_hi:[1,0,1] neg_lo:[1,0,0]
    v_pk_mul_f32 v[46:47], v[42:43], v[32:33] op_sel:[0,0] op_sel_hi:[0,1]
    v_pk_fma_f32 v[46:47], v[42:43], v[32:33], v[46:47] op_sel:[1,1,0] op_sel_hi:[1,0,1] neg_lo:[1,0,0]
    v_cvt_pk_f16_f32 v115, v40, -v41
    v_cvt_pk_f16_f32 v116, v42, -v43
    v_pk_mul_f32 v[40:41], v[44:45], v[32:33] op_sel:[0,0] op_sel_hi:[0,1]
    v_pk_fma_f32 v[40:41], v[44:45], v[32:33], v[40:41] op_sel:[1,1,0] op_sel_hi:[1,0,1] neg_lo:[1,0,0]
    v_pk_mul_f32 v[42:43], v[46:47], v[32:33] op_sel:[0,0] op_sel_hi:[0,1]
    v_pk_fma_f32 v[42:43], v[46:47], v[32:33], v[42:43] op_sel:[1,1,0] op_sel_hi:[1,0,1] neg_lo:[1,0,0]
    v_cvt_pk_f16_f32 v117, v44, -v45
    v_cvt_pk_f16_f32 v118, v46, -v47
    v_pk_mul_f32 v[44:45], v[40:41], v[32:33] op_sel:[0,0] op_sel_hi:[0,1]
    v_pk_fma_f32 v[44:45], v[40:41], v[32:33], v[44:45] op_sel:[1,1,0] op_sel_hi:[1,0,1] neg_lo:[1,0,0]
    v_pk_mul_f32 v[46:47], v[42:43], v[32:33] op_sel:[0,0] op_sel_hi:[0,1]
    v_pk_fma_f32 v[46:47], v[42:43], v[32:33], v[46:47] op_sel:[1,1,0] op_sel_hi:[1,0,1] neg_lo:[1,0,0]
    v_cvt_pk_f16_f32 v119, v40, -v41
    v_cvt_pk_f16_f32 v120, v42, -v43
    v_cvt_pk_f16_f32 v121, v44, -v45
    v_cvt_pk_f16_f32 v122, v46, -v47
    s_cmp_lt_u32 s3, 4
    s_cbranch_scc1 L_f_4
    s_waitcnt vmcnt(0)
    s_mov_b64 exec, 1
    v_mov_b32 v8, 153536
    v_mov_b32 v9, 1
    ds_add_u32 v8, v9 offset:56
    s_mov_b64 exec, -1
    v_mov_b32 v8, 153536
L_lw9:
    ds_read_b32 v9, v8 offset:56
    s_add_u32 s42, s42, 1
    s_cmp_lt_u32 s42, 0xf42400
    s_cselect_b64 s[40:41], -1, 0
    s_waitcnt lgkmcnt(0)
    v_cmp_gt_u32 vcc, 4, v9
    s_and_b64 vcc, vcc, s[40:41]
    s_cbranch_vccnz L_lw9
    s_lshl_b32 s60, s2, 7
    s_add_u32 s60, s60, 0x12c8000
    s_cmp_eq_u32 s3, 4
    s_cselect_b32 s60, s60, 0x40000000
    v_mov_b32 v16, s38
    s_mov_b64 exec, 1
    buffer_store_dword v16, off, s[4:7], s60 sc1
    s_mov_b64 exec, -1
    s_mov_b32 s59, 0
    s_branch L_k_dump
L_f_4:
    s_call_b64 s[62:63], L_sub_asetup
    v_mov_b32 v8, 153536
L_lw10:
    ds_read_b32 v9, v8 offset:16
    s_add_u32 s42, s42, 1
    s_cmp_lt_u32 s42, 0xf42400
    s_cselect_b64 s[40:41], -1, 0
    s_waitcnt lgkmcnt(0)
    v_cmp_gt_u32 vcc, 4, v9
    s_and_b64 vcc, vcc, s[40:41]
    s_cbranch_vccnz L_lw10
    s_and_b32 s44, s3, 3
    s_mul_i32 s44, s44, 17408
    s_mov_b32 m0, s44
    s_nop 0
    ds_write_addtid_b32 v64 offset:8704
    ds_write_addtid_b32 v65 offset:8976
    ds_write_addtid_b32 v66 offset:10880
    ds_write_addtid_b32 v67 offset:13056
    ds_write_addtid_b32 v68 offset:15232
    ds_write_addtid_b32 v69 offset:9248
    ds_write_addtid_b32 v70 offset:11152
    ds_write_addtid_b32 v71 offset:13328
    ds_write_addtid_b32 v72 offset:15504
    ds_write_addtid_b32 v73 offset:9520
    ds_write_addtid_b32 v74 offset:11424
    ds_write_addtid_b32 v75 offset:13600
    ds_write_addtid_b32 v76 offset:15776
    ds_write_addtid_b32 v77 offset:9792
    ds_write_addtid_b32 v78 offset:11696
    ds_write_addtid_b32 v79 offset:13872
    ds_write_addtid_b32 v80 offset:16048
    ds_write_addtid_b32 v81 offset:10064
    ds_write_addtid_b32 v82 offset:11968
    ds_write_addtid_b32 v83 offset:14144
    ds_write_addtid_b32 v84 offset:16320
    ds_write_addtid_b32 v85 offset:10336
    ds_write_addtid_b32 v86 offset:12240
    ds_write_addtid_b32 v87 offset:14416
    ds_write_addtid_b32 v88 offset:16592
    ds_write_addtid_b32 v89 offset:10608
    ds_write_addtid_b32 v90 offset:12512
    ds_write_addtid_b32 v91 offset:14688
    ds_write_addtid_b32 v92 offset:16864
    ds_write_addtid_b32 v93 offset:12784
    ds_write_addtid_b32 v94 offset:14960
    ds_write_addtid_b32 v95 offset:17136
    ds_write_addtid_b32 v96 offset:0
    ds_write_addtid_b32 v97 offset:272
    ds_write_addtid_b32 v98 offset:544
    ds_write_addtid_b32 v99 offset:816
    ds_write_addtid_b32 v100 offset:2176
    ds_write_addtid_b32 v101 offset:2448
    ds_write_addtid_b32 v102 offset:2720
    ds_write_addtid_b32 v103 offset:2992
    ds_write_addtid_b32 v104 offset:1088
    ds_write_addtid_b32 v104 offset:1360
    ds_write_addtid_b32 v105 offset:1904
    ds_write_addtid_b32 v105 offset:3264
    ds_write_addtid_b32 v105 offset:3536
    ds_write_addtid_b32 v106 offset:4080
    ds_write_addtid_b32 v107 offset:1632
    ds_write_addtid_b32 v108 offset:3808
    ds_write_addtid_b32 v109 offset:4352
    ds_write_addtid_b32 v110 offset:4624
    ds_write_addtid_b32 v111 offset:4896
    ds_write_addtid_b32 v112 offset:5440
    ds_write_addtid_b32 v113 offset:5712
    ds_write_addtid_b32 v114 offset:5984
    ds_write_addtid_b32 v115 offset:6528
    ds_write_addtid_b32 v116 offset:6800
    ds_write_addtid_b32 v117 offset:7616
    ds_write_addtid_b32 v118 offset:7888
    ds_write_addtid_b32 v119 offset:7072
    ds_write_addtid_b32 v120 offset:7344
    ds_write_addtid_b32 v121 offset:8160
    ds_write_addtid_b32 v122 offset:8432
    v_mov_b32 v8, 153536
L_lw11_t:
    ds_read_b32 v9, v8 offset:4
    s_waitcnt lgkmcnt(0)
    v_cmp_gt_u32 vcc, 4, v9
    s_cbranch_vccnz L_lw11
L_lw11_x:
    v_lshlrev_b32 v9, 9, v0
    s_mul_i32 s44, s100, 911
    s_lshr_b32 s44, s44, 16
    s_lshl_b32 s44, s44, 7
    s_add_u32 s44, s44, 0x12c8000
    s_mov_b32 s60, 0
L_poll12:
    buffer_load_dword v8, v9, s[4:7], s44 offen sc1
    s_add_u32 s60, s60, 1
    s_waitcnt vmcnt(0)
    v_cmp_ne_u32 vcc, s38, v8
    s_cbranch_vccz L_poll12_ok
    s_sleep 4
    s_cmp_lt_u32 s60, 0xf4240
    s_cbranch_scc1 L_poll12
L_poll12_ok:
    v_mul_u32_u24 v8, 9216, v0
    s_mul_i32 s44, s3, 589824
    s_lshl_b32 s45, s100, 5
    s_add_u32 s44, s44, s45
    s_add_u32 s44, s44, 0xd00000
    buffer_load_dwordx4 v[160:163], v8, s[4:7], s44 offen offset:0 sc1
    buffer_load_dwordx4 v[164:167], v8, s[4:7], s44 offen offset:16 sc1
    s_mov_b32 s57, 4
    s_mov_b32 s58, 8
    s_mov_b32 s59, 4
    s_call_b64 s[62:63], L_k_mfma
    s_lshl_b32 s44, s3, 10
    s_add_u32 s44, s44, 143872
    v_add_u32 v8, s44, v7
    s_waitcnt vmcnt(0)
    ds_write_b128 v8, v[160:163] offset:0
    ds_write_b128 v8, v[164:167] offset:4608
    s_waitcnt lgkmcnt(0)
    s_mov_b64 exec, 1
    v_mov_b32 v8, 153536
    v_mov_b32 v9, 1
    ds_add_u32 v8, v9 offset:4
    s_mov_b64 exec, -1
    s_mov_b32 s59, 8
    s_branch L_a_wait
L_lw11:
    s_sleep 4
    s_add_u32 s42, s42, 1
    s_cmp_lt_u32 s42, 0xf42400
    s_cbranch_scc1 L_lw11_t
    s_branch L_lw11_x
L_g_late:
    s_cmp_eq_u32 s39, 8
    s_cbranch_scc1 L_g_l8
    s_cmp_eq_u32 s39, 9
    s_cbranch_scc1 L_g_l9
    s_waitcnt lgkmcnt(0)
    s_mul_i32 s38, s38, 0x2c9277b5
    s_add_u32 s38, s38, 0xac564b05
    s_waitcnt vmcnt(8)
    s_barrier
    s_branch L_g_issue
L_g_l8:
    v_lshlrev_b32 v17, 9, v0
    s_mul_i32 s44, s100, 911
    s_lshr_b32 s44, s44, 16
    s_lshl_b32 s44, s44, 7
    s_add_u32 s44, s44, 0x12c8000
    s_cmp_eq_u32 s3, 5
    s_cselect_b32 s44, s44, 0x40000000
    s_waitcnt vmcnt(8)
    s_barrier
    buffer_load_dword v16, v17, s[4:7], s44 offen sc1
    s_branch L_g_issue
L_g_l9:
    s_waitcnt vmcnt(8)
    s_barrier
    s_cmp_lg_u32 s3, 5
    s_cbranch_scc1 L_g_p6
    v_cmp_ne_u32 vcc, s38, v16
    s_cbranch_vccnz L_g_p6
    s_mov_b64 exec, 1
    v_mov_b32 v16, 153536
    v_mov_b32 v17, 1
    ds_add_u32 v16, v17 offset:12
    s_mov_b64 exec, -1
L_g_p6:
    s_waitcnt vmcnt(0) lgkmcnt(0)
    s_barrier
    v_mov_b32 v16, 153536
    ds_read_b32 v17, v16 offset:12
    s_waitcnt lgkmcnt(0)
    v_readfirstlane_b32 s59, v17
    s_nop 3
    s_cmp_eq_u32 s59, 0
    s_cbranch_scc1 L_g_pk2
    s_branch L_g_pk3
L_g_pk2:
    v_lshlrev_b32 v17, 9, v0
    s_mul_i32 s44, s100, 911
    s_lshr_b32 s44, s44, 16
    s_lshl_b32 s44, s44, 7
    s_add_u32 s44, s44, 0x12c8000
    buffer_load_dword v16, v17, s[4:7], s44 offen sc1
L_g_pk3:
    v_pk_mul_f32 v[46:47], v[48:49], v[28:29] op_sel:[0,0] op_sel_hi:[0,1]
    v_pk_fma_f32 v[46:47], v[48:49], v[28:29], v[46:47] op_sel:[1,1,0] op_sel_hi:[1,0,1] neg_lo:[1,0,0]
    v_cvt_pk_f16_f32 v76, v46, v47
    v_pk_mul_f32 v[34:35], v[36:37], v[28:29] op_sel:[0,0] op_sel_hi:[0,1]
    v_pk_fma_f32 v[34:35], v[36:37], v[28:29], v[34:35] op_sel:[1,1,0] op_sel_hi:[1,0,1] neg_lo:[1,0,0]
    v_cvt_pk_f16_f32 v77, v34, v35
    v_pk_mul_f32 v[38:39], v[40:41], v[28:29] op_sel:[0,0] op_sel_hi:[0,1]
    v_pk_fma_f32 v[38:39], v[40:41], v[28:29], v[38:39] op_sel:[1,1,0] op_sel_hi:[1,0,1] neg_lo:[1,0,0]
    v_cvt_pk_f16_f32 v78, v38, v39
    v_pk_mul_f32 v[44:45], v[42:43], v[28:29] op_sel:[0,0] op_sel_hi:[0,1]
    v_pk_fma_f32 v[44:45], v[42:43], v[28:29], v[44:45] op_sel:[1,1,0] op_sel_hi:[1,0,1] neg_lo:[1,0,0]
    v_cvt_pk_f16_f32 v79, v44, v45
    v_pk_mul_f32 v[48:49], v[46:47], v[28:29] op_sel:[0,0] op_sel_hi:[0,1]
    v_pk_fma_f32 v[48:49], v[46:47], v[28:29], v[48:49] op_sel:[1,1,0] op_sel_hi:[1,0,1] neg_lo:[1,0,0]
    v_cvt_pk_f16_f32 v80, v48, v49
    v_pk_mul_f32 v[36:37], v[34:35], v[28:29] op_sel:[0,0] op_sel_hi:[0,1]
    v_pk_fma_f32 v[36:37], v[34:35], v[28:29], v[36:37] op_sel:[1,1,0] op_sel_hi:[1,0,1] neg_lo:[1,0,0]
    v_cvt_pk_f16_f32 v81, v36, v37
    v_pk_mul_f32 v[40:41], v[38:39], v[28:29] op_sel:[0,0] op_sel_hi:[0,1]
    v_pk_fma_f32 v[40:41], v[38:39], v[28:29], v[40:41] op_sel:[1,1,0] op_sel_hi:[1,0,1] neg_lo:[1,0,0]
    v_cvt_pk_f16_f32 v82, v40, v41
    v_pk_mul_f32 v[42:43], v[44:45], v[28:29] op_sel:[0,0] op_sel_hi:[0,1]
    v_pk_fma_f32 v[42:43], v[44:45], v[28:29], v[42:43] op_sel:[1,1,0] op_sel_hi:[1,0,1] neg_lo:[1,0,0]
    v_cvt_pk_f16_f32 v83, v42, v43
    v_pk_mul_f32 v[46:47], v[48:49], v[28:29] op_sel:[0,0] op_sel_hi:[0,1]
    v_pk_fma_f32 v[46:47], v[48:49], v[28:29], v[46:47] op_sel:[1,1,0] op_sel_hi:[1,0,1] neg_lo:[1,0,0]
    v_cvt_pk_f16_f32 v84, v46, v47
    v_pk_mul_f32 v[34:35], v[36:37], v[28:29] op_sel:[0,0] op_sel_hi:[0,1]
    v_pk_fma_f32 v[34:35], v[36:37], v[28:29], v[34:35] op_sel:[1,1,0] op_sel_hi:[1,0,1] neg_lo:[1,0,0]
    v_cvt_pk_f16_f32 v85, v34, v35
    v_pk_mul_f32 v[38:39], v[40:41], v[28:29] op_sel:[0,0] op_sel_hi:[0,1]
    v_pk_fma_f32 v[38:39], v[40:41], v[28:29], v[38:39] op_sel:[1,1,0] op_sel_hi:[1,0,1] neg_lo:[1,0,0]
    v_cvt_pk_f16_f32 v86, v38, v39
    v_pk_mul_f32 v[44:45], v[42:43], v[28:29] op_sel:[0,0] op_sel_hi:[0,1]
    v_pk_fma_f32 v[44:45], v[42:43], v[28:29], v[44:45] op_sel:[1,1,0] op_sel_hi:[1,0,1] neg_lo:[1,0,0]
    v_cvt_pk_f16_f32 v87, v44, v45
    v_pk_mul_f32 v[48:49], v[46:47], v[28:29] op_sel:[0,0] op_sel_hi:[0,1]
    v_pk_fma_f32 v[48:49], v[46:47], v[28:29], v[48:49] op_sel:[1,1,0] op_sel_hi:[1,0,1] neg_lo:[1,0,0]
    v_cvt_pk_f16_f32 v88, v48, v49
    v_pk_mul_f32 v[36:37], v[34:35], v[28:29] op_sel:[0,0] op_sel_hi:[0,1]
    v_pk_fma_f32 v[36:37], v[34:35], v[28:29], v[36:37] op_sel:[1,1,0] op_sel_hi:[1,0,1] neg_lo:[1,0,0]
    v_cvt_pk_f16_f32 v89, v36, v37
    v_pk_mul_f32 v[40:41], v[38:39], v[28:29] op_sel:[0,0] op_sel_hi:[0,1]
    v_pk_fma_f32 v[40:41], v[38:39], v[28:29], v[40:41] op_sel:[1,1,0] op_sel_hi:[1,0,1] neg_lo:[1,0,0]
    v_cvt_pk_f16_f32 v90, v40, v41
    v_pk_mul_f32 v[42:43], v[44:45], v[28:29] op_sel:[0,0] op_sel_hi:[0,1]
    v_pk_fma_f32 v[42:43], v[44:45], v[28:29], v[42:43] op_sel:[1,1,0] op_sel_hi:[1,0,1] neg_lo:[1,0,0]
    v_cvt_pk_f16_f32 v91, v42, v43
    v_pk_mul_f32 v[46:47], v[48:49], v[28:29] op_sel:[0,0] op_sel_hi:[0,1]
    v_pk_fma_f32 v[46:47], v[48:49], v[28:29], v[46:47] op_sel:[1,1,0] op_sel_hi:[1,0,1] neg_lo:[1,0,0]
    v_cvt_pk_f16_f32 v92, v46, v47
    v_pk_mul_f32 v[38:39], v[40:41], v[28:29] op_sel:[0,0] op_sel_hi:[0,1]
    v_pk_fma_f32 v[38:39], v[40:41], v[28:29], v[38:39] op_sel:[1,1,0] op_sel_hi:[1,0,1] neg_lo:[1,0,0]
    v_cvt_pk_f16_f32 v93, v38, v39
    v_pk_mul_f32 v[44:45], v[42:43], v[28:29] op_sel:[0,0] op_sel_hi:[0,1]
    v_pk_fma_f32 v[44:45], v[42:43], v[28:29], v[44:45] op_sel:[1,1,0] op_sel_hi:[1,0,1] neg_lo:[1,0,0]
    v_cvt_pk_f16_f32 v94, v44, v45
    v_pk_mul_f32 v[48:49], v[46:47], v[28:29] op_sel:[0,0] op_sel_hi:[0,1]
    v_pk_fma_f32 v[48:49], v[46:47], v[28:29], v[48:49] op_sel:[1,1,0] op_sel_hi:[1,0,1] neg_lo:[1,0,0]
    v_cvt_pk_f16_f32 v95, v48, v49
    v_and_b32 v20, 0x7fff7fff, v4
    v_and_b32 v21, 0x7fff7fff, v5
    v_pk_max_u16 v20, v20, v21
    v_lshlrev_b32 v21, 16, v20
    v_max_u32 v20, v20, v21
    s_nop 1
    v_max_u32_dpp v20, v20, v20 row_shr:1 row_mask:0xf bank_mask:0xf
    s_nop 1
    v_max_u32_dpp v20, v20, v20 row_shr:2 row_mask:0xf bank_mask:0xf
    s_nop 1
    v_max_u32_dpp v20, v20, v20 row_shr:4 row_mask:0xf bank_mask:0xf
    s_nop 1
    v_max_u32_dpp v20, v20, v20 row_shr:8 row_mask:0xf bank_mask:0xf
    s_nop 1
    v_max_u32_dpp v20, v20, v20 row_bcast:15 row_mask:0xa bank_mask:0xf
    s_nop 1
    v_max_u32_dpp v20, v20, v20 row_bcast:31 row_mask:0xc bank_mask:0xf
    v_lshlrev_b32 v34, s56, v4
    v_and_b32 v34, 0xffff0000, v34
    v_readlane_b32 s57, v20, 63
    v_lshlrev_b32 v35, s56, v5
    v_and_b32 v35, 0xffff0000, v35
    s_lshr_b32 s57, s57, 23
    s_max_u32 s57, s57, 1
    s_min_u32 s57, s57, 252
    s_sub_u32 s58, 254, s57
    s_lshl_b32 s58, s58, 23
    s_add_u32 s57, s57, 1
    s_lshl_b32 s57, s57, 23
    v_mul_f32 v34, s58, v34
    v_mul_f32 v35, s58, v35
    v_mul_f32 v1, s57, v1
    v_pk_mul_f32 v[36:37], v[34:35], v[26:27] op_sel:[0,0] op_sel_hi:[0,1]
    v_pk_fma_f32 v[36:37], v[34:35], v[26:27], v[36:37] op_sel:[1,1,0] op_sel_hi:[1,0,1] neg_lo:[1,0,0]
    v_cvt_pk_f16_f32 v96, v34, -v35
    v_pk_mul_f32 v[38:39], v[36:37], v[26:27] op_sel:[0,0] op_sel_hi:[0,1]
    v_pk_fma_f32 v[38:39], v[36:37], v[26:27], v[38:39] op_sel:[1,1,0] op_sel_hi:[1,0,1] neg_lo:[1,0,0]
    v_cvt_pk_f16_f32 v97, v36, -v37
    v_pk_mul_f32 v[40:41], v[38:39], v[26:27] op_sel:[0,0] op_sel_hi:[0,1]
    v_pk_fma_f32 v[40:41], v[38:39], v[26:27], v[40:41] op_sel:[1,1,0] op_sel_hi:[1,0,1] neg_lo:[1,0,0]
    v_cvt_pk_f16_f32 v98, v38, -v39
    v_pk_mul_f32 v[42:43], v[40:41], v[26:27] op_sel:[0,0] op_sel_hi:[0,1]
    v_pk_fma_f32 v[42:43], v[40:41], v[26:27], v[42:43] op_sel:[1,1,0] op_sel_hi:[1,0,1] neg_lo:[1,0,0]
    v_cvt_pk_f16_f32 v99, v40, -v41
    v_pk_mul_f32 v[44:45], v[42:43], v[26:27] op_sel:[0,0] op_sel_hi:[0,1]
    v_pk_fma_f32 v[44:45], v[42:43], v[26:27], v[44:45] op_sel:[1,1,0] op_sel_hi:[1,0,1] neg_lo:[1,0,0]
    v_cvt_pk_f16_f32 v100, v42, -v43
    v_pk_mul_f32 v[46:47], v[44:45], v[26:27] op_sel:[0,0] op_sel_hi:[0,1]
    v_pk_fma_f32 v[46:47], v[44:45], v[26:27], v[46:47] op_sel:[1,1,0] op_sel_hi:[1,0,1] neg_lo:[1,0,0]
    v_cvt_pk_f16_f32 v101, v44, -v45
    v_pk_mul_f32 v[48:49], v[46:47], v[26:27] op_sel:[0,0] op_sel_hi:[0,1]
    v_pk_fma_f32 v[48:49], v[46:47], v[26:27], v[48:49] op_sel:[1,1,0] op_sel_hi:[1,0,1] neg_lo:[1,0,0]
    v_cvt_pk_f16_f32 v102, v46, -v47
    v_pk_mul_f32 v[50:51], v[48:49], v[26:27] op_sel:[0,0] op_sel_hi:[0,1]
    v_pk_fma_f32 v[50:51], v[48:49], v[26:27], v[50:51] op_sel:[1,1,0] op_sel_hi:[1,0,1] neg_lo:[1,0,0]
    v_cvt_pk_f16_f32 v103, v48, -v49
    v_pk_mul_f32 v[52:53], v[34:35], v[32:33] op_sel:[0,0] op_sel_hi:[0,1]
    v_pk_fma_f32 v[52:53], v[34:35], v[32:33], v[52:53] op_sel:[1,1,0] op_sel_hi:[1,0,1] neg_lo:[1,0,0]
    v_pk_mul_f32 v[54:55], v[38:39], v[32:33] op_sel:[0,0] op_sel_hi:[0,1]
    v_pk_fma_f32 v[54:55], v[38:39], v[32:33], v[54:55] op_sel:[1,1,0] op_sel_hi:[1,0,1] neg_lo:[1,0,0]
    v_pk_mul_f32 v[56:57], v[42:43], v[32:33] op_sel:[0,0] op_sel_hi:[0,1]
    v_pk_fma_f32 v[56:57], v[42:43], v[32:33], v[56:57] op_sel:[1,1,0] op_sel_hi:[1,0,1] neg_lo:[1,0,0]
    v_pk_mul_f32 v[58:59], v[46:47], v[32:33] op_sel:[0,0] op_sel_hi:[0,1]
    v_pk_fma_f32 v[58:59], v[46:47], v[32:33], v[58:59] op_sel:[1,1,0] op_sel_hi:[1,0,1] neg_lo:[1,0,0]
    v_pk_mul_f32 v[60:61], v[50:51], v[32:33] op_sel:[0,0] op_sel_hi:[0,1]
    v_pk_fma_f32 v[60:61], v[50:51], v[32:33], v[60:61] op_sel:[1,1,0] op_sel_hi:[1,0,1] neg_lo:[1,0,0]
    v_pk_mul_f32 v[34:35], v[52:53], v[32:33] op_sel:[0,0] op_sel_hi:[0,1]
    v_pk_fma_f32 v[34:35], v[52:53], v[32:33], v[34:35] op_sel:[1,1,0] op_sel_hi:[1,0,1] neg_lo:[1,0,0]
    v_cvt_pk_f16_f32 v104, v52, -v53
    v_pk_mul_f32 v[36:37], v[56:57], v[32:33] op_sel:[0,0] op_sel_hi:[0,1]
    v_pk_fma_f32 v[36:37], v[56:57], v[32:33], v[36:37] op_sel:[1,1,0] op_sel_hi:[1,0,1] neg_lo:[1,0,0]
    v_cvt_pk_f16_f32 v105, v56, -v57
    v_pk_mul_f32 v[38:39], v[60:61], v[32:33] op_sel:[0,0] op_sel_hi:[0,1]
    v_pk_fma_f32 v[38:39], v[60:61], v[32:33], v[38:39] op_sel:[1,1,0] op_sel_hi:[1,0,1] neg_lo:[1,0,0]
    v_cvt_pk_f16_f32 v106, v60, -v61
    v_cvt_pk_f16_f32 v107, v54, -v55
    v_cvt_pk_f16_f32 v108, v58, -v59
    v_pk_mul_f32 v[52:53], v[34:35], v[32:33] op_sel:[0,0] op_sel_hi:[0,1]
    v_pk_fma_f32 v[52:53], v[34:35], v[32:33], v[52:53] op_sel:[1,1,0] op_sel_hi:[1,0,1] neg_lo:[1,0,0]
    v_cvt_pk_f16_f32 v109, v34, -v35
    v_pk_mul_f32 v[54:55], v[36:37], v[32:33] op_sel:[0,0] op_sel_hi:[0,1]
    v_pk_fma_f32 v[54:55], v[36:37], v[32:33], v[54:55] op_sel:[1,1,0] op_sel_hi:[1,0,1] neg_lo:[1,0,0]
    v_cvt_pk_f16_f32 v110, v36, -v37
    v_pk_mul_f32 v[56:57], v[38:39], v[32:33] op_sel:[0,0] op_sel_hi:[0,1]
    v_pk_fma_f32 v[56:57], v[38:39], v[32:33], v[56:57] op_sel:[1,1,0] op_sel_hi:[1,0,1] neg_lo:[1,0,0]
    v_cvt_pk_f16_f32 v111, v38, -v39
    v_pk_mul_f32 v[40:41], v[52:53], v[32:33] op_sel:[0,0] op_sel_hi:[0,1]
    v_pk_fma_f32 v[40:41], v[52:53], v[32:33], v[40:41] op_sel:[1,1,0] op_sel_hi:[1,0,1] neg_lo:[1,0,0]
    v_pk_mul_f32 v[42:43], v[56:57], v[32:33] op_sel:[0,0] op_sel_hi:[0,1]
    v_pk_fma_f32 v[42:43], v[56:57], v[32:33], v[42:43] op_sel:[1,1,0] op_sel_hi:[1,0,1] neg_lo:[1,0,0]
    v_cvt_pk_f16_f32 v112, v52, -v53
    v_cvt_pk_f16_f32 v113, v54, -v55
    v_cvt_pk_f16_f32 v114, v56, -v57
    v_pk_mul_f32 v[44:45], v[40:41], v[32:33] op_sel:[0,0] op_sel_hi:[0,1]
    v_pk_fma_f32 v[44:45], v[40:41], v[32:33], v[44:45] op_sel:[1,1,0] op_sel_hi:[1,0,1] neg_lo:[1,0,0]
    v_pk_mul_f32 v[46:47], v[42:43], v[32:33] op_sel:[0,0] op_sel_hi:[0,1]
    v_pk_fma_f32 v[46:47], v[42:43], v[32:33], v[46:47] op_sel:[1,1,0] op_sel_hi:[1,0,1] neg_lo:[1,0,0]
    v_cvt_pk_f16_f32 v115, v40, -v41
    v_cvt_pk_f16_f32 v116, v42, -v43
    v_pk_mul_f32 v[40:41], v[44:45], v[32:33] op_sel:[0,0] op_sel_hi:[0,1]
    v_pk_fma_f32 v[40:41], v[44:45], v[32:33], v[40:41] op_sel:[1,1,0] op_sel_hi:[1,0,1] neg_lo:[1,0,0]
    v_pk_mul_f32 v[42:43], v[46:47], v[32:33] op_sel:[0,0] op_sel_hi:[0,1]
    v_pk_fma_f32 v[42:43], v[46:47], v[32:33], v[42:43] op_sel:[1,1,0] op_sel_hi:[1,0,1] neg_lo:[1,0,0]
    v_cvt_pk_f16_f32 v117, v44, -v45
    v_cvt_pk_f16_f32 v118, v46, -v47
    v_pk_mul_f32 v[44:45], v[40:41], v[32:33] op_sel:[0,0] op_sel_hi:[0,1]
    v_pk_fma_f32 v[44:45], v[40:41], v[32:33], v[44:45] op_sel:[1,1,0] op_sel_hi:[1,0,1] neg_lo:[1,0,0]
    v_pk_mul_f32 v[46:47], v[42:43], v[32:33] op_sel:[0,0] op_sel_hi:[0,1]
    v_pk_fma_f32 v[46:47], v[42:43], v[32:33], v[46:47] op_sel:[1,1,0] op_sel_hi:[1,0,1] neg_lo:[1,0,0]
    v_cvt_pk_f16_f32 v119, v40, -v41
    v_cvt_pk_f16_f32 v120, v42, -v43
    v_cvt_pk_f16_f32 v121, v44, -v45
    v_cvt_pk_f16_f32 v122, v46, -v47
    s_cmp_lg_u32 s59, 0
    s_cbranch_scc1 L_g_pk4
    s_cmp_lg_u32 s59, 0
    s_cbranch_scc1 L_k_dump
    s_waitcnt vmcnt(0)
    s_mov_b64 exec, -1
    v_cmp_ne_u32 vcc, s38, v16
    s_mov_b64 exec, -1
    s_cbranch_vccnz L_k_dump
    s_mov_b32 s59, 1
L_g_pk4:
    v_mul_u32_u24 v16, 9216, v0
    s_and_b32 s45, s3, 3
    s_mul_i32 s44, s45, 589824
    s_lshl_b32 s60, s100, 5
    s_add_u32 s44, s44, s60
    s_add_u32 s44, s44, 0xd00000
    s_lshl_b32 s45, s45, 10
    s_add_u32 m0, s45, 143872
    s_nop 0
    buffer_load_dwordx4 v16, s[4:7], s44 offen sc1 lds
    s_add_u32 m0, s45, 148480
    s_add_u32 s44, s44, 16
    buffer_load_dwordx4 v16, s[4:7], s44 offen sc1 lds
L_k_dump:
    s_setprio 2
    s_and_b32 s44, s3, 3
    s_mul_i32 s44, s44, 17408
    s_mov_b32 m0, s44
    s_nop 0
    ds_write_addtid_b32 v64 offset:8704
    ds_write_addtid_b32 v65 offset:8976
    ds_write_addtid_b32 v66 offset:10880
    ds_write_addtid_b32 v67 offset:13056
    ds_write_addtid_b32 v68 offset:15232
    ds_write_addtid_b32 v69 offset:9248
    ds_write_addtid_b32 v70 offset:11152
    ds_write_addtid_b32 v71 offset:13328
    ds_write_addtid_b32 v72 offset:15504
    ds_write_addtid_b32 v73 offset:9520
    ds_write_addtid_b32 v74 offset:11424
    ds_write_addtid_b32 v75 offset:13600
    ds_write_addtid_b32 v76 offset:15776
    ds_write_addtid_b32 v77 offset:9792
    ds_write_addtid_b32 v78 offset:11696
    ds_write_addtid_b32 v79 offset:13872
    ds_write_addtid_b32 v80 offset:16048
    ds_write_addtid_b32 v81 offset:10064
    ds_write_addtid_b32 v82 offset:11968
    ds_write_addtid_b32 v83 offset:14144
    ds_write_addtid_b32 v84 offset:16320
    ds_write_addtid_b32 v85 offset:10336
    ds_write_addtid_b32 v86 offset:12240
    ds_write_addtid_b32 v87 offset:14416
    ds_write_addtid_b32 v88 offset:16592
    ds_write_addtid_b32 v89 offset:10608
    ds_write_addtid_b32 v90 offset:12512
    ds_write_addtid_b32 v91 offset:14688
    ds_write_addtid_b32 v92 offset:16864
    ds_write_addtid_b32 v93 offset:12784
    ds_write_addtid_b32 v94 offset:14960
    ds_write_addtid_b32 v95 offset:17136
    ds_write_addtid_b32 v96 offset:0
    ds_write_addtid_b32 v97 offset:272
    ds_write_addtid_b32 v98 offset:544
    ds_write_addtid_b32 v99 offset:816
    ds_write_addtid_b32 v100 offset:2176
    ds_write_addtid_b32 v101 offset:2448
    ds_write_addtid_b32 v102 offset:2720
    ds_write_addtid_b32 v103 offset:2992
    ds_write_addtid_b32 v104 offset:1088
    ds_write_addtid_b32 v104 offset:1360
    ds_write_addtid_b32 v105 offset:1904
    ds_write_addtid_b32 v105 offset:3264
    ds_write_addtid_b32 v105 offset:3536
    ds_write_addtid_b32 v106 offset:4080
    ds_write_addtid_b32 v107 offset:1632
    ds_write_addtid_b32 v108 offset:3808
    ds_write_addtid_b32 v109 offset:4352
    ds_write_addtid_b32 v110 offset:4624
    ds_write_addtid_b32 v111 offset:4896
    ds_write_addtid_b32 v112 offset:5440
    ds_write_addtid_b32 v113 offset:5712
    ds_write_addtid_b32 v114 offset:5984
    ds_write_addtid_b32 v115 offset:6528
    ds_write_addtid_b32 v116 offset:6800
    ds_write_addtid_b32 v117 offset:7616
    ds_write_addtid_b32 v118 offset:7888
    ds_write_addtid_b32 v119 offset:7072
    ds_write_addtid_b32 v120 offset:7344
    ds_write_addtid_b32 v121 offset:8160
    ds_write_addtid_b32 v122 offset:8432
L_k_dump2:
    s_mov_b32 s61, s59
    s_mov_b32 s57, 4
    s_mov_b32 s58, 4
    s_mov_b32 s59, 0
    s_getpc_b64 s[62:63]
L_k_pc:
    s_add_u32 s62, s62, L_k_ret-L_k_pc
    s_addc_u32 s63, s63, 0
L_k_mfma:
    s_and_b32 s45, s3, 3
    s_mul_i32 s45, s45, 17408
    v_and_b32 v8, 31, v0
    v_mul_u32_u24 v10, 272, v8
    v_lshrrev_b32 v8, 5, v0
    v_lshl_add_u32 v10, v8, 4, v10
    v_add_u32 v10, s45, v10
    ds_read_b128 v[16:19], v10 offset:0
    ds_read_b128 v[48:51], v10 offset:8704
    ds_read_b128 v[20:23], v10 offset:32
    ds_read_b128 v[52:55], v10 offset:8736
    ds_read_b128 v[24:27], v10 offset:64
    ds_read_b128 v[56:59], v10 offset:8768
    ds_read_b128 v[28:31], v10 offset:96
    ds_read_b128 v[60:63], v10 offset:8800
    ds_read_b128 v[32:35], v10 offset:128
    ds_read_b128 v[64:67], v10 offset:8832
    ds_read_b128 v[36:39], v10 offset:160
    ds_read_b128 v[68:71], v10 offset:8864
    ds_read_b128 v[40:43], v10 offset:192
    ds_read_b128 v[72:75], v10 offset:8896
    v_add_u32 v12, s45, v7
    s_and_b32 s46, s3, 3
    s_xor_b32 s46, s46, 1
    s_mul_i32 s46, s46, 17408
    v_add_u32 v13, s46, v7
    v_lshlrev_b32 v6, 16, v6
    v_cmp_eq_u32 vcc, 0, v0
    s_bfe_u32 s44, s3, 0x10001
    s_mul_i32 s46, s44, 16640
    v_cndmask_b32 v6, 0, v6, vcc
    s_add_u32 s46, s46, 76800
    v_add_u32 v11, s46, v7
    s_waitcnt lgkmcnt(12)
    v_mfma_f32_32x32x16_f16 v[124:139], v[16:19], v[48:51], 0
    ds_read_b128 v[44:47], v10 offset:224
    ds_read_b128 v[76:79], v10 offset:8928
    s_waitcnt lgkmcnt(12)
    v_mfma_f32_32x32x16_f16 v[124:139], v[20:23], v[52:55], v[124:139]
    s_waitcnt lgkmcnt(10)
    v_mfma_f32_32x32x16_f16 v[124:139], v[24:27], v[56:59], v[124:139]
    s_waitcnt lgkmcnt(8)
    v_mfma_f32_32x32x16_f16 v[124:139], v[28:31], v[60:63], v[124:139]
    s_waitcnt lgkmcnt(6)
    v_mfma_f32_32x32x16_f16 v[124:139], v[32:35], v[64:67], v[124:139]
    s_waitcnt lgkmcnt(4)
    v_mfma_f32_32x32x16_f16 v[124:139], v[36:39], v[68:71], v[124:139]
    s_waitcnt lgkmcnt(2)
    v_mfma_f32_32x32x16_f16 v[124:139], v[40:43], v[72:75], v[124:139]
    s_waitcnt lgkmcnt(0)
    v_mfma_f32_32x32x16_f16 v[124:139], v[44:47], v[76:79], v[124:139]
    v_lshrrev_b32 v8, 4, v0
    v_mul_u32_u24 v8, 4160, v8
    v_and_b32 v9, 15, v0
    v_lshl_add_u32 v8, v9, 2, v8
    v_add_u32 v8, s46, v8
    v_mov_b32 v9, 0
    v_mov_b32 v48, 153536
L_lw13:
    ds_read_b32 v49, v48 offset:8
    s_add_u32 s42, s42, 1
    s_cmp_lt_u32 s42, 0xf42400
    s_cselect_b64 s[40:41], -1, 0
    s_waitcnt lgkmcnt(0)
    v_cmp_gt_u32 vcc, s57, v49
    s_and_b64 vcc, vcc, s[40:41]
    s_cbranch_vccnz L_lw13
    s_nop 1
    s_bitcmp1_b32 s3, 0
    s_cbranch_scc1 L_km_w1
    ds_write_b128 v12, v[136:139] offset:3072
    s_branch L_km_w2
L_km_w1:
    ds_write_b128 v12, v[124:127] offset:0
    ds_write_b128 v12, v[128:131] offset:1024
L_km_w2:
    ds_write_b128 v12, v[132:135] offset:2048
    s_mov_b64 exec, 1
    v_mov_b32 v48, 153536
    v_mov_b32 v49, 1
    ds_add_u32 v48, v49 offset:44
    s_mov_b64 exec, -1
    v_mov_b32 v48, 153536
L_lw14:
    ds_read_b32 v49, v48 offset:44
    s_add_u32 s42, s42, 1
    s_cmp_lt_u32 s42, 0xf42400
    s_cselect_b64 s[40:41], -1, 0
    s_waitcnt lgkmcnt(0)
    v_cmp_gt_u32 vcc, s58, v49
    s_and_b64 vcc, vcc, s[40:41]
    s_cbranch_vccnz L_lw14
    ds_read_b128 v[140:143], v13 offset:0
    ds_read_b128 v[144:147], v13 offset:1024
    ds_read_b128 v[148:151], v13 offset:2048
    ds_read_b128 v[152:155], v13 offset:3072
    s_mov_b64 exec, 1
    v_mov_b32 v48, 153536
    v_mov_b32 v49, 1
    ds_add_u32 v48, v49 offset:16
    s_mov_b64 exec, -1
    v_mov_b32 v48, 153536
L_lw15:
    ds_read_b32 v49, v48 offset:24
    s_add_u32 s42, s42, 1
    s_cmp_lt_u32 s42, 0xf42400
    s_cselect_b64 s[40:41], -1, 0
    s_waitcnt lgkmcnt(0)
    v_cmp_gt_u32 vcc, s59, v49
    s_and_b64 vcc, vcc, s[40:41]
    s_cbranch_vccnz L_lw15
    s_bitcmp1_b32 s3, 0
    s_cbranch_scc1 L_km_hi
    ds_write_b32 v8, v9
    v_add_f32 v124, v124, v140
    v_fma_f32 v124, v124, v1, v6
    v_add_f32 v125, v125, v141
    v_mul_f32 v125, v125, v1
    v_add_f32 v126, v126, v142
    v_mul_f32 v126, v126, v1
    v_add_f32 v127, v127, v143
    v_mul_f32 v127, v127, v1
    v_add_f32 v128, v128, v144
    v_mul_f32 v128, v128, v1
    v_add_f32 v129, v129, v145
    v_mul_f32 v129, v129, v1
    v_add_f32 v130, v130, v146
    v_mul_f32 v130, v130, v1
    v_add_f32 v131, v131, v147
    v_mul_f32 v131, v131, v1
    v_cvt_pk_bf16_f32 v16, v124, v125
    v_cvt_pk_bf16_f32 v17, v126, v127
    v_cvt_pk_bf16_f32 v18, v128, v129
    v_cvt_pk_bf16_f32 v19, v130, v131
    ds_write_b128 v11, v[16:19] offset:64
    ds_read_b64 v[48:49], v11 offset:56
    v_add_f32 v132, v132, v148
    v_mul_f32 v132, v132, v1
    v_add_f32 v133, v133, v149
    v_mul_f32 v133, v133, v1
    v_add_f32 v134, v134, v150
    v_mul_f32 v134, v134, v1
    v_cvt_pk_bf16_f32 v20, v132, v132
    v_cvt_pk_bf16_f32 v21, v132, v133
    v_cvt_pk_bf16_f32 v22, v133, v133
    v_cvt_pk_bf16_f32 v23, v134, v134
    ds_write_b128 v11, v[20:23] offset:1088
    ds_read_b64 v[52:53], v11 offset:1080
    v_alignbit_b32 v81, v17, v16, 16
    v_alignbit_b32 v82, v18, v17, 16
    v_alignbit_b32 v83, v19, v18, 16
    v_alignbit_b32 v90, v17, v16, 16
    v_alignbit_b32 v91, v18, v17, 16
    v_mov_b32 v85, v16
    v_mov_b32 v86, v17
    v_mov_b32 v87, v18
    s_waitcnt lgkmcnt(2)
    v_alignbit_b32 v80, v16, v49, 16
    v_mov_b32 v84, v49
    v_alignbit_b32 v88, v49, v48, 16
    v_alignbit_b32 v89, v16, v49, 16
    ds_write_b128 v11, v[80:83] offset:4224
    ds_write_b128 v11, v[84:87] offset:8384
    ds_write_b128 v11, v[88:91] offset:12544
    v_alignbit_b32 v93, v21, v20, 16
    v_alignbit_b32 v94, v22, v21, 16
    v_alignbit_b32 v95, v23, v22, 16
    v_alignbit_b32 v102, v21, v20, 16
    v_alignbit_b32 v103, v22, v21, 16
    v_mov_b32 v97, v20
    v_mov_b32 v98, v21
    v_mov_b32 v99, v22
    s_waitcnt lgkmcnt(3)
    v_alignbit_b32 v92, v20, v53, 16
    v_mov_b32 v96, v53
    v_alignbit_b32 v100, v53, v52, 16
    v_alignbit_b32 v101, v20, v53, 16
    ds_write_b128 v11, v[92:95] offset:5248
    ds_write_b128 v11, v[96:99] offset:9408
    ds_write_b128 v11, v[100:103] offset:13568
    s_branch L_km_x
L_km_hi:
    v_and_b32 v8, 1, v0
    v_cmp_eq_u32 vcc, 1, v8
    v_add_f32 v132, v132, v148
    v_mul_f32 v132, v132, v1
    v_add_f32 v133, v133, v149
    v_mul_f32 v133, v133, v1
    v_add_f32 v134, v134, v150
    v_mul_f32 v134, v134, v1
    v_cvt_pk_bf16_f32 v20, v132, v132
    v_cvt_pk_bf16_f32 v21, v132, v133
    v_cvt_pk_bf16_f32 v22, v133, v133
    v_cvt_pk_bf16_f32 v23, v134, v134
    ds_write_b128 v11, v[20:23] offset:1088
    v_add_f32 v136, v136, v152
    v_mul_f32 v136, v136, v1
    v_add_f32 v137, v137, v153
    v_mul_f32 v137, v137, v1
    v_cndmask_b32 v8, v136, v137, vcc
    v_cvt_pk_bf16_f32 v24, v136, v136
    v_cvt_pk_bf16_f32 v25, v136, v136
    v_cvt_pk_bf16_f32 v26, v8, v137
    v_cvt_pk_bf16_f32 v27, v137, v137
    ds_write_b128 v11, v[24:27] offset:2112
    ds_read_b64 v[56:57], v11 offset:2104
    v_add_f32 v138, v138, v154
    v_mul_f32 v138, v138, v1
    v_add_f32 v139, v139, v155
    v_mul_f32 v139, v139, v1
    v_cndmask_b32 v8, v138, v139, vcc
    v_cvt_pk_bf16_f32 v28, v138, v138
    v_cvt_pk_bf16_f32 v29, v138, v138
    v_cvt_pk_bf16_f32 v30, v8, v139
    v_cvt_pk_bf16_f32 v31, v139, v139
    ds_write_b128 v11, v[28:31] offset:3136
    ds_read_b64 v[60:61], v11 offset:3128
    v_alignbit_b32 v81, v25, v24, 16
    v_alignbit_b32 v82, v26, v25, 16
    v_alignbit_b32 v83, v27, v26, 16
    v_alignbit_b32 v90, v25, v24, 16
    v_alignbit_b32 v91, v26, v25, 16
    v_mov_b32 v85, v24
    v_mov_b32 v86, v25
    v_mov_b32 v87, v26
    s_waitcnt lgkmcnt(2)
    v_alignbit_b32 v80, v24, v57, 16
    v_mov_b32 v84, v57
    v_alignbit_b32 v88, v57, v56, 16
    v_alignbit_b32 v89, v24, v57, 16
    ds_write_b128 v11, v[80:83] offset:6272
    ds_write_b128 v11, v[84:87] offset:10432
    ds_write_b128 v11, v[88:91] offset:14592
    v_alignbit_b32 v93, v29, v28, 16
    v_alignbit_b32 v94, v30, v29, 16
    v_alignbit_b32 v95, v31, v30, 16
    v_alignbit_b32 v102, v29, v28, 16
    v_alignbit_b32 v103, v30, v29, 16
    v_mov_b32 v97, v28
    v_mov_b32 v98, v29
    v_mov_b32 v99, v30
    s_waitcnt lgkmcnt(3)
    v_alignbit_b32 v92, v28, v61, 16
    v_mov_b32 v96, v61
    v_alignbit_b32 v100, v61, v60, 16
    v_alignbit_b32 v101, v28, v61, 16
    ds_write_b128 v11, v[92:95] offset:7296
    ds_write_b128 v11, v[96:99] offset:11456
    ds_write_b128 v11, v[100:103] offset:15616
L_km_x:
    s_waitcnt lgkmcnt(0)
    s_setpc_b64 s[62:63]
L_k_ret:
    s_cmp_lg_u32 s61, 0
    s_cbranch_scc1 L_k_j
    v_lshlrev_b32 v9, 9, v0
    s_mul_i32 s44, s100, 911
    s_lshr_b32 s44, s44, 16
    s_lshl_b32 s44, s44, 7
    s_add_u32 s44, s44, 0x12c8000
    s_mov_b32 s60, 0
L_poll16:
    buffer_load_dword v8, v9, s[4:7], s44 offen sc1
    s_add_u32 s60, s60, 1
    s_waitcnt vmcnt(0)
    v_cmp_ne_u32 vcc, s38, v8
    s_cbranch_vccz L_poll16_ok
    s_sleep 4
    s_cmp_lt_u32 s60, 0xf4240
    s_cbranch_scc1 L_poll16
L_poll16_ok:
    v_mul_u32_u24 v8, 9216, v0
    s_and_b32 s45, s3, 3
    s_mul_i32 s44, s45, 589824
    s_lshl_b32 s60, s100, 5
    s_add_u32 s44, s44, s60
    s_add_u32 s44, s44, 0xd00000
    s_lshl_b32 s45, s45, 10
    s_add_u32 m0, s45, 143872
    s_nop 0
    buffer_load_dwordx4 v8, s[4:7], s44 offen sc1 lds
    s_add_u32 m0, s45, 148480
    s_add_u32 s44, s44, 16
    buffer_load_dwordx4 v8, s[4:7], s44 offen sc1 lds
L_k_j:
    s_waitcnt vmcnt(0)
    s_mov_b64 exec, 1
    v_mov_b32 v8, 153536
    v_mov_b32 v9, 1
    ds_add_u32 v8, v9 offset:4
    s_mov_b64 exec, -1
L_conv:
    v_mov_b32 v8, 153536
L_lw17:
    ds_read_b32 v9, v8 offset:4
    s_add_u32 s42, s42, 1
    s_cmp_lt_u32 s42, 0xf42400
    s_cselect_b64 s[40:41], -1, 0
    s_waitcnt lgkmcnt(0)
    v_cmp_gt_u32 vcc, s101, v9
    s_and_b64 vcc, vcc, s[40:41]
    s_cbranch_vccnz L_lw17
    ds_read_b64_tr_b16 v[8:9], v208 offset:8
    ds_read_b64_tr_b16 v[10:11], v208 offset:0
    ds_read_b128 v[72:75], v209 offset:192
    ds_read_b64_tr_b16 v[12:13], v208 offset:520
    ds_read_b64_tr_b16 v[14:15], v208 offset:512
    ds_read_b128 v[76:79], v209 offset:704
    ds_read_b64_tr_b16 v[16:17], v208 offset:1032
    ds_read_b64_tr_b16 v[18:19], v208 offset:1024
    ds_read_b128 v[80:83], v209 offset:1216
    ds_read_b64_tr_b16 v[20:21], v208 offset:1544
    ds_read_b64_tr_b16 v[22:23], v208 offset:1536
    ds_read_b128 v[84:87], v209 offset:1728
    ds_read_b64_tr_b16 v[24:25], v208 offset:2056
    ds_read_b64_tr_b16 v[26:27], v208 offset:2048
    ds_read_b128 v[88:91], v209 offset:2240
    s_lshl_b32 s53, s100, 13
    s_and_b32 s54, s3, 3
    s_lshl_b32 s54, s54, 11
    s_add_u32 s53, s53, s54
    s_add_u32 s53, s53, 0x1000000
    s_waitcnt lgkmcnt(12)
    v_mfma_f32_16x16x32_bf16 v[136:139], v[8:11], v[72:75], 0
    s_waitcnt lgkmcnt(9)
    v_mfma_f32_16x16x32_bf16 v[140:143], v[8:11], v[76:79], 0
    ds_read_b64_tr_b16 v[28:29], v208 offset:2568
    v_mfma_f32_16x16x32_bf16 v[140:143], v[12:15], v[72:75], v[140:143]
    ds_read_b64_tr_b16 v[30:31], v208 offset:2560
    v_mfma_f32_16x16x32_bf16 v[144:147], v[12:15], v[76:79], 0
    ds_read_b128 v[92:95], v209 offset:2752
    s_waitcnt lgkmcnt(9)
    v_mfma_f32_16x16x32_bf16 v[144:147], v[8:11], v[80:83], v[144:147]
    ds_read_b64_tr_b16 v[32:33], v208 offset:3080
    v_mfma_f32_16x16x32_bf16 v[148:151], v[12:15], v[80:83], 0
    ds_read_b64_tr_b16 v[34:35], v208 offset:3072
    v_mfma_f32_16x16x32_bf16 v[144:147], v[16:19], v[72:75], v[144:147]
    ds_read_b128 v[96:99], v209 offset:3264
    v_mfma_f32_16x16x32_bf16 v[148:151], v[16:19], v[76:79], v[148:151]
    v_mfma_f32_16x16x32_bf16 v[152:155], v[16:19], v[80:83], 0
    s_waitcnt lgkmcnt(9)
    v_mfma_f32_16x16x32_bf16 v[148:151], v[8:11], v[84:87], v[148:151]
    ds_read_b64_tr_b16 v[36:37], v208 offset:3592
    v_mfma_f32_16x16x32_bf16 v[152:155], v[12:15], v[84:87], v[152:155]
    ds_read_b64_tr_b16 v[38:39], v208 offset:3584
    v_mfma_f32_16x16x32_bf16 v[156:159], v[16:19], v[84:87], 0
    ds_read_b128 v[100:103], v209 offset:3776
    v_mfma_f32_16x16x32_bf16 v[148:151], v[20:23], v[72:75], v[148:151]
    v_mfma_f32_16x16x32_bf16 v[152:155], v[20:23], v[76:79], v[152:155]
    v_mfma_f32_16x16x32_bf16 v[156:159], v[20:23], v[80:83], v[156:159]
    v_mfma_f32_16x16x32_bf16 v[160:163], v[20:23], v[84:87], 0
    s_waitcnt lgkmcnt(9)
    v_mfma_f32_16x16x32_bf16 v[152:155], v[8:11], v[88:91], v[152:155]
    ds_read_b64_tr_b16 v[40:41], v208 offset:72
    v_mfma_f32_16x16x32_bf16 v[156:159], v[12:15], v[88:91], v[156:159]
    ds_read_b64_tr_b16 v[42:43], v208 offset:64
    v_mfma_f32_16x16x32_bf16 v[160:163], v[16:19], v[88:91], v[160:163]
    ds_read_b128 v[104:107], v209 offset:128
    v_mfma_f32_16x16x32_bf16 v[164:167], v[20:23], v[88:91], 0
    v_mfma_f32_16x16x32_bf16 v[152:155], v[24:27], v[72:75], v[152:155]
    v_mfma_f32_16x16x32_bf16 v[156:159], v[24:27], v[76:79], v[156:159]
    v_mfma_f32_16x16x32_bf16 v[160:163], v[24:27], v[80:83], v[160:163]
    v_mfma_f32_16x16x32_bf16 v[164:167], v[24:27], v[84:87], v[164:167]
    s_waitcnt lgkmcnt(9)
    v_mfma_f32_16x16x32_bf16 v[156:159], v[8:11], v[92:95], v[156:159]
    ds_read_b64_tr_b16 v[44:45], v208 offset:584
    v_mfma_f32_16x16x32_bf16 v[160:163], v[12:15], v[92:95], v[160:163]
    ds_read_b64_tr_b16 v[46:47], v208 offset:576
    v_mfma_f32_16x16x32_bf16 v[164:167], v[16:19], v[92:95], v[164:167]
    ds_read_b128 v[108:111], v209 offset:640
    v_mfma_f32_16x16x32_bf16 v[156:159], v[28:31], v[72:75], v[156:159]
    v_mfma_f32_16x16x32_bf16 v[160:163], v[28:31], v[76:79], v[160:163]
    v_mfma_f32_16x16x32_bf16 v[164:167], v[28:31], v[80:83], v[164:167]
    s_waitcnt lgkmcnt(9)
    v_mfma_f32_16x16x32_bf16 v[160:163], v[8:11], v[96:99], v[160:163]
    ds_read_b64_tr_b16 v[48:49], v208 offset:1096
    v_mfma_f32_16x16x32_bf16 v[164:167], v[12:15], v[96:99], v[164:167]
    ds_read_b64_tr_b16 v[50:51], v208 offset:1088
    v_mfma_f32_16x16x32_bf16 v[160:163], v[32:35], v[72:75], v[160:163]
    ds_read_b128 v[112:115], v209 offset:1152
    v_mfma_f32_16x16x32_bf16 v[164:167], v[32:35], v[76:79], v[164:167]
    s_waitcnt lgkmcnt(9)
    v_mfma_f32_16x16x32_bf16 v[164:167], v[8:11], v[100:103], v[164:167]
    ds_read_b64_tr_b16 v[52:53], v208 offset:1608
    v_mfma_f32_16x16x32_bf16 v[164:167], v[36:39], v[72:75], v[164:167]
    ds_read_b64_tr_b16 v[54:55], v208 offset:1600
    ds_read_b128 v[116:119], v209 offset:1664
    ds_read_b64_tr_b16 v[56:57], v208 offset:2120
    ds_read_b64_tr_b16 v[58:59], v208 offset:2112
    ds_read_b128 v[120:123], v209 offset:2176
    ds_read_b64_tr_b16 v[60:61], v208 offset:2632
    ds_read_b64_tr_b16 v[62:63], v208 offset:2624
    ds_read_b128 v[124:127], v209 offset:2688
    ds_read_b64_tr_b16 v[64:65], v208 offset:3144
    ds_read_b64_tr_b16 v[66:67], v208 offset:3136
    ds_read_b128 v[128:131], v209 offset:3200
    ds_read_b64_tr_b16 v[68:69], v208 offset:3656
    ds_read_b64_tr_b16 v[70:71], v208 offset:3648
    ds_read_b128 v[132:135], v209 offset:3712
    s_waitcnt lgkmcnt(0)
    v_mfma_f32_16x16x32_bf16 v[136:139], v[40:43], v[104:107], v[136:139]
    ds_read_b64_tr_b16 v[8:9], v208 offset:136
    v_mfma_f32_16x16x32_bf16 v[140:143], v[40:43], v[108:111], v[140:143]
    ds_read_b64_tr_b16 v[10:11], v208 offset:128
    v_mfma_f32_16x16x32_bf16 v[144:147], v[40:43], v[112:115], v[144:147]
    ds_read_b128 v[72:75], v209 offset:64
    v_mfma_f32_16x16x32_bf16 v[148:151], v[40:43], v[116:119], v[148:151]
    ds_read_b64_tr_b16 v[12:13], v208 offset:648
    v_mfma_f32_16x16x32_bf16 v[152:155], v[40:43], v[120:123], v[152:155]
    ds_read_b64_tr_b16 v[14:15], v208 offset:640
    v_mfma_f32_16x16x32_bf16 v[156:159], v[40:43], v[124:127], v[156:159]
    ds_read_b128 v[76:79], v209 offset:576
    v_mfma_f32_16x16x32_bf16 v[160:163], v[40:43], v[128:131], v[160:163]
    ds_read_b64_tr_b16 v[16:17], v208 offset:1160
    v_mfma_f32_16x16x32_bf16 v[164:167], v[40:43], v[132:135], v[164:167]
    ds_read_b64_tr_b16 v[18:19], v208 offset:1152
    v_mfma_f32_16x16x32_bf16 v[140:143], v[44:47], v[104:107], v[140:143]
    ds_read_b128 v[80:83], v209 offset:1088
    v_mfma_f32_16x16x32_bf16 v[144:147], v[44:47], v[108:111], v[144:147]
    ds_read_b64_tr_b16 v[20:21], v208 offset:1672
    v_mfma_f32_16x16x32_bf16 v[148:151], v[44:47], v[112:115], v[148:151]
    ds_read_b64_tr_b16 v[22:23], v208 offset:1664
    v_mfma_f32_16x16x32_bf16 v[152:155], v[44:47], v[116:119], v[152:155]
    ds_read_b128 v[84:87], v209 offset:1600
    v_mfma_f32_16x16x32_bf16 v[156:159], v[44:47], v[120:123], v[156:159]
    ds_read_b64_tr_b16 v[24:25], v208 offset:2184
    v_mfma_f32_16x16x32_bf16 v[160:163], v[44:47], v[124:127], v[160:163]
    ds_read_b64_tr_b16 v[26:27], v208 offset:2176
    v_mfma_f32_16x16x32_bf16 v[164:167], v[44:47], v[128:131], v[164:167]
    ds_read_b128 v[88:91], v209 offset:2112
    v_mfma_f32_16x16x32_bf16 v[144:147], v[48:51], v[104:107], v[144:147]
    ds_read_b64_tr_b16 v[28:29], v208 offset:2696
    v_mfma_f32_16x16x32_bf16 v[148:151], v[48:51], v[108:111], v[148:151]
    ds_read_b64_tr_b16 v[30:31], v208 offset:2688
    v_mfma_f32_16x16x32_bf16 v[152:155], v[48:51], v[112:115], v[152:155]
    ds_read_b128 v[92:95], v209 offset:2624
    v_mfma_f32_16x16x32_bf16 v[156:159], v[48:51], v[116:119], v[156:159]
    ds_read_b64_tr_b16 v[32:33], v208 offset:3208
    v_mfma_f32_16x16x32_bf16 v[160:163], v[48:51], v[120:123], v[160:163]
    ds_read_b64_tr_b16 v[34:35], v208 offset:3200
    v_mfma_f32_16x16x32_bf16 v[164:167], v[48:51], v[124:127], v[164:167]
    ds_read_b128 v[96:99], v209 offset:3136
    v_mfma_f32_16x16x32_bf16 v[148:151], v[52:55], v[104:107], v[148:151]
    ds_read_b64_tr_b16 v[36:37], v208 offset:3720
    v_mfma_f32_16x16x32_bf16 v[152:155], v[52:55], v[108:111], v[152:155]
    ds_read_b64_tr_b16 v[38:39], v208 offset:3712
    v_mfma_f32_16x16x32_bf16 v[156:159], v[52:55], v[112:115], v[156:159]
    ds_read_b128 v[100:103], v209 offset:3648
    v_mfma_f32_16x16x32_bf16 v[160:163], v[52:55], v[116:119], v[160:163]
    v_mfma_f32_16x16x32_bf16 v[164:167], v[52:55], v[120:123], v[164:167]
    v_mfma_f32_16x16x32_bf16 v[152:155], v[56:59], v[104:107], v[152:155]
    v_mfma_f32_16x16x32_bf16 v[156:159], v[56:59], v[108:111], v[156:159]
    v_mfma_f32_16x16x32_bf16 v[160:163], v[56:59], v[112:115], v[160:163]
    v_mfma_f32_16x16x32_bf16 v[164:167], v[56:59], v[116:119], v[164:167]
    v_mfma_f32_16x16x32_bf16 v[156:159], v[60:63], v[104:107], v[156:159]
    v_mfma_f32_16x16x32_bf16 v[160:163], v[60:63], v[108:111], v[160:163]
    v_mfma_f32_16x16x32_bf16 v[164:167], v[60:63], v[112:115], v[164:167]
    v_mfma_f32_16x16x32_bf16 v[160:163], v[64:67], v[104:107], v[160:163]
    v_mfma_f32_16x16x32_bf16 v[164:167], v[64:67], v[108:111], v[164:167]
    v_mfma_f32_16x16x32_bf16 v[164:167], v[68:71], v[104:107], v[164:167]
    s_waitcnt lgkmcnt(0)
    v_mfma_f32_16x16x32_bf16 v[136:139], v[8:11], v[72:75], v[136:139]
    ds_read_b64_tr_b16 v[40:41], v208 offset:200
    v_mfma_f32_16x16x32_bf16 v[140:143], v[8:11], v[76:79], v[140:143]
    ds_read_b64_tr_b16 v[42:43], v208 offset:192
    v_mfma_f32_16x16x32_bf16 v[144:147], v[8:11], v[80:83], v[144:147]
    ds_read_b128 v[104:107], v209 offset:0
    v_mfma_f32_16x16x32_bf16 v[148:151], v[8:11], v[84:87], v[148:151]
    ds_read_b64_tr_b16 v[44:45], v208 offset:712
    v_mfma_f32_16x16x32_bf16 v[152:155], v[8:11], v[88:91], v[152:155]
    ds_read_b64_tr_b16 v[46:47], v208 offset:704
    v_mfma_f32_16x16x32_bf16 v[156:159], v[8:11], v[92:95], v[156:159]
    ds_read_b128 v[108:111], v209 offset:512
    v_mfma_f32_16x16x32_bf16 v[160:163], v[8:11], v[96:99], v[160:163]
    ds_read_b64_tr_b16 v[48:49], v208 offset:1224
    v_mfma_f32_16x16x32_bf16 v[164:167], v[8:11], v[100:103], v[164:167]
    ds_read_b64_tr_b16 v[50:51], v208 offset:1216
    v_mfma_f32_16x16x32_bf16 v[140:143], v[12:15], v[72:75], v[140:143]
    ds_read_b128 v[112:115], v209 offset:1024
    v_mfma_f32_16x16x32_bf16 v[144:147], v[12:15], v[76:79], v[144:147]
    ds_read_b64_tr_b16 v[52:53], v208 offset:1736
    v_mfma_f32_16x16x32_bf16 v[148:151], v[12:15], v[80:83], v[148:151]
    ds_read_b64_tr_b16 v[54:55], v208 offset:1728
    v_mfma_f32_16x16x32_bf16 v[152:155], v[12:15], v[84:87], v[152:155]
    ds_read_b128 v[116:119], v209 offset:1536
    v_mfma_f32_16x16x32_bf16 v[156:159], v[12:15], v[88:91], v[156:159]
    ds_read_b64_tr_b16 v[56:57], v208 offset:2248
    v_mfma_f32_16x16x32_bf16 v[160:163], v[12:15], v[92:95], v[160:163]
    ds_read_b64_tr_b16 v[58:59], v208 offset:2240
    v_mfma_f32_16x16x32_bf16 v[164:167], v[12:15], v[96:99], v[164:167]
    ds_read_b128 v[120:123], v209 offset:2048
    v_mfma_f32_16x16x32_bf16 v[144:147], v[16:19], v[72:75], v[144:147]
    ds_read_b64_tr_b16 v[60:61], v208 offset:2760
    v_mfma_f32_16x16x32_bf16 v[148:151], v[16:19], v[76:79], v[148:151]
    ds_read_b64_tr_b16 v[62:63], v208 offset:2752
    v_mfma_f32_16x16x32_bf16 v[152:155], v[16:19], v[80:83], v[152:155]
    ds_read_b128 v[124:127], v209 offset:2560
    v_mfma_f32_16x16x32_bf16 v[156:159], v[16:19], v[84:87], v[156:159]
    ds_read_b64_tr_b16 v[64:65], v208 offset:3272
    v_mfma_f32_16x16x32_bf16 v[160:163], v[16:19], v[88:91], v[160:163]
    ds_read_b64_tr_b16 v[66:67], v208 offset:3264
    v_mfma_f32_16x16x32_bf16 v[164:167], v[16:19], v[92:95], v[164:167]
    ds_read_b128 v[128:131], v209 offset:3072
    v_mfma_f32_16x16x32_bf16 v[148:151], v[20:23], v[72:75], v[148:151]
    ds_read_b64_tr_b16 v[68:69], v208 offset:3784
    v_mfma_f32_16x16x32_bf16 v[152:155], v[20:23], v[76:79], v[152:155]
    ds_read_b64_tr_b16 v[70:71], v208 offset:3776
    v_mfma_f32_16x16x32_bf16 v[156:159], v[20:23], v[80:83], v[156:159]
    ds_read_b128 v[132:135], v209 offset:3584
    v_mfma_f32_16x16x32_bf16 v[160:163], v[20:23], v[84:87], v[160:163]
    v_mfma_f32_16x16x32_bf16 v[164:167], v[20:23], v[88:91], v[164:167]
    v_mfma_f32_16x16x32_bf16 v[152:155], v[24:27], v[72:75], v[152:155]
    v_mfma_f32_16x16x32_bf16 v[156:159], v[24:27], v[76:79], v[156:159]
    v_mfma_f32_16x16x32_bf16 v[160:163], v[24:27], v[80:83], v[160:163]
    v_mfma_f32_16x16x32_bf16 v[164:167], v[24:27], v[84:87], v[164:167]
    v_mfma_f32_16x16x32_bf16 v[156:159], v[28:31], v[72:75], v[156:159]
    v_mfma_f32_16x16x32_bf16 v[160:163], v[28:31], v[76:79], v[160:163]
    v_mfma_f32_16x16x32_bf16 v[164:167], v[28:31], v[80:83], v[164:167]
    v_mfma_f32_16x16x32_bf16 v[160:163], v[32:35], v[72:75], v[160:163]
    v_mfma_f32_16x16x32_bf16 v[164:167], v[32:35], v[76:79], v[164:167]
    v_mfma_f32_16x16x32_bf16 v[164:167], v[36:39], v[72:75], v[164:167]
    s_waitcnt lgkmcnt(0)
    v_mfma_f32_16x16x32_bf16 v[136:139], v[40:43], v[104:107], v[136:139]
    v_mfma_f32_16x16x32_bf16 v[140:143], v[40:43], v[108:111], v[140:143]
    v_mfma_f32_16x16x32_bf16 v[144:147], v[40:43], v[112:115], v[144:147]
    v_mfma_f32_16x16x32_bf16 v[148:151], v[40:43], v[116:119], v[148:151]
    v_mfma_f32_16x16x32_bf16 v[152:155], v[40:43], v[120:123], v[152:155]
    v_mfma_f32_16x16x32_bf16 v[156:159], v[40:43], v[124:127], v[156:159]
    v_mfma_f32_16x16x32_bf16 v[160:163], v[40:43], v[128:131], v[160:163]
    v_mfma_f32_16x16x32_bf16 v[164:167], v[40:43], v[132:135], v[164:167]
    v_mfma_f32_16x16x32_bf16 v[140:143], v[44:47], v[104:107], v[140:143]
    v_mfma_f32_16x16x32_bf16 v[144:147], v[44:47], v[108:111], v[144:147]
    v_mfma_f32_16x16x32_bf16 v[148:151], v[44:47], v[112:115], v[148:151]
    v_mfma_f32_16x16x32_bf16 v[152:155], v[44:47], v[116:119], v[152:155]
    v_mfma_f32_16x16x32_bf16 v[156:159], v[44:47], v[120:123], v[156:159]
    v_mfma_f32_16x16x32_bf16 v[160:163], v[44:47], v[124:127], v[160:163]
    v_mfma_f32_16x16x32_bf16 v[164:167], v[44:47], v[128:131], v[164:167]
    v_mfma_f32_16x16x32_bf16 v[144:147], v[48:51], v[104:107], v[144:147]
    v_mfma_f32_16x16x32_bf16 v[148:151], v[48:51], v[108:111], v[148:151]
    v_mfma_f32_16x16x32_bf16 v[152:155], v[48:51], v[112:115], v[152:155]
    v_mfma_f32_16x16x32_bf16 v[156:159], v[48:51], v[116:119], v[156:159]
    v_mfma_f32_16x16x32_bf16 v[160:163], v[48:51], v[120:123], v[160:163]
    v_mfma_f32_16x16x32_bf16 v[164:167], v[48:51], v[124:127], v[164:167]
    ds_write_b128 v210, v[136:139] offset:0
    v_mfma_f32_16x16x32_bf16 v[148:151], v[52:55], v[104:107], v[148:151]
    v_mfma_f32_16x16x32_bf16 v[152:155], v[52:55], v[108:111], v[152:155]
    v_mfma_f32_16x16x32_bf16 v[156:159], v[52:55], v[112:115], v[156:159]
    v_mfma_f32_16x16x32_bf16 v[160:163], v[52:55], v[116:119], v[160:163]
    v_mfma_f32_16x16x32_bf16 v[164:167], v[52:55], v[120:123], v[164:167]
    ds_write_b128 v210, v[140:143] offset:1024
    v_mfma_f32_16x16x32_bf16 v[152:155], v[56:59], v[104:107], v[152:155]
    v_mfma_f32_16x16x32_bf16 v[156:159], v[56:59], v[108:111], v[156:159]
    v_mfma_f32_16x16x32_bf16 v[160:163], v[56:59], v[112:115], v[160:163]
    v_mfma_f32_16x16x32_bf16 v[164:167], v[56:59], v[116:119], v[164:167]
    ds_write_b128 v210, v[144:147] offset:2048
    v_mfma_f32_16x16x32_bf16 v[156:159], v[60:63], v[104:107], v[156:159]
    v_mfma_f32_16x16x32_bf16 v[160:163], v[60:63], v[108:111], v[160:163]
    v_mfma_f32_16x16x32_bf16 v[164:167], v[60:63], v[112:115], v[164:167]
    ds_write_b128 v210, v[148:151] offset:3072
    v_mfma_f32_16x16x32_bf16 v[160:163], v[64:67], v[104:107], v[160:163]
    v_mfma_f32_16x16x32_bf16 v[164:167], v[64:67], v[108:111], v[164:167]
    ds_write_b128 v210, v[152:155] offset:4096
    v_mfma_f32_16x16x32_bf16 v[164:167], v[68:71], v[104:107], v[164:167]
    s_nop 1
    ds_write_b128 v210, v[156:159] offset:5120
    s_nop 3
    ds_write_b128 v210, v[160:163] offset:6144
    s_nop 0
    ds_write_b128 v210, v[164:167] offset:7168
    s_waitcnt lgkmcnt(0)
    s_mov_b64 exec, 1
    v_mov_b32 v104, 153536
    v_mov_b32 v105, 1
    ds_add_u32 v104, v105 offset:24
    s_mov_b64 exec, -1
    v_mov_b32 v104, 153536
L_lw18:
    ds_read_b32 v105, v104 offset:24
    s_add_u32 s42, s42, 1
    s_cmp_lt_u32 s42, 0xf42400
    s_cselect_b64 s[40:41], -1, 0
    s_waitcnt lgkmcnt(0)
    v_cmp_gt_u32 vcc, s101, v105
    s_and_b64 vcc, vcc, s[40:41]
    s_cbranch_vccnz L_lw18
    ds_read_b128 v[8:11], v211 offset:0
    ds_read_b128 v[12:15], v211 offset:256
    ds_read_b128 v[16:19], v211 offset:8192
    ds_read_b128 v[20:23], v211 offset:8448
    ds_read_b128 v[40:43], v211 offset:2048
    ds_read_b128 v[44:47], v211 offset:2304
    ds_read_b128 v[48:51], v211 offset:10240
    ds_read_b128 v[52:55], v211 offset:10496
    s_waitcnt lgkmcnt(4)
    v_add_f32 v8, v8, v16
    v_add_f32 v9, v9, v17
    v_add_f32 v10, v10, v18
    v_add_f32 v11, v11, v19
    v_add_f32 v12, v12, v20
    v_add_f32 v13, v13, v21
    v_add_f32 v14, v14, v22
    v_add_f32 v15, v15, v23
    v_cvt_pk_bf16_f32 v72, v8, v9
    v_cvt_pk_bf16_f32 v73, v10, v11
    v_cvt_pk_bf16_f32 v74, v12, v13
    v_cvt_pk_bf16_f32 v75, v14, v15
    buffer_store_dwordx4 v[72:75], v7, s[4:7], s53 offen offset:0 sc1
    s_waitcnt lgkmcnt(0)
    v_add_f32 v40, v40, v48
    v_add_f32 v41, v41, v49
    v_add_f32 v42, v42, v50
    v_add_f32 v43, v43, v51
    v_add_f32 v44, v44, v52
    v_add_f32 v45, v45, v53
    v_add_f32 v46, v46, v54
    v_add_f32 v47, v47, v55
    v_cvt_pk_bf16_f32 v76, v40, v41
    v_cvt_pk_bf16_f32 v77, v42, v43
    v_cvt_pk_bf16_f32 v78, v44, v45
    v_cvt_pk_bf16_f32 v79, v46, v47
    buffer_store_dwordx4 v[76:79], v7, s[4:7], s53 offen offset:1024 sc1
    s_mov_b64 exec, 1
    v_mov_b32 v104, 153536
    v_mov_b32 v105, 1
    ds_add_u32 v104, v105 offset:28
    s_mov_b64 exec, -1
    s_cmp_lt_u32 s2, 224
    s_cbranch_scc1 L_h
    s_cmp_eq_u32 s101, 8
    s_cbranch_scc1 L_h
    v_mov_b32 v8, 153536
L_lw19:
    ds_read_b32 v9, v8 offset:28
    s_add_u32 s42, s42, 1
    s_cmp_lt_u32 s42, 0xf42400
    s_cselect_b64 s[40:41], -1, 0
    s_waitcnt lgkmcnt(0)
    v_cmp_gt_u32 vcc, 4, v9
    s_and_b64 vcc, vcc, s[40:41]
    s_cbranch_vccnz L_lw19
    s_mov_b32 s101, 8
    s_add_u32 s100, s2, 32
    s_branch L_conv
L_h:
    s_and_b32 s50, s2, 7
    s_lshl_b32 s50, s50, 2
    s_bfe_u32 s51, s2, 0x20003
    s_add_u32 s50, s50, s51
    s_lshr_b32 s51, s2, 5
    s_mul_i32 s52, s50, 0x12000
    s_add_u32 s53, s52, 0x240000
    s_add_u32 s54, s52, 0x480000
    v_and_b32 v8, 31, v0
    v_lshrrev_b32 v9, 5, v0
    v_mul_u32_u24 v180, 33024, v9
    v_lshl_add_u32 v180, v8, 4, v180
    v_lshlrev_b32 v181, 2, v0
    s_lshl_b32 s55, s51, 2
    s_and_b32 s56, s3, 3
    s_add_u32 s55, s55, s56
    s_mul_i32 s0, s50, 66048
    s_lshl_b32 s56, s55, 10
    s_add_u32 s0, s0, s56
    s_add_u32 s0, s0, 0x700000
    s_mul_i32 s1, s50, 8320
    s_lshl_b32 s56, s55, 8
    s_add_u32 s1, s1, s56
    s_add_u32 s1, s1, 0x980000
    v_mov_b32 v16, -1
    v_mov_b32 v17, -1
    v_mov_b32 v18, -1
    v_mov_b32 v19, -1
    s_and_b32 s50, s2, 7
    s_lshl_b32 s50, s50, 2
    s_bfe_u32 s51, s2, 0x20003
    s_add_u32 s50, s50, s51
    s_lshr_b32 s51, s2, 5
    s_mul_i32 s52, s50, 0x12000
    s_add_u32 s53, s52, 0x240000
    s_add_u32 s54, s52, 0x480000
    v_lshrrev_b32 v8, 5, v0
    v_add_u32 v8, 1, v8
    v_bfe_u32 v9, v0, 4, 1
    v_and_b32 v10, 15, v0
    v_mul_u32_u24 v12, 576, v8
    v_mul_u32_u24 v11, 17, v9
    s_mul_i32 s55, s50, 18
    v_add3_u32 v12, v12, v11, s55
    v_lshrrev_b32 v12, 7, v12
    v_lshl_add_u32 v12, v12, 4, v10
    v_lshlrev_b32 v12, 7, v12
    v_mov_b32 v8, 153536
L_lw20_t:
    ds_read_b32 v9, v8 offset:20
    s_waitcnt lgkmcnt(0)
    v_cmp_gt_u32 vcc, 4, v9
    s_cbranch_vccnz L_lw20
L_lw20_x:
    s_mov_b32 s44, 0x12c0000
    s_mov_b32 s60, 0
L_poll21:
    buffer_load_dword v8, v12, s[4:7], s44 offen sc1
    s_add_u32 s60, s60, 1
    s_waitcnt vmcnt(0)
    v_cmp_ne_u32 vcc, s38, v8
    s_cbranch_vccz L_poll21_ok
    s_sleep 8
    s_cmp_lt_u32 s60, 0xf4240
    s_cbranch_scc1 L_poll21
L_poll21_ok:
    s_and_b32 s57, s3, 3
    s_lshl_b32 s44, s57, 12
    s_add_u32 s45, s53, s44
    s_mul_i32 s46, s57, 1088
    s_add_u32 m0, s46, 57216
    s_add_u32 s47, s45, 1024
    buffer_load_dwordx4 v7, s[4:7], s47 offen sc1 lds
    s_add_u32 m0, s46, 61568
    s_add_u32 s47, s45, 17408
    buffer_load_dwordx4 v7, s[4:7], s47 offen sc1 lds
    s_add_u32 m0, s46, 65920
    s_add_u32 s47, s45, 33792
    buffer_load_dwordx4 v7, s[4:7], s47 offen sc1 lds
    s_add_u32 m0, s46, 70272
    s_add_u32 s47, s45, 50176
    buffer_load_dwordx4 v7, s[4:7], s47 offen sc1 lds
    s_and_b32 s47, s57, 1
    s_bitcmp1_b32 s57, 1
    s_cselect_b32 s45, s54, s53
    s_mov_b32 s48, 36224
    s_mov_b32 s49, 1088
    s_cselect_b32 s48, 16672, s48
    s_cselect_b32 s49, 1040, s49
    s_mul_i32 s49, s49, s47
    s_add_u32 s48, s48, s49
    s_lshl_b32 s47, s47, 12
    s_add_u32 s45, s45, s47
    s_add_u32 m0, s48, 38400
    s_add_u32 s45, s45, 66560
    buffer_load_dwordx4 v7, s[4:7], s45 offen sc1 lds
    s_add_u32 s45, s54, s44
    s_mul_i32 s46, s57, 1040
    s_add_u32 m0, s46, 38432
    s_add_u32 s47, s45, 1024
    buffer_load_dwordx4 v7, s[4:7], s47 offen sc1 lds
    s_add_u32 m0, s46, 42592
    s_add_u32 s47, s45, 17408
    buffer_load_dwordx4 v7, s[4:7], s47 offen sc1 lds
    s_add_u32 m0, s46, 46752
    s_add_u32 s47, s45, 33792
    buffer_load_dwordx4 v7, s[4:7], s47 offen sc1 lds
    s_add_u32 m0, s46, 50912
    s_add_u32 s47, s45, 50176
    buffer_load_dwordx4 v7, s[4:7], s47 offen sc1 lds
    s_waitcnt vmcnt(0)
    s_mov_b64 exec, 1
    v_mov_b32 v8, 153536
    v_mov_b32 v9, 1
    ds_add_u32 v8, v9 offset:32
    s_mov_b64 exec, -1
    s_and_b32 s57, s3, 3
    v_mov_b32 v8, 153536
    v_mov_b32 v9, 0
    ds_write_b32 v8, v9 offset:44
    ds_write_b32 v8, v9 offset:12
    v_mov_b32 v8, 153536
L_lw22:
    ds_read_b32 v9, v8 offset:28
    s_add_u32 s42, s42, 1
    s_cmp_lt_u32 s42, 0xf42400
    s_cselect_b64 s[40:41], -1, 0
    s_waitcnt lgkmcnt(0)
    v_cmp_gt_u32 vcc, s101, v9
    s_and_b64 vcc, vcc, s[40:41]
    s_cbranch_vccnz L_lw22
    v_mov_b32 v8, 153536
    s_setprio 0
L_lw23_t:
    ds_read_b32 v9, v8 offset:52
    s_waitcnt lgkmcnt(0)
    v_cmp_gt_u32 vcc, 1, v9
    s_cbranch_vccnz L_lw23
L_lw23_x:
    buffer_store_dwordx4 v[16:19], v180, s[4:7], s0 offen offset:0 sc1
    buffer_store_dwordx4 v[16:19], v180, s[4:7], s0 offen offset:512 sc1
    buffer_store_dword v16, v181, s[4:7], s1 offen sc1
    s_lshl_b32 s44, s57, 12
    s_add_u32 s45, s53, s44
    s_mul_i32 s46, s57, 1088
    s_add_u32 m0, s46, 95616
    s_add_u32 s47, s45, 2048
    buffer_load_dwordx4 v7, s[4:7], s47 offen sc1 lds
    s_add_u32 m0, s46, 99968
    s_add_u32 s47, s45, 18432
    buffer_load_dwordx4 v7, s[4:7], s47 offen sc1 lds
    s_add_u32 m0, s46, 104320
    s_add_u32 s47, s45, 34816
    buffer_load_dwordx4 v7, s[4:7], s47 offen sc1 lds
    s_add_u32 m0, s46, 108672
    s_add_u32 s47, s45, 51200
    buffer_load_dwordx4 v7, s[4:7], s47 offen sc1 lds
    s_and_b32 s47, s57, 1
    s_bitcmp1_b32 s57, 1
    s_cselect_b32 s45, s54, s53
    s_mov_b32 s48, 36224
    s_mov_b32 s49, 1088
    s_cselect_b32 s48, 16672, s48
    s_cselect_b32 s49, 1040, s49
    s_mul_i32 s49, s49, s47
    s_add_u32 s48, s48, s49
    s_lshl_b32 s47, s47, 12
    s_add_u32 s45, s45, s47
    s_add_u32 m0, s48, 76800
    s_add_u32 s45, s45, 67584
    buffer_load_dwordx4 v7, s[4:7], s45 offen sc1 lds
    s_add_u32 s45, s54, s44
    s_mul_i32 s46, s57, 1040
    s_add_u32 m0, s46, 76832
    s_add_u32 s47, s45, 2048
    buffer_load_dwordx4 v7, s[4:7], s47 offen sc1 lds
    s_add_u32 m0, s46, 80992
    s_add_u32 s47, s45, 18432
    buffer_load_dwordx4 v7, s[4:7], s47 offen sc1 lds
    s_add_u32 m0, s46, 85152
    s_add_u32 s47, s45, 34816
    buffer_load_dwordx4 v7, s[4:7], s47 offen sc1 lds
    s_add_u32 m0, s46, 89312
    s_add_u32 s47, s45, 51200
    buffer_load_dwordx4 v7, s[4:7], s47 offen sc1 lds
    s_lshl_b32 s44, s57, 12
    s_add_u32 s45, s53, s44
    s_mul_i32 s46, s57, 1088
    s_add_u32 m0, s46, 134016
    s_add_u32 s47, s45, 3072
    buffer_load_dwordx4 v7, s[4:7], s47 offen sc1 lds
    s_add_u32 m0, s46, 138368
    s_add_u32 s47, s45, 19456
    buffer_load_dwordx4 v7, s[4:7], s47 offen sc1 lds
    s_add_u32 m0, s46, 142720
    s_add_u32 s47, s45, 35840
    buffer_load_dwordx4 v7, s[4:7], s47 offen sc1 lds
    s_add_u32 m0, s46, 147072
    s_add_u32 s47, s45, 52224
    buffer_load_dwordx4 v7, s[4:7], s47 offen sc1 lds
    s_and_b32 s47, s57, 1
    s_bitcmp1_b32 s57, 1
    s_cselect_b32 s45, s54, s53
    s_mov_b32 s48, 36224
    s_mov_b32 s49, 1088
    s_cselect_b32 s48, 16672, s48
    s_cselect_b32 s49, 1040, s49
    s_mul_i32 s49, s49, s47
    s_add_u32 s48, s48, s49
    s_lshl_b32 s47, s47, 12
    s_add_u32 s45, s45, s47
    s_add_u32 m0, s48, 115200
    s_add_u32 s45, s45, 68608
    buffer_load_dwordx4 v7, s[4:7], s45 offen sc1 lds
    s_add_u32 s45, s54, s44
    s_mul_i32 s46, s57, 1040
    s_add_u32 m0, s46, 115232
    s_add_u32 s47, s45, 3072
    buffer_load_dwordx4 v7, s[4:7], s47 offen sc1 lds
    s_add_u32 m0, s46, 119392
    s_add_u32 s47, s45, 19456
    buffer_load_dwordx4 v7, s[4:7], s47 offen sc1 lds
    s_add_u32 m0, s46, 123552
    s_add_u32 s47, s45, 35840
    buffer_load_dwordx4 v7, s[4:7], s47 offen sc1 lds
    s_add_u32 m0, s46, 127712
    s_add_u32 s47, s45, 52224
    buffer_load_dwordx4 v7, s[4:7], s47 offen sc1 lds
    v_mov_b32 v9, 1
    s_waitcnt vmcnt(0)
    s_mov_b64 exec, 1
    ds_add_rtn_u32 v10, v8, v9 offset:36
    s_waitcnt lgkmcnt(0)
    v_cmp_eq_u32 vcc, 3, v10
    s_cbranch_vccz L_h_noy
    s_lshl_b32 s44, s2, 7
    s_add_u32 s44, s44, 0x12d0000
    v_mov_b32 v10, s38
    buffer_store_dword v10, off, s[4:7], s44 sc1
L_h_noy:
    s_mov_b64 exec, -1
    s_cmp_lg_u32 s3, 5
    s_cbranch_scc1 L_h_n5
    v_lshlrev_b32 v8, 7, v0
    s_mov_b32 s60, 0
L_y_poll:
    s_sleep 50
    s_mov_b32 s44, 0x12d0000
    buffer_load_dword v9, v8, s[4:7], s44 offen sc1
    s_mov_b32 s44, 0x12d2000
    buffer_load_dword v10, v8, s[4:7], s44 offen sc1
    s_mov_b32 s44, 0x12d4000
    buffer_load_dword v11, v8, s[4:7], s44 offen sc1
    s_mov_b32 s44, 0x12d6000
    buffer_load_dword v12, v8, s[4:7], s44 offen sc1
    s_add_u32 s60, s60, 1
    s_waitcnt vmcnt(0)
    v_xor_b32 v9, s38, v9
    v_xor_b32 v10, s38, v10
    v_xor_b32 v11, s38, v11
    v_xor_b32 v12, s38, v12
    v_or3_b32 v9, v9, v10, v11
    v_or_b32 v9, v9, v12
    v_cmp_ne_u32 vcc, 0, v9
    s_cbranch_vccz L_y_ok
    s_cmp_lt_u32 s60, 0xf4240
    s_cbranch_scc1 L_y_poll
L_y_ok:
    s_mov_b64 exec, 1
    v_mov_b32 v9, 153536
    v_mov_b32 v10, 1
    ds_add_u32 v9, v10 offset:0
    s_mov_b64 exec, -1
    s_cmp_lg_u32 s2, 0
    s_cbranch_scc1 L_y_nt
    s_mov_b64 exec, 1
    v_mov_b32 v9, s38
    s_mov_b32 s44, 0x12c7800
    buffer_store_dword v9, off, s[4:7], s44 sc1
    s_mov_b64 exec, -1
L_y_nt:
L_h_n5:
    s_cmp_lg_u32 s3, 4
    s_cbranch_scc1 L_h_not
    v_mov_b32 v8, 153536
    s_setprio 0
L_lw24_t:
    ds_read_b32 v9, v8 offset:0
    s_waitcnt lgkmcnt(0)
    v_cmp_gt_u32 vcc, 2, v9
    s_cbranch_vccnz L_lw24
L_lw24_x:
    s_mov_b32 s8, s36
    s_mov_b32 s9, s37
    s_mov_b32 s10, 0x480000
    s_mov_b32 s11, 0x00020000
    v_mov_b32 v8, 153536
L_lw25:
    ds_read_b32 v9, v8 offset:48
    s_add_u32 s42, s42, 1
    s_cmp_lt_u32 s42, 0xf42400
    s_cselect_b64 s[40:41], -1, 0
    s_waitcnt lgkmcnt(0)
    v_cmp_gt_u32 vcc, 4, v9
    s_and_b64 vcc, vcc, s[40:41]
    s_cbranch_vccnz L_lw25
    v_lshrrev_b32 v11, 3, v0
    v_lshlrev_b32 v11, 12, v11
    v_and_b32 v9, 7, v0
    v_lshl_add_u32 v11, v9, 4, v11
    v_lshrrev_b32 v8, 4, v0
    v_mul_u32_u24 v12, 1040, v8
    v_bfe_u32 v10, v0, 2, 2
    v_lshl_add_u32 v12, v10, 7, v12
    v_and_b32 v9, 3, v0
    v_lshl_add_u32 v12, v9, 3, v12
    v_add_u32 v12, 153600, v12
    v_and_b32 v9, 15, v0
    v_mul_u32_u24 v13, 2304, v9
    v_lshl_add_u32 v13, v8, 4, v13
    s_mov_b32 s44, s2
L_y_unit:
    s_and_b32 s45, s44, 31
    s_lshr_b32 s46, s44, 5
    s_lshl_b32 s47, s46, 18
    s_lshl_b32 s48, s45, 7
    s_add_u32 s47, s47, s48
    s_add_u32 s47, s47, 0x1000000
    s_mov_b32 m0, 153600
    s_add_u32 s48, s47, 0
    buffer_load_dwordx4 v11, s[4:7], s48 offen sc1 lds
    s_mov_b32 m0, 154640
    s_add_u32 s48, s47, 32768
    buffer_load_dwordx4 v11, s[4:7], s48 offen sc1 lds
    s_mov_b32 m0, 155680
    s_add_u32 s48, s47, 65536
    buffer_load_dwordx4 v11, s[4:7], s48 offen sc1 lds
    s_mov_b32 m0, 156720
    s_add_u32 s48, s47, 98304
    buffer_load_dwordx4 v11, s[4:7], s48 offen sc1 lds
    s_mov_b32 m0, 157760
    s_add_u32 s48, s47, 131072
    buffer_load_dwordx4 v11, s[4:7], s48 offen sc1 lds
    s_mov_b32 m0, 158800
    s_add_u32 s48, s47, 163840
    buffer_load_dwordx4 v11, s[4:7], s48 offen sc1 lds
    s_mov_b32 m0, 159840
    s_add_u32 s48, s47, 196608
    buffer_load_dwordx4 v11, s[4:7], s48 offen sc1 lds
    s_mov_b32 m0, 160880
    s_add_u32 s48, s47, 229376
    buffer_load_dwordx4 v11, s[4:7], s48 offen sc1 lds
    s_mul_i32 s47, s45, 147456
    s_lshl_b32 s48, s46, 7
    s_add_u32 s47, s47, s48
    s_add_u32 s47, s47, 1152
    s_waitcnt vmcnt(0)
    ds_read_b64_tr_b16 v[16:17], v12 offset:0
    ds_read_b64_tr_b16 v[18:19], v12 offset:512
    ds_read_b64_tr_b16 v[20:21], v12 offset:32
    ds_read_b64_tr_b16 v[22:23], v12 offset:544
    ds_read_b64_tr_b16 v[24:25], v12 offset:64
    ds_read_b64_tr_b16 v[26:27], v12 offset:576
    ds_read_b64_tr_b16 v[28:29], v12 offset:96
    ds_read_b64_tr_b16 v[30:31], v12 offset:608
    s_waitcnt lgkmcnt(6)
    s_add_u32 s48, s47, 0
    s_waitcnt vmcnt(1)
    buffer_store_dwordx4 v[16:19], v13, s[8:11], s48 offen offset:0
    s_waitcnt lgkmcnt(4)
    s_add_u32 s48, s47, 36864
    s_waitcnt vmcnt(1)
    buffer_store_dwordx4 v[20:23], v13, s[8:11], s48 offen offset:0
    s_waitcnt lgkmcnt(2)
    s_add_u32 s48, s47, 73728
    s_waitcnt vmcnt(1)
    buffer_store_dwordx4 v[24:27], v13, s[8:11], s48 offen offset:0
    s_waitcnt lgkmcnt(0)
    s_add_u32 s48, s47, 110592
    s_waitcnt vmcnt(1)
    buffer_store_dwordx4 v[28:31], v13, s[8:11], s48 offen offset:0
    ds_read_b64_tr_b16 v[32:33], v12 offset:4160
    ds_read_b64_tr_b16 v[34:35], v12 offset:4672
    ds_read_b64_tr_b16 v[36:37], v12 offset:4192
    ds_read_b64_tr_b16 v[38:39], v12 offset:4704
    ds_read_b64_tr_b16 v[40:41], v12 offset:4224
    ds_read_b64_tr_b16 v[42:43], v12 offset:4736
    ds_read_b64_tr_b16 v[44:45], v12 offset:4256
    ds_read_b64_tr_b16 v[46:47], v12 offset:4768
    s_waitcnt lgkmcnt(6)
    s_add_u32 s48, s47, 0
    s_waitcnt vmcnt(1)
    buffer_store_dwordx4 v[32:35], v13, s[8:11], s48 offen offset:64
    s_waitcnt lgkmcnt(4)
    s_add_u32 s48, s47, 36864
    s_waitcnt vmcnt(1)
    buffer_store_dwordx4 v[36:39], v13, s[8:11], s48 offen offset:64
    s_waitcnt lgkmcnt(2)
    s_add_u32 s48, s47, 73728
    s_waitcnt vmcnt(1)
    buffer_store_dwordx4 v[40:43], v13, s[8:11], s48 offen offset:64
    s_waitcnt lgkmcnt(0)
    s_add_u32 s48, s47, 110592
    s_waitcnt vmcnt(1)
    buffer_store_dwordx4 v[44:47], v13, s[8:11], s48 offen offset:64
    s_add_u32 s44, s44, 64
    s_sub_u32 s45, s44, 256
    s_cmp_lt_u32 s45, 32
    s_cbranch_scc1 L_y_unit
    s_mov_b64 exec, 1
    v_mov_b32 v8, 153536
    v_mov_b32 v9, 1
    ds_add_u32 v8, v9 offset:60
    s_mov_b64 exec, -1
L_h_not:
    s_cmp_ge_u32 s2, 192
    s_cbranch_scc1 L_end
    v_mov_b32 v8, 153536
    s_setprio 0
L_lw26_t:
    ds_read_b32 v9, v8 offset:0
    s_waitcnt lgkmcnt(0)
    v_cmp_gt_u32 vcc, 2, v9
    s_cbranch_vccnz L_lw26
L_lw26_x:
    s_setprio 0
    s_mov_b32 s8, s36
    s_mov_b32 s9, s37
    s_mov_b32 s10, 0x480000
    s_mov_b32 s11, 0x00020000
    s_and_b32 s44, s2, 7
    s_lshl_b32 s44, s44, 2
    s_bfe_u32 s46, s2, 0x20003
    s_add_u32 s44, s44, s46
    s_lshl_b32 s44, s44, 6
    v_and_b32 v36, 15, v0
    v_lshrrev_b32 v37, 4, v0
    v_mul_u32_u24 v32, 33024, v37
    v_mul_u32_u24 v33, 33280, v37
    v_lshl_add_u32 v33, v36, 2, v33
    v_lshl_add_u32 v32, v36, 4, v32
    v_mov_b32 v35, 153536
    s_and_b32 s57, s3, 3
    s_lshl_b32 s46, s57, 4
    s_add_u32 s46, s46, s44
    s_lshl_b32 s47, s46, 4
    s_add_u32 s47, s47, 0x700000
    s_lshl_b32 s48, s46, 2
    s_add_u32 s48, s48, 0x980000
    v_add_u32 v40, 49152, v7
    s_mov_b32 s59, 0
    s_mov_b32 s60, 0
    s_mul_i32 s61, s57, 3328
    s_add_u32 s61, s61, 115200
    v_mul_u32_u24 v252, 208, v36
    v_lshl_add_u32 v252, v37, 3, v252
    v_add_u32 v252, s61, v252
    v_add_u32 v38, 0, v0
    v_mul_u32_u24 v39, 5462, v38
    v_lshrrev_b32 v39, 16, v39
    v_lshlrev_b32 v38, 4, v38
    v_lshl_add_u32 v253, v39, 4, v38
    v_add_u32 v253, s61, v253
    v_mul_u32_u24 v39, 2112, v39
    v_add_u32 v6, v38, v39
    v_add_u32 v38, 64, v0
    v_mul_u32_u24 v39, 5462, v38
    v_lshrrev_b32 v39, 16, v39
    v_lshlrev_b32 v38, 4, v38
    v_lshl_add_u32 v254, v39, 4, v38
    v_add_u32 v254, s61, v254
    v_mul_u32_u24 v39, 2112, v39
    v_add_u32 v5, v38, v39
    v_add_u32 v38, 128, v0
    v_mul_u32_u24 v39, 5462, v38
    v_lshrrev_b32 v39, 16, v39
    v_lshlrev_b32 v38, 4, v38
    v_lshl_add_u32 v255, v39, 4, v38
    v_add_u32 v255, s61, v255
    v_mul_u32_u24 v39, 2112, v39
    v_add_u32 v4, v38, v39
    s_mul_i32 s61, s46, 2304
    s_lshr_b32 s45, s2, 5
    s_mul_i32 s45, s45, 192
    s_add_u32 s61, s61, s45
    s_mov_b32 s50, s46
    s_and_b32 s57, s3, 3
    s_mul_i32 s44, s57, 27648
    s_lshr_b32 s45, s2, 5
    s_mul_i32 s45, s45, 110592
    s_add_u32 s45, s45, s44
    s_add_u32 s45, s45, 0xa00000
    v_mov_b32 v38, 153536
    s_setprio 0
L_lw27_t:
    ds_read_b32 v39, v38 offset:52
    s_waitcnt lgkmcnt(0)
    v_cmp_gt_u32 vcc, 8, v39
    s_cbranch_vccnz L_lw27
L_lw27_x:
    s_setprio 0
    s_add_u32 m0, s44, 0
    s_add_u32 s46, s45, 0
    buffer_load_dwordx4 v7, s[4:7], s46 offen offset:0 sc1 lds
    buffer_load_dwordx4 v7, s[4:7], s46 offen offset:1024 sc1 lds
    buffer_load_dwordx4 v7, s[4:7], s46 offen offset:2048 sc1 lds
    buffer_load_dwordx4 v7, s[4:7], s46 offen offset:3072 sc1 lds
    s_add_u32 m0, s44, 4096
    s_add_u32 s46, s45, 4096
    buffer_load_dwordx4 v7, s[4:7], s46 offen offset:0 sc1 lds
    s_waitcnt vmcnt(4)
    buffer_load_dwordx4 v7, s[4:7], s46 offen offset:1024 sc1 lds
    s_waitcnt vmcnt(4)
    buffer_load_dwordx4 v7, s[4:7], s46 offen offset:2048 sc1 lds
    s_waitcnt vmcnt(4)
    buffer_load_dwordx4 v7, s[4:7], s46 offen offset:3072 sc1 lds
    s_waitcnt vmcnt(4)
    s_add_u32 m0, s44, 8192
    s_add_u32 s46, s45, 8192
    buffer_load_dwordx4 v7, s[4:7], s46 offen offset:0 sc1 lds
    s_waitcnt vmcnt(4)
    buffer_load_dwordx4 v7, s[4:7], s46 offen offset:1024 sc1 lds
    s_waitcnt vmcnt(4)
    buffer_load_dwordx4 v7, s[4:7], s46 offen offset:2048 sc1 lds
    s_waitcnt vmcnt(4)
    buffer_load_dwordx4 v7, s[4:7], s46 offen offset:3072 sc1 lds
    s_waitcnt vmcnt(4)
    s_add_u32 m0, s44, 12288
    s_add_u32 s46, s45, 12288
    buffer_load_dwordx4 v7, s[4:7], s46 offen offset:0 sc1 lds
    s_waitcnt vmcnt(4)
    buffer_load_dwordx4 v7, s[4:7], s46 offen offset:1024 sc1 lds
    s_waitcnt vmcnt(4)
    buffer_load_dwordx4 v7, s[4:7], s46 offen offset:2048 sc1 lds
    s_waitcnt vmcnt(4)
    buffer_load_dwordx4 v7, s[4:7], s46 offen offset:3072 sc1 lds
    s_waitcnt vmcnt(4)
    s_add_u32 m0, s44, 16384
    s_add_u32 s46, s45, 16384
    buffer_load_dwordx4 v7, s[4:7], s46 offen offset:0 sc1 lds
    s_waitcnt vmcnt(4)
    buffer_load_dwordx4 v7, s[4:7], s46 offen offset:1024 sc1 lds
    s_waitcnt vmcnt(4)
    buffer_load_dwordx4 v7, s[4:7], s46 offen offset:2048 sc1 lds
    s_waitcnt vmcnt(4)
    buffer_load_dwordx4 v7, s[4:7], s46 offen offset:3072 sc1 lds
    s_waitcnt vmcnt(4)
    s_add_u32 m0, s44, 20480
    s_add_u32 s46, s45, 20480
    buffer_load_dwordx4 v7, s[4:7], s46 offen offset:0 sc1 lds
    s_waitcnt vmcnt(4)
    buffer_load_dwordx4 v7, s[4:7], s46 offen offset:1024 sc1 lds
    s_waitcnt vmcnt(4)
    buffer_load_dwordx4 v7, s[4:7], s46 offen offset:2048 sc1 lds
    s_waitcnt vmcnt(4)
    buffer_load_dwordx4 v7, s[4:7], s46 offen offset:3072 sc1 lds
    s_waitcnt vmcnt(4)
    s_add_u32 m0, s44, 24576
    s_add_u32 s46, s45, 24576
    buffer_load_dwordx4 v7, s[4:7], s46 offen offset:0 sc1 lds
    s_waitcnt vmcnt(4)
    buffer_load_dwordx4 v7, s[4:7], s46 offen offset:1024 sc1 lds
    s_waitcnt vmcnt(4)
    buffer_load_dwordx4 v7, s[4:7], s46 offen offset:2048 sc1 lds
    s_mov_b32 s46, s50
    s_waitcnt vmcnt(0)
    s_mov_b64 exec, 1
    v_mov_b32 v38, 153536
    v_mov_b32 v39, 1
    ds_add_u32 v38, v39 offset:44
    s_mov_b64 exec, -1
    v_mov_b32 v38, 153536
L_lw28_t:
    ds_read_b32 v39, v38 offset:44
    s_waitcnt lgkmcnt(0)
    v_cmp_gt_u32 vcc, 4, v39
    s_cbranch_vccnz L_lw28
L_lw28_x:
    s_setprio 0
    s_mov_b32 s53, 0
    s_mov_b32 s45, 0
    v_mov_b32 v38, 153536
L_lw29_t:
    ds_read_b32 v39, v38 offset:40
    s_waitcnt lgkmcnt(0)
    v_cmp_gt_u32 vcc, 4, v39
    s_cbranch_vccnz L_lw29
L_lw29_x:
    ds_read_b128 v[116:119], v7 offset:0
    ds_read_b128 v[120:123], v7 offset:1024
    ds_read_b128 v[124:127], v7 offset:2048
    ds_read_b128 v[128:131], v7 offset:3072
    ds_read_b128 v[132:135], v7 offset:4096
    ds_read_b128 v[136:139], v7 offset:5120
    ds_read_b128 v[140:143], v7 offset:6144
    ds_read_b128 v[144:147], v7 offset:7168
    ds_read_b128 v[148:151], v7 offset:8192
    ds_read_b128 v[152:155], v7 offset:9216
    ds_read_b128 v[156:159], v7 offset:10240
    ds_read_b128 v[160:163], v7 offset:11264
    ds_read_b128 v[164:167], v7 offset:12288
    ds_read_b128 v[168:171], v7 offset:13312
    ds_read_b128 v[172:175], v7 offset:14336
    ds_read_b128 v[176:179], v7 offset:15360
    ds_read_b128 v[180:183], v7 offset:16384
    ds_read_b128 v[184:187], v7 offset:17408
    ds_read_b128 v[188:191], v7 offset:18432
    ds_read_b128 v[192:195], v7 offset:19456
    ds_read_b128 v[196:199], v7 offset:20480
    ds_read_b128 v[200:203], v7 offset:21504
    ds_read_b128 v[204:207], v7 offset:22528
    ds_read_b128 v[208:211], v7 offset:23552
    ds_read_b128 v[212:215], v7 offset:24576
    ds_read_b128 v[216:219], v7 offset:25600
    ds_read_b128 v[220:223], v7 offset:26624
    ds_read_b128 v[224:227], v7 offset:27648
    ds_read_b128 v[228:231], v7 offset:28672
    ds_read_b128 v[232:235], v7 offset:29696
    ds_read_b128 v[236:239], v7 offset:30720
    ds_read_b128 v[240:243], v7 offset:31744
    s_waitcnt lgkmcnt(0)
    s_mov_b32 s44, 0
    s_cmp_eq_u32 s44, 0
    s_cbranch_scc1 L_p_s0
L_p_ok0:
    v_mfma_f32_16x16x32_bf16 v[8:11], v[116:119], v[44:47], 0
    ds_read_b128 v[244:247], v7 offset:32768
    v_mfma_f32_16x16x32_bf16 v[12:15], v[120:123], v[44:47], 0
    ds_read_b128 v[248:251], v7 offset:33792
    v_mfma_f32_16x16x32_bf16 v[16:19], v[124:127], v[44:47], 0
    ds_read_b128 v[116:119], v7 offset:34816
    v_mfma_f32_16x16x32_bf16 v[20:23], v[128:131], v[44:47], 0
    ds_read_b128 v[120:123], v7 offset:35840
    v_mfma_f32_16x16x32_bf16 v[24:27], v[132:135], v[44:47], 0
    v_mfma_f32_16x16x32_bf16 v[28:31], v[136:139], v[44:47], 0
    ds_read_b128 v[124:127], v7 offset:36864
    v_mfma_f32_16x16x32_bf16 v[8:11], v[140:143], v[48:51], v[8:11]
    ds_read_b128 v[128:131], v7 offset:37888
    v_mfma_f32_16x16x32_bf16 v[12:15], v[144:147], v[48:51], v[12:15]
    ds_read_b128 v[132:135], v7 offset:38912
    v_mfma_f32_16x16x32_bf16 v[16:19], v[148:151], v[48:51], v[16:19]
    ds_read_b128 v[136:139], v7 offset:39936
    v_mfma_f32_16x16x32_bf16 v[20:23], v[152:155], v[48:51], v[20:23]
    v_mfma_f32_16x16x32_bf16 v[24:27], v[156:159], v[48:51], v[24:27]
    ds_read_b128 v[140:143], v7 offset:40960
    v_mfma_f32_16x16x32_bf16 v[28:31], v[160:163], v[48:51], v[28:31]
    ds_read_b128 v[144:147], v7 offset:41984
    v_mfma_f32_16x16x32_bf16 v[8:11], v[164:167], v[52:55], v[8:11]
    ds_read_b128 v[148:151], v7 offset:43008
    v_mfma_f32_16x16x32_bf16 v[12:15], v[168:171], v[52:55], v[12:15]
    ds_read_b128 v[152:155], v7 offset:44032
    v_mfma_f32_16x16x32_bf16 v[16:19], v[172:175], v[52:55], v[16:19]
    v_mfma_f32_16x16x32_bf16 v[20:23], v[176:179], v[52:55], v[20:23]
    ds_read_b128 v[156:159], v7 offset:45056
    v_mfma_f32_16x16x32_bf16 v[24:27], v[180:183], v[52:55], v[24:27]
    ds_read_b128 v[160:163], v7 offset:46080
    v_mfma_f32_16x16x32_bf16 v[28:31], v[184:187], v[52:55], v[28:31]
    ds_read_b128 v[164:167], v7 offset:47104
    v_mfma_f32_16x16x32_bf16 v[8:11], v[188:191], v[56:59], v[8:11]
    ds_read_b128 v[168:171], v7 offset:48128
    v_mfma_f32_16x16x32_bf16 v[12:15], v[192:195], v[56:59], v[12:15]
    v_mfma_f32_16x16x32_bf16 v[16:19], v[196:199], v[56:59], v[16:19]
    ds_read_b128 v[172:175], v40 offset:0
    v_mfma_f32_16x16x32_bf16 v[20:23], v[200:203], v[56:59], v[20:23]
    ds_read_b128 v[176:179], v40 offset:1024
    v_mfma_f32_16x16x32_bf16 v[24:27], v[204:207], v[56:59], v[24:27]
    ds_read_b128 v[180:183], v40 offset:2048
    v_mfma_f32_16x16x32_bf16 v[28:31], v[208:211], v[56:59], v[28:31]
    ds_read_b128 v[184:187], v40 offset:3072
    s_cmp_eq_u32 s44, 0
    s_cbranch_scc1 L_p_s1
L_p_ok1:
    v_mfma_f32_16x16x32_bf16 v[8:11], v[212:215], v[60:63], v[8:11]
    v_mfma_f32_16x16x32_bf16 v[12:15], v[216:219], v[60:63], v[12:15]
    ds_read_b128 v[188:191], v40 offset:4096
    v_mfma_f32_16x16x32_bf16 v[16:19], v[220:223], v[60:63], v[16:19]
    ds_read_b128 v[192:195], v40 offset:5120
    v_mfma_f32_16x16x32_bf16 v[20:23], v[224:227], v[60:63], v[20:23]
    ds_read_b128 v[196:199], v40 offset:6144
    v_mfma_f32_16x16x32_bf16 v[24:27], v[228:231], v[60:63], v[24:27]
    ds_read_b128 v[200:203], v40 offset:7168
    v_mfma_f32_16x16x32_bf16 v[28:31], v[232:235], v[60:63], v[28:31]
    v_mfma_f32_16x16x32_bf16 v[8:11], v[236:239], v[64:67], v[8:11]
    ds_read_b128 v[204:207], v40 offset:8192
    v_mfma_f32_16x16x32_bf16 v[12:15], v[240:243], v[64:67], v[12:15]
    ds_read_b128 v[208:211], v40 offset:9216
    s_waitcnt lgkmcnt(15)
    v_mfma_f32_16x16x32_bf16 v[16:19], v[244:247], v[64:67], v[16:19]
    ds_read_b128 v[212:215], v40 offset:10240
    v_mfma_f32_16x16x32_bf16 v[20:23], v[248:251], v[64:67], v[20:23]
    ds_read_b128 v[216:219], v40 offset:11264
    v_mfma_f32_16x16x32_bf16 v[24:27], v[116:119], v[64:67], v[24:27]
    v_mfma_f32_16x16x32_bf16 v[28:31], v[120:123], v[64:67], v[28:31]
    ds_read_b128 v[220:223], v40 offset:12288
    s_waitcnt lgkmcnt(15)
    v_mfma_f32_16x16x32_bf16 v[8:11], v[124:127], v[68:71], v[8:11]
    ds_read_b128 v[224:227], v40 offset:13312
    v_mfma_f32_16x16x32_bf16 v[12:15], v[128:131], v[68:71], v[12:15]
    ds_read_b128 v[228:231], v40 offset:14336
    v_mfma_f32_16x16x32_bf16 v[16:19], v[132:135], v[68:71], v[16:19]
    ds_read_b128 v[232:235], v40 offset:15360
    v_mfma_f32_16x16x32_bf16 v[20:23], v[136:139], v[68:71], v[20:23]
    s_waitcnt lgkmcnt(15)
    v_mfma_f32_16x16x32_bf16 v[24:27], v[140:143], v[68:71], v[24:27]
    ds_read_b128 v[236:239], v40 offset:16384
    v_mfma_f32_16x16x32_bf16 v[28:31], v[144:147], v[68:71], v[28:31]
    ds_read_b128 v[240:243], v40 offset:17408
    v_mfma_f32_16x16x32_bf16 v[8:11], v[148:151], v[72:75], v[8:11]
    ds_read_b128 v[244:247], v40 offset:18432
    v_mfma_f32_16x16x32_bf16 v[12:15], v[152:155], v[72:75], v[12:15]
    ds_read_b128 v[248:251], v40 offset:19456
    s_waitcnt lgkmcnt(15)
    v_mfma_f32_16x16x32_bf16 v[16:19], v[156:159], v[72:75], v[16:19]
    v_mfma_f32_16x16x32_bf16 v[20:23], v[160:163], v[72:75], v[20:23]
    ds_read_b128 v[116:119], v40 offset:20480
    v_mfma_f32_16x16x32_bf16 v[24:27], v[164:167], v[72:75], v[24:27]
    ds_read_b128 v[120:123], v40 offset:21504
    v_mfma_f32_16x16x32_bf16 v[28:31], v[168:171], v[72:75], v[28:31]
    ds_read_b128 v[124:127], v40 offset:22528
    s_cmp_eq_u32 s44, 0
    s_cbranch_scc1 L_p_s2
L_p_ok2:
    s_waitcnt lgkmcnt(15)
    v_mfma_f32_16x16x32_bf16 v[8:11], v[172:175], v[76:79], v[8:11]
    ds_read_b128 v[128:131], v40 offset:23552
    v_mfma_f32_16x16x32_bf16 v[12:15], v[176:179], v[76:79], v[12:15]
    v_mfma_f32_16x16x32_bf16 v[16:19], v[180:183], v[76:79], v[16:19]
    ds_read_b128 v[132:135], v40 offset:24576
    v_mfma_f32_16x16x32_bf16 v[20:23], v[184:187], v[76:79], v[20:23]
    ds_read_b128 v[136:139], v40 offset:25600
    s_waitcnt lgkmcnt(15)
    v_mfma_f32_16x16x32_bf16 v[24:27], v[188:191], v[76:79], v[24:27]
    ds_read_b128 v[140:143], v40 offset:26624
    v_mfma_f32_16x16x32_bf16 v[28:31], v[192:195], v[76:79], v[28:31]
    ds_read_b128 v[144:147], v40 offset:27648
    v_mfma_f32_16x16x32_bf16 v[8:11], v[196:199], v[80:83], v[8:11]
    v_mfma_f32_16x16x32_bf16 v[12:15], v[200:203], v[80:83], v[12:15]
    ds_read_b128 v[148:151], v40 offset:28672
    s_waitcnt lgkmcnt(15)
    v_mfma_f32_16x16x32_bf16 v[16:19], v[204:207], v[80:83], v[16:19]
    ds_read_b128 v[152:155], v40 offset:29696
    v_mfma_f32_16x16x32_bf16 v[20:23], v[208:211], v[80:83], v[20:23]
    ds_read_b128 v[156:159], v40 offset:30720
    v_mfma_f32_16x16x32_bf16 v[24:27], v[212:215], v[80:83], v[24:27]
    ds_read_b128 v[160:163], v40 offset:31744
    v_mfma_f32_16x16x32_bf16 v[28:31], v[216:219], v[80:83], v[28:31]
    s_waitcnt lgkmcnt(15)
    v_mfma_f32_16x16x32_bf16 v[8:11], v[220:223], v[84:87], v[8:11]
    ds_read_b128 v[164:167], v40 offset:32768
    v_mfma_f32_16x16x32_bf16 v[12:15], v[224:227], v[84:87], v[12:15]
    ds_read_b128 v[168:171], v40 offset:33792
    v_mfma_f32_16x16x32_bf16 v[16:19], v[228:231], v[84:87], v[16:19]
    ds_read_b128 v[172:175], v40 offset:34816
    v_mfma_f32_16x16x32_bf16 v[20:23], v[232:235], v[84:87], v[20:23]
    ds_read_b128 v[176:179], v40 offset:35840
    s_waitcnt lgkmcnt(15)
    v_mfma_f32_16x16x32_bf16 v[24:27], v[236:239], v[84:87], v[24:27]
    v_mfma_f32_16x16x32_bf16 v[28:31], v[240:243], v[84:87], v[28:31]
    ds_read_b128 v[180:183], v40 offset:36864
    v_mfma_f32_16x16x32_bf16 v[8:11], v[244:247], v[88:91], v[8:11]
    ds_read_b128 v[184:187], v40 offset:37888
    v_mfma_f32_16x16x32_bf16 v[12:15], v[248:251], v[88:91], v[12:15]
    ds_read_b128 v[188:191], v40 offset:38912
    s_waitcnt lgkmcnt(15)
    v_mfma_f32_16x16x32_bf16 v[16:19], v[116:119], v[88:91], v[16:19]
    ds_read_b128 v[192:195], v40 offset:39936
    v_mfma_f32_16x16x32_bf16 v[20:23], v[120:123], v[88:91], v[20:23]
    v_mfma_f32_16x16x32_bf16 v[24:27], v[124:127], v[88:91], v[24:27]
    ds_read_b128 v[196:199], v40 offset:40960
    v_mfma_f32_16x16x32_bf16 v[28:31], v[128:131], v[88:91], v[28:31]
    ds_read_b128 v[200:203], v40 offset:41984
    s_cmp_eq_u32 s44, 0
    s_cbranch_scc1 L_p_s3
L_p_ok3:
    s_waitcnt lgkmcnt(14)
    v_mfma_f32_16x16x32_bf16 v[8:11], v[132:135], v[92:95], v[8:11]
    ds_read_b128 v[204:207], v40 offset:43008
    v_mfma_f32_16x16x32_bf16 v[12:15], v[136:139], v[92:95], v[12:15]
    ds_read_b128 v[208:211], v40 offset:44032
    v_mfma_f32_16x16x32_bf16 v[16:19], v[140:143], v[92:95], v[16:19]
    v_mfma_f32_16x16x32_bf16 v[20:23], v[144:147], v[92:95], v[20:23]
    ds_read_b128 v[212:215], v40 offset:45056
    s_waitcnt lgkmcnt(13)
    v_mfma_f32_16x16x32_bf16 v[24:27], v[148:151], v[92:95], v[24:27]
    ds_read_b128 v[216:219], v40 offset:46080
    v_mfma_f32_16x16x32_bf16 v[28:31], v[152:155], v[92:95], v[28:31]
    ds_read_b128 v[220:223], v40 offset:47104
    v_mfma_f32_16x16x32_bf16 v[8:11], v[156:159], v[96:99], v[8:11]
    ds_read_b128 v[224:227], v40 offset:48128
    v_mfma_f32_16x16x32_bf16 v[12:15], v[160:163], v[96:99], v[12:15]
    s_waitcnt lgkmcnt(12)
    v_mfma_f32_16x16x32_bf16 v[16:19], v[164:167], v[96:99], v[16:19]
    ds_read_b128 v[228:231], v40 offset:49152
    v_mfma_f32_16x16x32_bf16 v[20:23], v[168:171], v[96:99], v[20:23]
    ds_read_b128 v[232:235], v40 offset:50176
    v_mfma_f32_16x16x32_bf16 v[24:27], v[172:175], v[96:99], v[24:27]
    ds_read_b128 v[236:239], v40 offset:51200
    v_mfma_f32_16x16x32_bf16 v[28:31], v[176:179], v[96:99], v[28:31]
    ds_read_b128 v[240:243], v40 offset:52224
    s_waitcnt lgkmcnt(12)
    v_mfma_f32_16x16x32_bf16 v[8:11], v[180:183], v[100:103], v[8:11]
    v_mfma_f32_16x16x32_bf16 v[12:15], v[184:187], v[100:103], v[12:15]
    ds_read_b128 v[244:247], v40 offset:53248
    v_mfma_f32_16x16x32_bf16 v[16:19], v[188:191], v[100:103], v[16:19]
    ds_read_b128 v[248:251], v40 offset:54272
    v_mfma_f32_16x16x32_bf16 v[20:23], v[192:195], v[100:103], v[20:23]
    ds_read_b128 v[116:119], v40 offset:55296
    s_waitcnt lgkmcnt(11)
    v_mfma_f32_16x16x32_bf16 v[24:27], v[196:199], v[100:103], v[24:27]
    ds_read_b128 v[120:123], v40 offset:56320
    v_mfma_f32_16x16x32_bf16 v[28:31], v[200:203], v[100:103], v[28:31]
    v_mfma_f32_16x16x32_bf16 v[8:11], v[204:207], v[104:107], v[8:11]
    ds_read_b128 v[124:127], v40 offset:57344
    v_mfma_f32_16x16x32_bf16 v[12:15], v[208:211], v[104:107], v[12:15]
    ds_read_b128 v[128:131], v40 offset:58368
    s_waitcnt lgkmcnt(10)
    v_mfma_f32_16x16x32_bf16 v[16:19], v[212:215], v[104:107], v[16:19]
    ds_read_b128 v[132:135], v40 offset:59392
    v_mfma_f32_16x16x32_bf16 v[20:23], v[216:219], v[104:107], v[20:23]
    ds_read_b128 v[136:139], v40 offset:60416
    v_mfma_f32_16x16x32_bf16 v[24:27], v[220:223], v[104:107], v[24:27]
    v_mfma_f32_16x16x32_bf16 v[28:31], v[224:227], v[104:107], v[28:31]
    s_cmp_eq_u32 s44, 0
    s_cbranch_scc1 L_p_s4
L_p_ok4:
    s_waitcnt lgkmcnt(8)
    v_mfma_f32_16x16x32_bf16 v[8:11], v[228:231], v[108:111], v[8:11]
    v_mfma_f32_16x16x32_bf16 v[12:15], v[232:235], v[108:111], v[12:15]
    v_mfma_f32_16x16x32_bf16 v[16:19], v[236:239], v[108:111], v[16:19]
    v_mfma_f32_16x16x32_bf16 v[20:23], v[240:243], v[108:111], v[20:23]
    s_waitcnt lgkmcnt(4)
    v_mfma_f32_16x16x32_bf16 v[24:27], v[244:247], v[108:111], v[24:27]
    v_mfma_f32_16x16x32_bf16 v[28:31], v[248:251], v[108:111], v[28:31]
    v_mfma_f32_16x16x32_bf16 v[8:11], v[116:119], v[112:115], v[8:11]
    v_mfma_f32_16x16x32_bf16 v[12:15], v[120:123], v[112:115], v[12:15]
    s_waitcnt lgkmcnt(0)
    v_mfma_f32_16x16x32_bf16 v[16:19], v[124:127], v[112:115], v[16:19]
    v_mfma_f32_16x16x32_bf16 v[20:23], v[128:131], v[112:115], v[20:23]
    v_mfma_f32_16x16x32_bf16 v[24:27], v[132:135], v[112:115], v[24:27]
    v_mfma_f32_16x16x32_bf16 v[28:31], v[136:139], v[112:115], v[28:31]
    s_nop 2
    v_cvt_pk_bf16_f32 v44, v8, v9
    v_cvt_pk_bf16_f32 v45, v10, v11
    ds_write_b64 v252, v[44:45] offset:0
    v_cvt_pk_bf16_f32 v48, v12, v13
    v_cvt_pk_bf16_f32 v49, v14, v15
    ds_write_b64 v252, v[48:49] offset:32
    v_cvt_pk_bf16_f32 v52, v16, v17
    v_cvt_pk_bf16_f32 v53, v18, v19
    ds_write_b64 v252, v[52:53] offset:64
    v_cvt_pk_bf16_f32 v56, v20, v21
    v_cvt_pk_bf16_f32 v57, v22, v23
    ds_write_b64 v252, v[56:57] offset:96
    s_nop 0
    v_cvt_pk_bf16_f32 v60, v24, v25
    v_cvt_pk_bf16_f32 v61, v26, v27
    ds_write_b64 v252, v[60:61] offset:128
    v_cvt_pk_bf16_f32 v64, v28, v29
    v_cvt_pk_bf16_f32 v65, v30, v31
    ds_write_b64 v252, v[64:65] offset:160
    ds_read_b128 v[76:79], v253
    ds_read_b128 v[80:83], v254
    ds_read_b128 v[84:87], v255
    s_waitcnt lgkmcnt(2)
    buffer_store_dwordx4 v[76:79], v6, s[8:11], s61 offen
    s_waitcnt lgkmcnt(1)
    buffer_store_dwordx4 v[80:83], v5, s[8:11], s61 offen
    s_waitcnt lgkmcnt(0)
    buffer_store_dwordx4 v[84:87], v4, s[8:11], s61 offen
L_end:
L_exit:
    s_endpgm
L_p_probe:
    ds_read_b32 v34, v35 offset:12
    s_add_u32 s60, s60, 1
    s_waitcnt lgkmcnt(0)
    v_readfirstlane_b32 s55, v34
    s_cmp_lt_u32 s60, 0xf42400
    s_cselect_b32 s55, s55, -1
    s_cmp_lg_u32 s55, s45
    s_cbranch_scc1 L_p_chg
    s_setpc_b64 s[62:63]
L_p_chg:
    s_mov_b32 s45, s55
    s_not_b32 s55, s55
    s_bitcmp1_b32 s59, 0
    s_cbranch_scc1 L_p_pn0
    s_and_b32 s56, s55, 0xff
    s_cbranch_scc1 L_p_pn0
    s_bitset1_b32 s59, 0
    s_add_u32 s53, s53, 4
    s_mov_b32 s50, s53
    s_add_u32 s49, s47, 0
    buffer_load_dwordx4 v[44:47], v32, s[4:7], s49 offen sc1
    s_add_u32 s49, s47, 132096
    buffer_load_dwordx4 v[48:51], v32, s[4:7], s49 offen sc1
    s_add_u32 s49, s47, 264192
    buffer_load_dwordx4 v[52:55], v32, s[4:7], s49 offen sc1
    s_add_u32 s49, s47, 396288
    buffer_load_dwordx4 v[56:59], v32, s[4:7], s49 offen sc1
L_p_pn0:
    s_bitcmp1_b32 s59, 1
    s_cbranch_scc1 L_p_pn1
    s_and_b32 s56, s55, 0xff00
    s_cbranch_scc1 L_p_pn1
    s_bitset1_b32 s59, 1
    s_add_u32 s53, s53, 4
    s_mov_b32 s51, s53
    s_add_u32 s49, s47, 528384
    buffer_load_dwordx4 v[60:63], v32, s[4:7], s49 offen sc1
    s_add_u32 s49, s47, 660480
    buffer_load_dwordx4 v[64:67], v32, s[4:7], s49 offen sc1
    s_add_u32 s49, s47, 792576
    buffer_load_dwordx4 v[68:71], v32, s[4:7], s49 offen sc1
    s_add_u32 s49, s47, 924672
    buffer_load_dwordx4 v[72:75], v32, s[4:7], s49 offen sc1
L_p_pn1:
    s_bitcmp1_b32 s59, 2
    s_cbranch_scc1 L_p_pn2
    s_and_b32 s56, s55, 0xff0000
    s_cbranch_scc1 L_p_pn2
    s_bitset1_b32 s59, 2
    s_add_u32 s53, s53, 4
    s_mov_b32 s54, s53
    s_add_u32 s49, s47, 1056768
    buffer_load_dwordx4 v[76:79], v32, s[4:7], s49 offen sc1
    s_add_u32 s49, s47, 1188864
    buffer_load_dwordx4 v[80:83], v32, s[4:7], s49 offen sc1
    s_add_u32 s49, s47, 1320960
    buffer_load_dwordx4 v[84:87], v32, s[4:7], s49 offen sc1
    s_add_u32 s49, s47, 1453056
    buffer_load_dwordx4 v[88:91], v32, s[4:7], s49 offen sc1
L_p_pn2:
    s_bitcmp1_b32 s59, 3
    s_cbranch_scc1 L_p_pn3
    s_and_b32 s56, s55, 0xff000000
    s_cbranch_scc1 L_p_pn3
    s_bitset1_b32 s59, 3
    s_add_u32 s53, s53, 4
    s_mov_b32 s58, s53
    s_add_u32 s49, s47, 1585152
    buffer_load_dwordx4 v[92:95], v32, s[4:7], s49 offen sc1
    s_add_u32 s49, s47, 1717248
    buffer_load_dwordx4 v[96:99], v32, s[4:7], s49 offen sc1
    s_add_u32 s49, s47, 1849344
    buffer_load_dwordx4 v[100:103], v32, s[4:7], s49 offen sc1
    s_add_u32 s49, s47, 1981440
    buffer_load_dwordx4 v[104:107], v32, s[4:7], s49 offen sc1
L_p_pn3:
    s_bitcmp1_b32 s59, 4
    s_cbranch_scc1 L_p_pn4
    s_and_b32 s56, s55, 0xffffffff
    s_cbranch_scc1 L_p_pn4
    s_bitset1_b32 s59, 4
    s_add_u32 s53, s53, 8
    s_add_u32 s49, s48, 0
    buffer_load_dword v108, v33, s[4:7], s49 offen sc1
    s_add_u32 s49, s48, 8320
    buffer_load_dword v109, v33, s[4:7], s49 offen sc1
    s_add_u32 s49, s48, 16640
    buffer_load_dword v110, v33, s[4:7], s49 offen sc1
    s_add_u32 s49, s48, 24960
    buffer_load_dword v111, v33, s[4:7], s49 offen sc1
    s_add_u32 s49, s48, 133120
    buffer_load_dword v112, v33, s[4:7], s49 offen sc1
    s_add_u32 s49, s48, 141440
    buffer_load_dword v113, v33, s[4:7], s49 offen sc1
    s_add_u32 s49, s48, 149760
    buffer_load_dword v114, v33, s[4:7], s49 offen sc1
    s_add_u32 s49, s48, 158080
    buffer_load_dword v115, v33, s[4:7], s49 offen sc1
L_p_pn4:
L_p_px:
    s_setpc_b64 s[62:63]
L_p_wait:
    s_cmp_lg_u32 s52, 0
    s_cbranch_scc1 L_p_wt0
    s_waitcnt vmcnt(0)
    s_setpc_b64 s[62:63]
L_p_wt0:
    s_cmp_lg_u32 s52, 4
    s_cbranch_scc1 L_p_wt4
    s_waitcnt vmcnt(4)
    s_setpc_b64 s[62:63]
L_p_wt4:
    s_cmp_lg_u32 s52, 8
    s_cbranch_scc1 L_p_wt8
    s_waitcnt vmcnt(8)
    s_setpc_b64 s[62:63]
L_p_wt8:
    s_cmp_lg_u32 s52, 12
    s_cbranch_scc1 L_p_wt12
    s_waitcnt vmcnt(12)
    s_setpc_b64 s[62:63]
L_p_wt12:
    s_cmp_lg_u32 s52, 16
    s_cbranch_scc1 L_p_wt16
    s_waitcnt vmcnt(16)
    s_setpc_b64 s[62:63]
L_p_wt16:
    s_waitcnt vmcnt(20)
    s_setpc_b64 s[62:63]
L_p_s0:
    s_cmp_eq_u32 s59, 31
    s_cbranch_scc1 L_p_r0
    s_call_b64 s[62:63], L_p_probe
    s_bitcmp0_b32 s59, 0
    s_cbranch_scc1 L_p_s0
L_p_r0:
    s_sub_u32 s52, s53, s50
    s_cmp_eq_u32 s50, 16
    s_cbranch_scc0 L_p_w0
    s_call_b64 s[62:63], L_p_all
    s_cbranch_vccz L_p_ok0
    s_mov_b32 s44, 0
L_p_w0:
    s_call_b64 s[62:63], L_p_wait
L_p_c0:
    v_max3_u32 v38, v44, v45, v46
    v_max3_u32 v38, v38, v47, v48
    v_max3_u32 v38, v38, v49, v50
    v_max3_u32 v38, v38, v51, v52
    v_max3_u32 v38, v38, v53, v54
    v_max3_u32 v38, v38, v55, v56
    v_max3_u32 v38, v38, v57, v58
    v_max_u32 v38, v38, v59
    v_cmp_eq_u32 vcc, -1, v38
    s_cbranch_vccz L_p_ok0
    s_add_u32 s60, s60, 1
    s_cmp_ge_u32 s60, 0xf42400
    s_cbranch_scc1 L_p_ok0
    s_add_u32 s49, s47, 0
    buffer_load_dwordx4 v[44:47], v32, s[4:7], s49 offen sc1
    s_add_u32 s49, s47, 132096
    buffer_load_dwordx4 v[48:51], v32, s[4:7], s49 offen sc1
    s_add_u32 s49, s47, 264192
    buffer_load_dwordx4 v[52:55], v32, s[4:7], s49 offen sc1
    s_add_u32 s49, s47, 396288
    buffer_load_dwordx4 v[56:59], v32, s[4:7], s49 offen sc1
    s_waitcnt vmcnt(0)
    s_branch L_p_c0
L_p_s1:
    s_cmp_eq_u32 s59, 31
    s_cbranch_scc1 L_p_r1
    s_call_b64 s[62:63], L_p_probe
    s_bitcmp0_b32 s59, 1
    s_cbranch_scc1 L_p_s1
L_p_r1:
    s_sub_u32 s52, s53, s51
    s_cmp_eq_u32 s59, 31
    s_cbranch_scc0 L_p_w1
    s_call_b64 s[62:63], L_p_all
    s_cbranch_vccz L_p_ok1
    s_mov_b32 s44, 0
L_p_w1:
    s_call_b64 s[62:63], L_p_wait
L_p_c1:
    v_max3_u32 v38, v60, v61, v62
    v_max3_u32 v38, v38, v63, v64
    v_max3_u32 v38, v38, v65, v66
    v_max3_u32 v38, v38, v67, v68
    v_max3_u32 v38, v38, v69, v70
    v_max3_u32 v38, v38, v71, v72
    v_max3_u32 v38, v38, v73, v74
    v_max_u32 v38, v38, v75
    v_cmp_eq_u32 vcc, -1, v38
    s_cbranch_vccz L_p_ok1
    s_add_u32 s60, s60, 1
    s_cmp_ge_u32 s60, 0xf42400
    s_cbranch_scc1 L_p_ok1
    s_add_u32 s49, s47, 528384
    buffer_load_dwordx4 v[60:63], v32, s[4:7], s49 offen sc1
    s_add_u32 s49, s47, 660480
    buffer_load_dwordx4 v[64:67], v32, s[4:7], s49 offen sc1
    s_add_u32 s49, s47, 792576
    buffer_load_dwordx4 v[68:71], v32, s[4:7], s49 offen sc1
    s_add_u32 s49, s47, 924672
    buffer_load_dwordx4 v[72:75], v32, s[4:7], s49 offen sc1
    s_waitcnt vmcnt(0)
    s_branch L_p_c1
L_p_s2:
    s_cmp_eq_u32 s59, 31
    s_cbranch_scc1 L_p_r2
    s_call_b64 s[62:63], L_p_probe
    s_bitcmp0_b32 s59, 2
    s_cbranch_scc1 L_p_s2
L_p_r2:
    s_sub_u32 s52, s53, s54
    s_cmp_eq_u32 s59, 31
    s_cbranch_scc0 L_p_w2
    s_call_b64 s[62:63], L_p_all
    s_cbranch_vccz L_p_ok2
    s_mov_b32 s44, 0
L_p_w2:
    s_call_b64 s[62:63], L_p_wait
L_p_c2:
    v_max3_u32 v38, v76, v77, v78
    v_max3_u32 v38, v38, v79, v80
    v_max3_u32 v38, v38, v81, v82
    v_max3_u32 v38, v38, v83, v84
    v_max3_u32 v38, v38, v85, v86
    v_max3_u32 v38, v38, v87, v88
    v_max3_u32 v38, v38, v89, v90
    v_max_u32 v38, v38, v91
    v_cmp_eq_u32 vcc, -1, v38
    s_cbranch_vccz L_p_ok2
    s_add_u32 s60, s60, 1
    s_cmp_ge_u32 s60, 0xf42400
    s_cbranch_scc1 L_p_ok2
    s_add_u32 s49, s47, 1056768
    buffer_load_dwordx4 v[76:79], v32, s[4:7], s49 offen sc1
    s_add_u32 s49, s47, 1188864
    buffer_load_dwordx4 v[80:83], v32, s[4:7], s49 offen sc1
    s_add_u32 s49, s47, 1320960
    buffer_load_dwordx4 v[84:87], v32, s[4:7], s49 offen sc1
    s_add_u32 s49, s47, 1453056
    buffer_load_dwordx4 v[88:91], v32, s[4:7], s49 offen sc1
    s_waitcnt vmcnt(0)
    s_branch L_p_c2
L_p_s3:
    s_cmp_eq_u32 s59, 31
    s_cbranch_scc1 L_p_r3
    s_call_b64 s[62:63], L_p_probe
    s_bitcmp0_b32 s59, 3
    s_cbranch_scc1 L_p_s3
L_p_r3:
    s_sub_u32 s52, s53, s58
    s_cmp_eq_u32 s59, 31
    s_cbranch_scc0 L_p_w3
    s_call_b64 s[62:63], L_p_all
    s_cbranch_vccz L_p_ok3
    s_mov_b32 s44, 0
L_p_w3:
    s_call_b64 s[62:63], L_p_wait
L_p_c3:
    v_max3_u32 v38, v92, v93, v94
    v_max3_u32 v38, v38, v95, v96
    v_max3_u32 v38, v38, v97, v98
    v_max3_u32 v38, v38, v99, v100
    v_max3_u32 v38, v38, v101, v102
    v_max3_u32 v38, v38, v103, v104
    v_max3_u32 v38, v38, v105, v106
    v_max_u32 v38, v38, v107
    v_cmp_eq_u32 vcc, -1, v38
    s_cbranch_vccz L_p_ok3
    s_add_u32 s60, s60, 1
    s_cmp_ge_u32 s60, 0xf42400
    s_cbranch_scc1 L_p_ok3
    s_add_u32 s49, s47, 1585152
    buffer_load_dwordx4 v[92:95], v32, s[4:7], s49 offen sc1
    s_add_u32 s49, s47, 1717248
    buffer_load_dwordx4 v[96:99], v32, s[4:7], s49 offen sc1
    s_add_u32 s49, s47, 1849344
    buffer_load_dwordx4 v[100:103], v32, s[4:7], s49 offen sc1
    s_add_u32 s49, s47, 1981440
    buffer_load_dwordx4 v[104:107], v32, s[4:7], s49 offen sc1
    s_waitcnt vmcnt(0)
    s_branch L_p_c3
L_p_s4:
    s_waitcnt vmcnt(0)
L_p_c4:
    v_max3_u32 v38, v108, v109, v110
    v_max3_u32 v38, v38, v111, v112
    v_max3_u32 v38, v38, v113, v114
    v_max_u32 v38, v38, v115
    v_cmp_eq_u32 vcc, -1, v38
    s_cbranch_vccz L_p_ok4
    s_add_u32 s60, s60, 1
    s_cmp_ge_u32 s60, 0xf42400
    s_cbranch_scc1 L_p_ok4
    s_add_u32 s49, s48, 0
    buffer_load_dword v108, v33, s[4:7], s49 offen sc1
    s_add_u32 s49, s48, 8320
    buffer_load_dword v109, v33, s[4:7], s49 offen sc1
    s_add_u32 s49, s48, 16640
    buffer_load_dword v110, v33, s[4:7], s49 offen sc1
    s_add_u32 s49, s48, 24960
    buffer_load_dword v111, v33, s[4:7], s49 offen sc1
    s_add_u32 s49, s48, 133120
    buffer_load_dword v112, v33, s[4:7], s49 offen sc1
    s_add_u32 s49, s48, 141440
    buffer_load_dword v113, v33, s[4:7], s49 offen sc1
    s_add_u32 s49, s48, 149760
    buffer_load_dword v114, v33, s[4:7], s49 offen sc1
    s_add_u32 s49, s48, 158080
    buffer_load_dword v115, v33, s[4:7], s49 offen sc1
    s_waitcnt vmcnt(0)
    s_branch L_p_c4
L_p_all:
    s_waitcnt vmcnt(8)
    v_max3_u32 v38, v44, v45, v46
    v_max3_u32 v39, v47, v48, v49
    v_max3_u32 v38, v38, v50, v51
    v_max3_u32 v39, v39, v52, v53
    v_max3_u32 v38, v38, v54, v55
    v_max3_u32 v39, v39, v56, v57
    v_max3_u32 v38, v38, v58, v59
    v_max3_u32 v39, v39, v60, v61
    v_max3_u32 v38, v38, v62, v63
    v_max3_u32 v39, v39, v64, v65
    v_max3_u32 v38, v38, v66, v67
    v_max3_u32 v39, v39, v68, v69
    v_max3_u32 v38, v38, v70, v71
    v_max3_u32 v39, v39, v72, v73
    v_max3_u32 v38, v38, v74, v75
    v_max3_u32 v39, v39, v76, v77
    v_max3_u32 v38, v38, v78, v79
    v_max3_u32 v39, v39, v80, v81
    v_max3_u32 v38, v38, v82, v83
    v_max3_u32 v39, v39, v84, v85
    v_max3_u32 v38, v38, v86, v87
    v_max3_u32 v39, v39, v88, v89
    v_max3_u32 v38, v38, v90, v91
    v_max3_u32 v39, v39, v92, v93
    v_max3_u32 v38, v38, v94, v95
    v_max3_u32 v39, v39, v96, v97
    v_max3_u32 v38, v38, v98, v99
    v_max3_u32 v39, v39, v100, v101
    v_max3_u32 v38, v38, v102, v103
    v_max3_u32 v39, v39, v104, v105
    v_max3_u32 v38, v38, v106, v107
    s_waitcnt vmcnt(0)
    v_max3_u32 v39, v39, v108, v109
    v_max3_u32 v38, v38, v110, v111
    v_max3_u32 v39, v39, v112, v113
    v_max3_u32 v38, v38, v114, v115
    v_max_u32 v38, v38, v39
    v_cmp_eq_u32 vcc, -1, v38
    s_mov_b32 s44, 1
    s_setpc_b64 s[62:63]
L_lw20:
    s_sleep 4
    s_add_u32 s42, s42, 1
    s_cmp_lt_u32 s42, 0xf42400
    s_cbranch_scc1 L_lw20_t
    s_branch L_lw20_x
L_lw23:
    s_sleep 8
    s_add_u32 s42, s42, 1
    s_cmp_lt_u32 s42, 0xf42400
    s_cbranch_scc1 L_lw23_t
    s_branch L_lw23_x
L_lw24:
    s_sleep 16
    s_add_u32 s42, s42, 1
    s_cmp_lt_u32 s42, 0xf42400
    s_cbranch_scc1 L_lw24_t
    s_branch L_lw24_x
L_lw26:
    s_sleep 16
    s_add_u32 s42, s42, 1
    s_cmp_lt_u32 s42, 0xf42400
    s_cbranch_scc1 L_lw26_t
    s_branch L_lw26_x
L_lw27:
    s_sleep 16
    s_add_u32 s42, s42, 1
    s_cmp_lt_u32 s42, 0xf42400
    s_cbranch_scc1 L_lw27_t
    s_branch L_lw27_x
L_lw28:
    s_sleep 4
    s_add_u32 s42, s42, 1
    s_cmp_lt_u32 s42, 0xf42400
    s_cbranch_scc1 L_lw28_t
    s_branch L_lw28_x
L_lw29:
    s_sleep 2
    s_add_u32 s42, s42, 1
    s_cmp_lt_u32 s42, 0xf42400
    s_cbranch_scc1 L_lw29_t
    s_branch L_lw29_x
L_code_end:
.section .rodata,"a"
.p2align 6
.amdhsa_kernel concat_heads__mha_block__ssm_conv_s4d__prompt_kernel
  .amdhsa_next_free_vgpr 256
  .amdhsa_next_free_sgpr 102
  .amdhsa_accum_offset 256
  .amdhsa_group_segment_fixed_size 0
  .amdhsa_kernarg_size 104
  .amdhsa_user_sgpr_count 2
  .amdhsa_user_sgpr_kernarg_segment_ptr 1
  .amdhsa_system_sgpr_workgroup_id_x 1
.end_amdhsa_kernel
```
